```python
import torch

def _softmax(x, axis=-1):
    return torch.softmax(x, dim=axis)
def _gelu(x):
    return torch.nn.functional.gelu(x, approximate="tanh")
def _silu(x):
    return torch.nn.functional.silu(x)
def _sigmoid(x):
    return torch.sigmoid(x)
def _layernorm(x, axis=-1, eps=1e-5):
    m = x.mean(dim=axis, keepdim=True)
    v = x.var(dim=axis, keepdim=True, unbiased=False)
    return (x - m) / torch.sqrt(v + eps)
def _scatter_add(tgt, idx, src, axis=0):
    return tgt.clone().index_add_(axis, idx, src)
def _segment_sum(src, seg, n):
    out = torch.zeros((n,) + src.shape[1:], dtype=src.dtype)
    return out.index_add_(0, seg, src)
def _pad(x, pw):
    flat = tuple(v for pair in reversed(pw) for v in pair)
    return torch.nn.functional.pad(x, flat)

kernel_name = 'recurrent_scan__ssm_conv_s5__dense_activation_gelu__prompt'

def setup_inputs():

    _w = (lambda a: (lambda t: t.to(torch.bfloat16) if t.is_floating_point() else t)(torch.as_tensor(a)))
    def _A_setup():
        B, S, D = 1, 2048, 640
        P = D
        Lambda_re = -0.5 * (lambda _x: torch.exp(torch.as_tensor(_x)))((lambda *s: torch.randn(*s, dtype=torch.bfloat16) * 0.4)(P))
        Lambda_im = (lambda *s: torch.randn(*s, dtype=torch.bfloat16) * 0.4)(P) * 1.0
        B_re = (lambda *s: torch.randn(*s, dtype=torch.bfloat16) * 0.4)(P, D) * (D ** -0.5)
        B_im = (lambda *s: torch.randn(*s, dtype=torch.bfloat16) * 0.4)(P, D) * (D ** -0.5)
        C_re = (lambda *s: torch.randn(*s, dtype=torch.bfloat16) * 0.4)(D, P) * (P ** -0.5)
        C_im = (lambda *s: torch.randn(*s, dtype=torch.bfloat16) * 0.4)(D, P) * (P ** -0.5)
        log_dt = (lambda *s: torch.randn(*s, dtype=torch.bfloat16) * 0.4)(P) * 0.3 - 2.0
        Dskip = (lambda *s: torch.randn(*s, dtype=torch.bfloat16) * 0.2)(D)
        return {
            "x": _w((lambda *s: torch.randn(*s, dtype=torch.bfloat16) * 0.05)(B, S, D)),
            "Lambda_re": _w(Lambda_re),
            "Lambda_im": _w(Lambda_im),
            "B_re": _w(B_re),
            "B_im": _w(B_im),
            "C_re": _w(C_re),
            "C_im": _w(C_im),
            "log_dt": _w(log_dt),
            "Dskip": _w(Dskip),
        }
    _A_in = _A_setup()

    def _B_setup():
        B, S, D, F = 1, 2048, 640, 1728
        return {
            "x": _w((lambda *s: torch.randn(*s, dtype=torch.bfloat16) * 0.05)(B, S, D)),
            "w1": _w((lambda *s: torch.randn(*s, dtype=torch.bfloat16) * 0.8)(D, F) * (D ** -0.5)),
            "b1": _w((lambda *s: torch.randn(*s, dtype=torch.bfloat16) * 12.8)(F) * 0.01),
            "w2": _w((lambda *s: torch.randn(*s, dtype=torch.bfloat16) * 0.8)(F, D) * (F ** -0.5)),
            "b2": _w((lambda *s: torch.randn(*s, dtype=torch.bfloat16) * 12.8)(D) * 0.01),
        }
    _B_in = _B_setup()

    return {
        "A_x": _A_in["x"],
        "A_Lambda_re": _A_in["Lambda_re"],
        "A_Lambda_im": _A_in["Lambda_im"],
        "A_B_re": _A_in["B_re"],
        "A_B_im": _A_in["B_im"],
        "A_C_re": _A_in["C_re"],
        "A_C_im": _A_in["C_im"],
        "A_log_dt": _A_in["log_dt"],
        "A_Dskip": _A_in["Dskip"],
        "B_x": _B_in["x"],
        "B_w1": _B_in["w1"],
        "B_b1": _B_in["b1"],
        "B_w2": _B_in["w2"],
        "B_b2": _B_in["b2"],
    }

def reference(A_x, A_Lambda_re, A_Lambda_im, A_B_re, A_B_im, A_C_re, A_C_im, A_log_dt, A_Dskip, B_x, B_w1, B_b1, B_w2, B_b2):
    def _A_ref(x, Lambda_re, Lambda_im, B_re, B_im, C_re, C_im, log_dt, Dskip):
        Bsz, L, H = x.shape
        Lam = Lambda_re + 1j * Lambda_im
        Bmat = B_re + 1j * B_im
        Cmat = C_re + 1j * C_im
        dt = torch.exp(log_dt)
        Lam_bar = torch.exp(dt * Lam)
        B_bar = ((Lam_bar - 1.0) / Lam)[:, None] * Bmat
        Bu = torch.einsum("bld,pd->blp", x + 0j, B_bar)
        h = torch.zeros_like(Bu[:, 0, :])
        hs = []
        for t in range(L):
            h = Lam_bar[None, :] * h + Bu[:, t, :]
            hs.append(h)
        hseq = torch.stack(hs, 1)
        y = 2.0 * torch.einsum("blp,dp->bld", hseq, Cmat).real + x * Dskip[None, None, :]
        return y

    def _B_ref(x, w1, b1, w2, b2):
        h = torch.einsum("bsd,df->bsf", x, w1) + b1
        h = _gelu(h)
        return torch.einsum("bsf,fd->bsd", h, w2) + b2

    x = A_x
    xn = _layernorm(x, axis=-1)
    s = _A_ref(xn, A_Lambda_re, A_Lambda_im, A_B_re, A_B_im, A_C_re, A_C_im, A_log_dt, A_Dskip)
    g = _silu(_B_ref(xn, B_w1, B_b1, B_w2, B_b2))
    return x + s * g
```

```asm
; @launch grid=(256,1,1) block=(256,1,1) lds=163840
.amdgcn_target "amdgcn-amd-amdhsa--gfx950"
.text
.globl recurrent_scan__ssm_conv_s5__dense_activation_gelu__prompt_kernel
.p2align 12
.p2align 8
.type recurrent_scan__ssm_conv_s5__dense_activation_gelu__prompt_kernel,@function
recurrent_scan__ssm_conv_s5__dense_activation_gelu__prompt_kernel:
    s_load_dwordx16 s[4:19], s[0:1], 0
    s_load_dwordx8 s[24:31], s[0:1], 80
    s_cmp_ge_u32 s2, 256
    s_cbranch_scc1 L_exit
    v_lshrrev_b32 v4, 6, v0
    v_and_b32 v1, 63, v0
    v_readfirstlane_b32 s60, v4
    s_bfe_u32 s3, s2, 0x30003
    s_and_b32 s67, s2, 4
    s_lshl1_add_u32 s3, s67, s3
    s_lshr_b32 s67, s2, 6
    s_and_b32 s68, s2, 3
    s_lshl2_add_u32 s22, s67, s68
    s_mul_i32 s61, s3, 5
    s_lshr_b32 s61, s61, 3
    s_lshr_b32 s73, s60, 1
    s_and_b32 s74, s60, 1
    v_lshrrev_b32 v3, 4, v1
    v_lshrrev_b32 v12, 3, v1
    v_and_b32 v13, 7, v1
    s_lshl_b32 s67, s3, 7
    v_lshrrev_b32 v14, 5, v1
    s_lshl4_add_u32 s68, s3, s22
    s_lshl_b32 s68, s68, 3
    v_lshrrev_b32 v4, 5, v0
    v_add_u32 v4, s68, v4
    v_and_b32 v5, 31, v1
    v_mul_u32_u24 v4, 1280, v4
    v_lshl_add_u32 v6, v5, 4, v4
    v_lshl_add_u32 v7, v5, 3, v4
    s_lshl_b32 s68, s73, 6
    s_add_u32 s67, s67, s68
    s_lshl3_add_u32 s67, s74, s67
    v_and_b32 v18, 3, v12
    v_lshl_add_u32 v18, v14, 4, v18
    v_add_u32 v18, s67, v18
    v_mul_u32_u24 v18, 1280, v18
    v_xor_b32 v14, v13, v3
    v_lshl_add_u32 v18, v14, 4, v18
    v_xor_b32 v19, 64, v18
    v_add_u32 v20, 3072, v18
    v_add_u32 v21, 43008, v19
    v_add_u32 v19, 39936, v19
    s_lshl_b32 s64, s60, 12
    s_mul_i32 s65, s60, 6144
    s_add_u32 s65, s65, 49152
    s_sub_u32 s67, s22, 9
    s_mul_i32 s72, s67, 96
    s_min_u32 s72, s72, 544
    s_mul_i32 s67, s73, 48
    s_add_u32 s67, s67, s72
    s_mulk_i32 s67, 1280
    s_mul_i32 s68, s60, 55296
    s_mul_i32 s69, s22, 384
    s_add_u32 s68, s68, s69
    s_movk_i32 s69, 1280
    s_movk_i32 s70, 128
    v_lshlrev_b32 v14, 1, v3
    v_and_b32 v14, 2, v14
    s_cmp_ge_u32 s22, 9
    s_cselect_b32 s67, s67, s68
    s_cselect_b32 s69, s69, 3456
    s_cselect_b32 s71, s70, 221184
    s_cselect_b32 s70, 20480, s70
    s_cselect_b64 vcc, -1, 0
    s_addk_i32 s67, 2048
    v_cndmask_b32 v14, v14, v3, vcc
    v_xor_b32 v14, v13, v14
    v_mov_b32 v22, s67
    v_mad_u32_u24 v22, v12, s69, v22
    v_lshl_add_u32 v22, v14, 4, v22
    s_lshl_b32 s69, s69, 3
    v_xor_b32 v23, 64, v22
    v_add_u32 v23, s69, v23
    s_sub_u32 s67, s70, 2048
    v_add_u32 v24, s67, v22
    v_add_u32 v25, s70, v23
    s_add_u32 s67, s67, s70
    v_add_u32 v27, s67, v23
    s_addk_i32 s67, 1024
    v_add_u32 v26, s67, v22
    v_subrev_u32 v23, 1024, v23
    s_waitcnt lgkmcnt(0)
    s_mov_b32 s36, s4
    s_mov_b32 s37, s5
    s_mov_b32 s38, 2621440
    s_mov_b32 s39, 0x20000
    buffer_load_dwordx4 v[160:163], v6, s[36:39], 0 offen
    buffer_load_dwordx4 v[164:167], v6, s[36:39], 0 offen offset:512
    buffer_load_dwordx2 v[168:169], v7, s[36:39], 0 offen offset:1024
    s_add_u32 m0, s64, 0
    s_lshl_b32 s62, s61, 7
    buffer_load_dwordx4 v18, s[36:39], s62 offen offset:0 lds
    buffer_load_dwordx4 v19, s[36:39], s62 offen offset:1024 lds
    buffer_load_dwordx4 v20, s[36:39], s62 offen offset:2048 lds
    buffer_load_dwordx4 v21, s[36:39], s62 offen offset:3072 lds
    s_cmp_eq_u32 s74, 1
    s_cselect_b32 s48, s16, s14
    s_cselect_b32 s49, s17, s15
    s_cselect_b32 s40, s12, s10
    s_cselect_b32 s41, s13, s11
    s_mov_b32 s42, 821248
    s_cmp_ge_u32 s22, 9
    s_cselect_b32 s40, s40, s24
    s_cselect_b32 s41, s41, s25
    s_cselect_b32 s42, s42, 2213888
    s_cselect_b32 s48, s48, s28
    s_cselect_b32 s49, s49, s29
    s_mov_b32 s43, 0x20000
    s_sub_u32 s40, s40, 2048
    s_subb_u32 s41, s41, 0
    s_add_u32 m0, s65, 0
    s_mul_i32 s63, s61, s71
    buffer_load_dwordx4 v22, s[40:43], s63 offen offset:0 lds
    buffer_load_dwordx4 v23, s[40:43], s63 offen offset:1024 lds
    s_getpc_b64 s[92:93]
L_pc:
    s_lshr_b32 s67, s2, 3
    s_lshl2_add_u32 s67, s67, s60
    s_mulk_i32 s67, 448
    s_add_u32 s67, s67, L_F_start-L_pc
    s_add_u32 s92, s92, s67
    s_addc_u32 s93, s93, 0
    s_load_dword s94, s[92:93], 0
    s_load_dword s95, s[92:93], 64
    s_load_dword s96, s[92:93], 128
    s_load_dword s97, s[92:93], 192
    s_load_dword s98, s[92:93], 256
    s_load_dword s99, s[92:93], 320
    s_load_dword s100, s[92:93], 384
    buffer_load_dwordx4 v24, s[40:43], s63 offen offset:2048 lds
    s_add_u32 m0, s65, 3072
    s_add_u32 s61, s61, 1
    buffer_load_dwordx4 v25, s[40:43], s63 offen offset:0 lds
    buffer_load_dwordx4 v26, s[40:43], s63 offen offset:1024 lds
    s_cmp_eq_u32 s61, 10
    s_cselect_b32 s61, 0, s61
    buffer_load_dwordx4 v27, s[40:43], s63 offen offset:2048 lds
    s_lshl4_add_u32 s23, s22, s3
    s_lshr_b32 s67, s23, 3
    s_and_b32 s68, s23, 7
    s_sub_u32 s50, s42, 2048
    s_mov_b32 s51, 0x20000
    s_cbranch_vccnz L_relS
    s_lshl2_add_u32 s67, s67, s60
    s_mulk_i32 s67, 192
    s_add_u32 s67, s67, s68
    s_mul_i32 s5, s67, 160
    s_mul_i32 s24, s60, 3840
    s_movk_i32 s69, 7680
    s_movk_i32 s70, 960
    v_mul_u32_u24 v12, 26, v1
    v_lshrrev_b32 v12, 8, v12
    v_mul_u32_u24 v13, 10, v12
    v_sub_u32 v13, v1, v13
    s_bfm_b64 exec, 60, 0
    s_branch L_relJ
L_relS:
    s_lshl1_add_u32 s68, s68, s73
    s_mulk_i32 s68, 400
    s_add_u32 s68, s68, s67
    s_sub_u32 s68, s68, 18
    s_lshl_b32 s5, s68, 7
    s_cmp_ge_u32 s67, 28
    s_cselect_b32 s5, 1879048192, s5
    s_lshl1_add_u32 s24, s74, s73
    s_mulk_i32 s24, 5280
    s_movk_i32 s69, 10240
    s_movk_i32 s70, 1056
    v_lshrrev_b32 v14, 5, v1
    v_xor_b32 v13, v13, v14
L_relJ:
    s_add_u32 m0, s24, 122880
    v_mul_u32_u24 v12, 1280, v12
    v_lshl_add_u32 v12, v13, 4, v12
    buffer_load_dwordx4 v12, s[48:51], s5 offen lds
    s_add_u32 m0, m0, s70
    s_add_u32 s5, s5, s69
    buffer_load_dwordx4 v12, s[48:51], s5 offen lds
    s_add_u32 m0, m0, s70
    s_add_u32 s5, s5, s69
    buffer_load_dwordx4 v12, s[48:51], s5 offen lds
    s_add_u32 m0, m0, s70
    s_add_u32 s5, s5, s69
    buffer_load_dwordx4 v12, s[48:51], s5 offen lds
    s_cbranch_vccnz L_S_start
    s_branch L_F_start
L_exit:
    s_endpgm
L_G_start:
    s_lshl_b32 s68, s78, 11
    s_add_u32 s68, s68, 65536
    v_max_u32 v27, 9, v2
    v_lshl_add_u32 v27, v27, 7, s68
    s_add_u32 s5, s5, 65536
    s_waitcnt vmcnt(0)
    s_barrier
    buffer_store_dword v16, v26, s[44:47], s5 offen sc1
    s_sub_u32 s5, s5, 65536
    s_branch L_Y_join
    .p2align 12
L_F_start:
    s_load_dwordx2 s[20:21], s[0:1], 64
    s_load_dwordx2 s[32:33], s[0:1], 112
    s_load_dwordx2 s[34:35], s[0:1], 128
    s_mov_b64 exec, -1
    v_and_b32 v2, 15, v0
    s_waitcnt lgkmcnt(0)
    s_mov_b32 s44, s34
    s_mov_b32 s45, s35
    s_mov_b32 s46, 23068672
    s_mov_b32 s47, 0x20000
    s_and_b32 s79, s2, 1
    s_bfe_u32 s76, s2, 0x20005
    s_lshl2_add_u32 s79, s79, s76
    s_mul_i32 s67, s22, 384
    s_lshl_b32 s68, s60, 8
    s_add_u32 s67, s67, s68
    s_mul_i32 s69, s79, 160
    s_cmp_eq_u32 s60, 2
    s_cselect_b32 s52, s30, s20
    s_cselect_b32 s53, s31, s21
    s_movk_i32 s54, 1280
    s_mov_b32 s55, 0x20000
    s_mov_b32 s70, 162816
    s_cmp_lt_u32 s60, 2
    s_cselect_b32 s52, s26, s52
    s_cselect_b32 s53, s27, s53
    s_cselect_b32 s54, 3456, s54
    s_cselect_b32 s69, s67, s69
    s_cselect_b32 s70, 143360, s70
    s_add_u32 s70, s70, s68
    s_mov_b32 m0, s70
    v_lshlrev_b32 v14, 2, v1
    buffer_load_dword v14, s[52:55], s69 offen lds
    s_mov_b32 s56, s32
    s_mov_b32 s57, s33
    s_mov_b32 s58, 5242880
    s_mov_b32 s59, 0x20000
    v_lshlrev_b32 v14, 21, v1
    buffer_load_dword a255, v14, s[56:59], 0 offen
    s_lshr_b32 s67, s2, 3
    s_lshl2_add_u32 s67, s67, s60
    s_lshl_b32 s67, s67, 10
    s_add_u32 s67, s67, 29696
    v_lshl_add_u32 v12, v1, 7, s67
    v_lshrrev_b32 v13, 3, v1
    v_cmp_eq_u32 vcc, 2, v13
    s_nop 1
    v_cndmask_b32 v14, v14, v12, vcc
    buffer_load_dword a255, v14, s[44:47], 0 offen offset:1024 sc1
    s_mov_b64 exec, 0
    s_cmp_eq_u32 s60, 0
    s_cbranch_scc1 L_FA_pad0
    s_cmp_eq_u32 s60, 1
    s_cbranch_scc1 L_FA_pad1
    s_cmp_eq_u32 s60, 2
    s_cbranch_scc1 L_FA_pad2
    s_branch L_FA_pad3
L_FA_ret:
    s_mov_b64 exec, -1
    s_load_dword s66, s[34:35], 0
    s_add_u32 m0, s64, 16384
    s_lshl_b32 s62, s61, 7
    buffer_load_dwordx4 v18, s[36:39], s62 offen offset:0 lds
    v_lshlrev_b32 v15, 4, v1
    s_lshl_b32 s67, s73, 13
    v_lshrrev_b32 v12, 1, v2
    v_xor_b32 v12, v3, v12
    v_lshlrev_b32 v13, 7, v2
    v_lshl_add_u32 v13, v12, 4, v13
    v_add_u32 v28, s67, v13
    v_xor_b32_e64 v29, 64, v28
    v_mov_b32 v12, 0x3f803f80
    v_accvgpr_write_b32 a240, v12
    v_accvgpr_write_b32 a241, v12
    v_accvgpr_write_b32 a242, v12
    v_accvgpr_write_b32 a243, v12
    v_bfe_u32 v12, v1, 2, 2
    v_lshrrev_b32 v13, 1, v3
    v_mul_u32_u24 v13, 6144, v13
    buffer_load_dwordx4 v19, s[36:39], s62 offen offset:1024 lds
    v_lshl_add_u32 v13, v12, 7, v13
    v_and_b32 v14, 3, v1
    v_lshl_add_u32 v13, v14, 3, v13
    v_and_b32 v14, 1, v3
    v_mul_u32_u24 v14, 1088, v14
    v_and_b32 v12, 2, v12
    v_lshl_add_u32 v13, v12, 4, v13
    v_add_u32 v13, v13, v14
    s_lshl_b32 s67, s74, 6
    s_lshl_b32 s68, s74, 11
    s_add_u32 s69, s68, 49152
    v_xor_b32 v13, s67, v13
    v_add_u32 v30, s69, v13
    v_xor_b32 v31, 32, v30
    v_xor_b32 v32, 64, v30
    v_add_u32 v32, s68, v32
    v_xor_b32 v33, 32, v32
    buffer_load_dwordx4 v20, s[36:39], s62 offen offset:2048 lds
    s_waitcnt vmcnt(22)
    v_lshlrev_b32 v172, 16, v160
    v_and_b32 v173, 0xffff0000, v160
    v_lshlrev_b32 v174, 16, v161
    v_and_b32 v175, 0xffff0000, v161
    v_lshlrev_b32 v176, 16, v162
    v_and_b32 v177, 0xffff0000, v162
    v_lshlrev_b32 v178, 16, v163
    v_and_b32 v179, 0xffff0000, v163
    s_waitcnt vmcnt(21)
    v_lshlrev_b32 v180, 16, v164
    v_and_b32 v181, 0xffff0000, v164
    v_lshlrev_b32 v182, 16, v165
    v_and_b32 v183, 0xffff0000, v165
    v_lshlrev_b32 v184, 16, v166
    v_and_b32 v185, 0xffff0000, v166
    v_lshlrev_b32 v186, 16, v167
    v_and_b32 v187, 0xffff0000, v167
    s_waitcnt vmcnt(20)
    v_lshlrev_b32 v188, 16, v168
    buffer_load_dwordx4 v21, s[36:39], s62 offen offset:3072 lds
    v_and_b32 v189, 0xffff0000, v168
    v_lshlrev_b32 v190, 16, v169
    v_and_b32 v191, 0xffff0000, v169
    v_pk_add_f32 v[160:161], v[172:173], v[174:175]
    v_pk_add_f32 v[160:161], v[160:161], v[176:177]
    v_pk_add_f32 v[160:161], v[160:161], v[178:179]
    v_pk_add_f32 v[160:161], v[160:161], v[180:181]
    v_pk_add_f32 v[160:161], v[160:161], v[182:183]
    v_pk_add_f32 v[160:161], v[160:161], v[184:185]
    v_pk_add_f32 v[160:161], v[160:161], v[186:187]
    v_pk_add_f32 v[160:161], v[160:161], v[188:189]
    v_pk_add_f32 v[160:161], v[160:161], v[190:191]
    v_add_f32 v162, v160, v161
    s_nop 1
    v_add_f32_dpp v162, v162, v162 row_ror:8 row_mask:0xf bank_mask:0xf
    s_nop 1
    v_add_f32_dpp v162, v162, v162 row_ror:4 row_mask:0xf bank_mask:0xf
    s_nop 1
    v_add_f32_dpp v162, v162, v162 row_ror:2 row_mask:0xf bank_mask:0xf
    s_add_u32 m0, s65, 24576
    s_mul_i32 s63, s61, s71
    buffer_load_dwordx4 v22, s[40:43], s63 offen offset:0 lds
    v_add_f32_dpp v162, v162, v162 row_ror:1 row_mask:0xf bank_mask:0xf
    v_mov_b32 v163, v162
    s_nop 1
    v_permlane16_swap_b32 v162, v163
    v_add_f32_e64 v162, v162, v163
    v_mul_f32 v162, 0x3acccccd, v162
    v_pk_add_f32 v[172:173], v[172:173], v[162:163] op_sel_hi:[1,0] neg_lo:[0,1] neg_hi:[0,1]
    v_pk_add_f32 v[174:175], v[174:175], v[162:163] op_sel_hi:[1,0] neg_lo:[0,1] neg_hi:[0,1]
    v_pk_add_f32 v[176:177], v[176:177], v[162:163] op_sel_hi:[1,0] neg_lo:[0,1] neg_hi:[0,1]
    v_pk_add_f32 v[178:179], v[178:179], v[162:163] op_sel_hi:[1,0] neg_lo:[0,1] neg_hi:[0,1]
    v_pk_add_f32 v[180:181], v[180:181], v[162:163] op_sel_hi:[1,0] neg_lo:[0,1] neg_hi:[0,1]
    v_pk_add_f32 v[182:183], v[182:183], v[162:163] op_sel_hi:[1,0] neg_lo:[0,1] neg_hi:[0,1]
    v_pk_add_f32 v[184:185], v[184:185], v[162:163] op_sel_hi:[1,0] neg_lo:[0,1] neg_hi:[0,1]
    v_pk_add_f32 v[186:187], v[186:187], v[162:163] op_sel_hi:[1,0] neg_lo:[0,1] neg_hi:[0,1]
    v_pk_add_f32 v[188:189], v[188:189], v[162:163] op_sel_hi:[1,0] neg_lo:[0,1] neg_hi:[0,1]
    v_pk_add_f32 v[190:191], v[190:191], v[162:163] op_sel_hi:[1,0] neg_lo:[0,1] neg_hi:[0,1]
    v_pk_mul_f32 v[160:161], v[172:173], v[172:173]
    v_pk_fma_f32 v[160:161], v[174:175], v[174:175], v[160:161]
    buffer_load_dwordx4 v23, s[40:43], s63 offen offset:1024 lds
    v_pk_fma_f32 v[160:161], v[176:177], v[176:177], v[160:161]
    v_pk_fma_f32 v[160:161], v[178:179], v[178:179], v[160:161]
    v_pk_fma_f32 v[160:161], v[180:181], v[180:181], v[160:161]
    v_pk_fma_f32 v[160:161], v[182:183], v[182:183], v[160:161]
    v_pk_fma_f32 v[160:161], v[184:185], v[184:185], v[160:161]
    v_pk_fma_f32 v[160:161], v[186:187], v[186:187], v[160:161]
    v_pk_fma_f32 v[160:161], v[188:189], v[188:189], v[160:161]
    v_pk_fma_f32 v[160:161], v[190:191], v[190:191], v[160:161]
    v_add_f32 v164, v160, v161
    s_nop 1
    v_add_f32_dpp v164, v164, v164 row_ror:8 row_mask:0xf bank_mask:0xf
    s_nop 1
    v_add_f32_dpp v164, v164, v164 row_ror:4 row_mask:0xf bank_mask:0xf
    s_nop 1
    v_add_f32_dpp v164, v164, v164 row_ror:2 row_mask:0xf bank_mask:0xf
    s_nop 1
    v_add_f32_dpp v164, v164, v164 row_ror:1 row_mask:0xf bank_mask:0xf
    v_mov_b32 v165, v164
    s_nop 1
    v_permlane16_swap_b32 v164, v165
    v_add_f32 v164, v164, v165
    v_mul_f32 v164, 0x3acccccd, v164
    buffer_load_dwordx4 v24, s[40:43], s63 offen offset:2048 lds
    v_cvt_pk_bf16_f32 v164, v164, v164
    v_lshlrev_b32 v164, 16, v164
    v_cvt_pk_bf16_f32 v162, v162, v162
    v_lshlrev_b32 v162, 16, v162
    v_add_f32 v164, 0x3727c5ac, v164
    v_cvt_pk_bf16_f32 v164, v164, v164
    v_lshlrev_b32 v164, 16, v164
    v_sqrt_f32 v164, v164
    v_lshrrev_b32 v172, 5, v0
    v_cvt_pk_bf16_f32 v164, v164, v164
    v_lshlrev_b32 v164, 16, v164
    v_rcp_f32 v164, v164
    v_lshlrev_b32 v172, 3, v172
    v_mul_f32 v165, v162, v164
    v_add_u32 v172, 162816, v172
    ds_write_b64 v172, v[164:165]
    s_waitcnt vmcnt(14) lgkmcnt(0)
    s_barrier
    ds_read_b64_tr_b16 v[96:97], v30 offset:0
    ds_read_b64_tr_b16 v[98:99], v30 offset:512
    ds_read_b128 v[80:83], v28 offset:0
    ds_read_b128 v[84:87], v28 offset:2048
    ds_read_b128 v[88:91], v28 offset:4096
    ds_read_b128 v[92:95], v28 offset:6144
    ds_read_b64_tr_b16 v[100:101], v31 offset:0
    ds_read_b64_tr_b16 v[102:103], v31 offset:512
    ds_read_b64_tr_b16 v[104:105], v32 offset:0
    ds_read_b64_tr_b16 v[106:107], v32 offset:512
    ds_read_b64_tr_b16 v[108:109], v33 offset:0
    ds_read_b64_tr_b16 v[110:111], v33 offset:512
    ds_read_b64_tr_b16 v[112:113], v30 offset:2048
    ds_read_b64_tr_b16 v[114:115], v30 offset:2560
    ds_read_b64_tr_b16 v[116:117], v31 offset:2048
    ds_read_b64_tr_b16 v[118:119], v31 offset:2560
    s_waitcnt lgkmcnt(13)
    v_mfma_f32_16x16x32_bf16 v[160:163], v[96:99], v[80:83], 0
    ds_read_b64_tr_b16 v[136:137], v30 offset:12288
    s_mul_i32 s66, s66, 1664525
    s_waitcnt lgkmcnt(13)
    v_mfma_f32_16x16x32_bf16 v[184:187], v[96:99], v[84:87], 0
    ds_read_b64_tr_b16 v[138:139], v30 offset:12800
    s_add_u32 m0, s65, 27648
    s_waitcnt lgkmcnt(13)
    v_mfma_f32_16x16x32_bf16 v[208:211], v[96:99], v[88:91], 0
    ds_read_b128 v[120:123], v29 offset:0
    s_add_u32 s61, s61, 1
    s_waitcnt lgkmcnt(13)
    v_mfma_f32_16x16x32_bf16 v[232:235], v[96:99], v[92:95], 0
    buffer_load_dwordx4 v25, s[40:43], s63 offen offset:0 lds
    v_mfma_f32_16x16x32_bf16 a[0:3], a[240:243], v[96:99], 0
    ds_read_b128 v[124:127], v29 offset:2048
    s_add_u32 s66, s66, 1013904223
    s_waitcnt lgkmcnt(12)
    v_mfma_f32_16x16x32_bf16 v[236:239], v[100:103], v[92:95], 0
    ds_read_b128 v[128:131], v29 offset:4096
    s_mul_i32 s75, s3, 5
    v_mfma_f32_16x16x32_bf16 a[4:7], a[240:243], v[100:103], 0
    s_lshr_b32 s75, s75, 3
    s_lshl4_add_u32 s75, s22, s75
    s_lshl1_add_u32 s75, s75, s74
    v_mfma_f32_16x16x32_bf16 v[212:215], v[100:103], v[88:91], 0
    buffer_load_dwordx4 v26, s[40:43], s63 offen offset:1024 lds
    v_mfma_f32_16x16x32_bf16 v[188:191], v[100:103], v[84:87], 0
    ds_read_b128 v[132:135], v29 offset:6144
    s_mul_i32 s75, s75, 384
    v_mfma_f32_16x16x32_bf16 v[164:167], v[100:103], v[80:83], 0
    ds_read_b64_tr_b16 v[140:141], v31 offset:12288
    s_add_u32 s75, s75, 163840
    s_waitcnt lgkmcnt(13)
    v_mfma_f32_16x16x32_bf16 v[168:171], v[104:107], v[80:83], 0
    ds_read_b64_tr_b16 v[142:143], v31 offset:12800
    v_mov_b32 v12, 0x3f803f80
    v_mfma_f32_16x16x32_bf16 v[192:195], v[104:107], v[84:87], 0
    s_cmp_eq_u32 s61, 10
    s_cselect_b32 s61, 0, s61
    v_accvgpr_write_b32 a244, v12
    v_mfma_f32_16x16x32_bf16 v[216:219], v[104:107], v[88:91], 0
    buffer_load_dwordx4 v27, s[40:43], s63 offen offset:2048 lds
    v_mfma_f32_16x16x32_bf16 v[240:243], v[104:107], v[92:95], 0
    ds_read_b64_tr_b16 v[144:145], v32 offset:12288
    s_add_u32 m0, s64, 32768
    v_mfma_f32_16x16x32_bf16 a[8:11], a[240:243], v[104:107], 0
    ds_read_b64_tr_b16 v[146:147], v32 offset:12800
    s_lshl_b32 s62, s61, 7
    s_waitcnt lgkmcnt(14)
    v_mfma_f32_16x16x32_bf16 v[244:247], v[108:111], v[92:95], 0
    ds_read_b64_tr_b16 v[148:149], v33 offset:12288
    v_accvgpr_write_b32 a245, 0
    v_mfma_f32_16x16x32_bf16 a[12:15], a[240:243], v[108:111], 0
    buffer_load_dwordx4 v18, s[36:39], s62 offen offset:0 lds
    v_mfma_f32_16x16x32_bf16 v[220:223], v[108:111], v[88:91], 0
    ds_read_b64_tr_b16 v[150:151], v33 offset:12800
    v_accvgpr_write_b32 a246, 0
    v_mfma_f32_16x16x32_bf16 v[196:199], v[108:111], v[84:87], 0
    ds_read_b64_tr_b16 v[152:153], v30 offset:14336
    v_accvgpr_write_b32 a247, v12
    v_mfma_f32_16x16x32_bf16 v[172:175], v[108:111], v[80:83], 0
    s_bitcmp1_b32 0xb5b5, s3
    s_cselect_b32 s75, s75, 1879048192
    s_lshr_b32 s67, s23, 3
    s_waitcnt lgkmcnt(15)
    v_mfma_f32_16x16x32_bf16 v[176:179], v[112:115], v[80:83], 0
    ds_read_b64_tr_b16 v[154:155], v30 offset:14848
    s_and_b32 s68, s23, 7
    v_mfma_f32_16x16x32_bf16 v[200:203], v[112:115], v[84:87], 0
    buffer_load_dwordx4 v19, s[36:39], s62 offen offset:1024 lds
    v_mfma_f32_16x16x32_bf16 v[224:227], v[112:115], v[88:91], 0
    ds_read_b64_tr_b16 v[156:157], v31 offset:14336
    s_mul_i32 s4, s60, 18
    v_mfma_f32_16x16x32_bf16 v[248:251], v[112:115], v[92:95], 0
    ds_read_b64_tr_b16 v[158:159], v31 offset:14848
    s_add_u32 s4, s4, s67
    v_mfma_f32_16x16x32_bf16 a[16:19], a[240:243], v[112:115], 0
    s_cmp_ge_u32 s60, 2
    s_cselect_b32 s75, 1879048192, s75
    s_mul_i32 s68, s68, 96
    s_waitcnt lgkmcnt(15)
    v_mfma_f32_16x16x32_bf16 v[252:255], v[116:119], v[92:95], 0
    s_add_u32 s4, s4, s68
    s_mul_i32 s4, s4, 5120
    s_add_u32 s67, s60, 1
    v_mfma_f32_16x16x32_bf16 a[20:23], a[240:243], v[116:119], 0
    buffer_load_dwordx4 v20, s[36:39], s62 offen offset:2048 lds
    v_mfma_f32_16x16x32_bf16 v[228:231], v[116:119], v[88:91], 0
    s_lshr_b32 s67, s67, 2
    s_mul_i32 s67, s67, 1879048192
    v_lshlrev_b32 v50, 26, v3
    v_mfma_f32_16x16x32_bf16 v[204:207], v[116:119], v[84:87], 0
    v_lshl_add_u32 v50, v2, 4, v50
    v_lshrrev_b32 v51, 1, v50
    v_mfma_f32_16x16x32_bf16 v[180:183], v[116:119], v[80:83], 0
    s_waitcnt lgkmcnt(0)
    v_mfma_f32_16x16x32_bf16 v[160:163], v[136:139], v[120:123], v[160:163]
    s_add_u32 s4, s4, s67
    s_add_u32 s4, s4, 1048576
    s_mov_b32 s6, 0x05040100
    v_mfma_f32_16x16x32_bf16 v[184:187], v[136:139], v[124:127], v[184:187]
    s_mov_b32 s7, 0x07060302
    s_mul_i32 s67, s60, 5120
    s_add_u32 s67, s67, 122880
    v_mfma_f32_16x16x32_bf16 v[208:211], v[136:139], v[128:131], v[208:211]
    buffer_load_dwordx4 v21, s[36:39], s62 offen offset:3072 lds
    v_mfma_f32_16x16x32_bf16 v[232:235], v[136:139], v[132:135], v[232:235]
    s_add_u32 m0, s65, 49152
    s_mul_i32 s63, s61, s71
    v_mul_u32_u24 v5, 640, v3
    v_mfma_f32_16x16x32_bf16 a[0:3], a[240:243], v[136:139], a[0:3]
    v_lshl_add_u32 v5, v2, 3, v5
    v_add_u32 v5, s67, v5
    v_mfma_f32_16x16x32_bf16 v[236:239], v[140:143], v[132:135], v[236:239]
    v_add_u32 v6, 2560, v5
    v_lshrrev_b32 v4, 2, v1
    v_mfma_f32_16x16x32_bf16 a[4:7], a[240:243], v[140:143], a[4:7]
    buffer_load_dwordx4 v22, s[40:43], s63 offen offset:0 lds
    v_mfma_f32_16x16x32_bf16 v[212:215], v[140:143], v[128:131], v[212:215]
    v_mul_u32_u24 v4, 160, v4
    v_and_b32 v14, 3, v1
    v_mfma_f32_16x16x32_bf16 v[188:191], v[140:143], v[124:127], v[188:191]
    v_lshl_add_u32 v4, v14, 3, v4
    v_add_u32 v4, s67, v4
    v_mfma_f32_16x16x32_bf16 v[164:167], v[140:143], v[120:123], v[164:167]
    s_bfe_u32 s78, s2, 0x20001
    s_bfe_u32 s67, s2, 0x20003
    s_lshl2_add_u32 s78, s78, s67
    v_mfma_f32_16x16x32_bf16 v[168:171], v[144:147], v[120:123], v[168:171]
    buffer_load_dwordx4 v23, s[40:43], s63 offen offset:1024 lds
    v_mfma_f32_16x16x32_bf16 v[192:195], v[144:147], v[124:127], v[192:195]
    s_lshr_b32 s67, s2, 7
    s_mul_i32 s68, s67, 56
    s_add_u32 s68, s68, s60
    v_mfma_f32_16x16x32_bf16 v[216:219], v[144:147], v[128:131], v[216:219]
    v_mfma_f32_16x16x32_bf16 v[240:243], v[144:147], v[132:135], v[240:243]
    v_mfma_f32_16x16x32_bf16 a[8:11], a[240:243], v[144:147], a[8:11]
    buffer_load_dwordx4 v24, s[40:43], s63 offen offset:2048 lds
    v_mfma_f32_16x16x32_bf16 v[244:247], v[148:151], v[132:135], v[244:247]
    s_add_u32 m0, s65, 52224
    s_add_u32 s61, s61, 1
    v_mfma_f32_16x16x32_bf16 a[12:15], a[240:243], v[148:151], a[12:15]
    v_mfma_f32_16x16x32_bf16 v[220:223], v[148:151], v[128:131], v[220:223]
    v_mfma_f32_16x16x32_bf16 v[196:199], v[148:151], v[124:127], v[196:199]
    buffer_load_dwordx4 v25, s[40:43], s63 offen offset:0 lds
    v_mfma_f32_16x16x32_bf16 v[172:175], v[148:151], v[120:123], v[172:175]
    v_mfma_f32_16x16x32_bf16 v[176:179], v[152:155], v[120:123], v[176:179]
    v_mfma_f32_16x16x32_bf16 v[200:203], v[152:155], v[124:127], v[200:203]
    v_mfma_f32_16x16x32_bf16 v[224:227], v[152:155], v[128:131], v[224:227]
    buffer_load_dwordx4 v26, s[40:43], s63 offen offset:1024 lds
    v_mfma_f32_16x16x32_bf16 v[248:251], v[152:155], v[132:135], v[248:251]
    s_cmp_eq_u32 s61, 10
    s_cselect_b32 s61, 0, s61
    v_mfma_f32_16x16x32_bf16 a[16:19], a[240:243], v[152:155], a[16:19]
    v_mfma_f32_16x16x32_bf16 v[252:255], v[156:159], v[132:135], v[252:255]
    v_mfma_f32_16x16x32_bf16 a[20:23], a[240:243], v[156:159], a[20:23]
    buffer_load_dwordx4 v27, s[40:43], s63 offen offset:2048 lds
    v_mfma_f32_16x16x32_bf16 v[228:231], v[156:159], v[128:131], v[228:231]
    v_mfma_f32_16x16x32_bf16 v[204:207], v[156:159], v[124:127], v[204:207]
    v_mfma_f32_16x16x32_bf16 v[180:183], v[156:159], v[120:123], v[180:183]
    s_waitcnt vmcnt(10)
    s_barrier
    s_nop 0
    ds_read_b64_tr_b16 v[96:97], v30 offset:24576
    ds_read_b64_tr_b16 v[98:99], v30 offset:25088
    ds_read_b128 v[80:83], v28 offset:16384
    ds_read_b128 v[84:87], v28 offset:18432
    ds_read_b128 v[88:91], v28 offset:20480
    ds_read_b128 v[92:95], v28 offset:22528
    ds_read_b64_tr_b16 v[100:101], v31 offset:24576
    ds_read_b64_tr_b16 v[102:103], v31 offset:25088
    ds_read_b64_tr_b16 v[104:105], v32 offset:24576
    ds_read_b64_tr_b16 v[106:107], v32 offset:25088
    ds_read_b64_tr_b16 v[108:109], v33 offset:24576
    ds_read_b64_tr_b16 v[110:111], v33 offset:25088
    ds_read_b64_tr_b16 v[112:113], v30 offset:26624
    ds_read_b64_tr_b16 v[114:115], v30 offset:27136
    ds_read_b64_tr_b16 v[116:117], v31 offset:26624
    ds_read_b64_tr_b16 v[118:119], v31 offset:27136
    s_waitcnt lgkmcnt(13)
    v_mfma_f32_16x16x32_bf16 v[160:163], v[96:99], v[80:83], v[160:163]
    ds_read2_b64 v[34:37], v5 offset0:0 offset1:20
    s_mul_i32 s76, s79, 96
    s_waitcnt lgkmcnt(13)
    v_mfma_f32_16x16x32_bf16 v[184:187], v[96:99], v[84:87], v[184:187]
    ds_read_b64_tr_b16 v[136:137], v30 offset:36864
    ds_read_b64_tr_b16 v[138:139], v30 offset:37376
    s_waitcnt lgkmcnt(14)
    v_mfma_f32_16x16x32_bf16 v[208:211], v[96:99], v[88:91], v[208:211]
    ds_read_b128 v[120:123], v29 offset:16384
    ds_read_b128 v[124:127], v29 offset:18432
    s_waitcnt lgkmcnt(15)
    v_mfma_f32_16x16x32_bf16 v[232:235], v[96:99], v[92:95], v[232:235]
    s_add_u32 m0, s64, 0
    s_lshl_b32 s62, s61, 7
    s_add_u32 s76, s76, s68
    s_waitcnt lgkmcnt(13)
    v_mfma_f32_16x16x32_bf16 v[236:239], v[100:103], v[92:95], v[236:239]
    buffer_load_dwordx4 v18, s[36:39], s62 offen offset:0 lds
    v_mfma_f32_16x16x32_bf16 v[212:215], v[100:103], v[88:91], v[212:215]
    ds_read2_b64 v[38:41], v5 offset0:40 offset1:60
    s_mul_i32 s76, s76, 5120
    v_mfma_f32_16x16x32_bf16 v[188:191], v[100:103], v[84:87], v[188:191]
    buffer_load_dwordx4 v19, s[36:39], s62 offen offset:1024 lds
    v_mfma_f32_16x16x32_bf16 v[164:167], v[100:103], v[80:83], v[164:167]
    buffer_load_dwordx4 v20, s[36:39], s62 offen offset:2048 lds
    s_waitcnt lgkmcnt(12)
    v_mfma_f32_16x16x32_bf16 v[168:171], v[104:107], v[80:83], v[168:171]
    ds_read2_b64 v[42:45], v6 offset0:0 offset1:20
    s_add_u32 s76, s76, 1048576
    v_mfma_f32_16x16x32_bf16 v[192:195], v[104:107], v[84:87], v[192:195]
    buffer_load_dwordx4 v21, s[36:39], s62 offen offset:3072 lds
    v_mfma_f32_16x16x32_bf16 v[216:219], v[104:107], v[88:91], v[216:219]
    ds_read_b128 v[128:131], v29 offset:20480
    ds_read_b128 v[132:135], v29 offset:22528
    v_mfma_f32_16x16x32_bf16 v[240:243], v[104:107], v[92:95], v[240:243]
    ds_read2_b64 v[46:49], v6 offset0:40 offset1:60
    s_add_u32 m0, s65, 0
    s_waitcnt lgkmcnt(14)
    v_mfma_f32_16x16x32_bf16 v[244:247], v[108:111], v[92:95], v[244:247]
    ds_read_b64_tr_b16 v[140:141], v31 offset:36864
    ds_read_b64_tr_b16 v[142:143], v31 offset:37376
    v_mfma_f32_16x16x32_bf16 v[220:223], v[108:111], v[88:91], v[220:223]
    ds_read_b64_tr_b16 v[144:145], v32 offset:36864
    ds_read_b64_tr_b16 v[146:147], v32 offset:37376
    v_mfma_f32_16x16x32_bf16 v[196:199], v[108:111], v[84:87], v[196:199]
    ds_read_b64_tr_b16 v[72:73], v4 offset:128
    s_mul_i32 s63, s61, s71
    v_mfma_f32_16x16x32_bf16 v[172:175], v[108:111], v[80:83], v[172:175]
    buffer_load_dwordx4 v22, s[40:43], s63 offen offset:0 lds
    s_waitcnt lgkmcnt(15)
    v_mfma_f32_16x16x32_bf16 v[176:179], v[112:115], v[80:83], v[176:179]
    buffer_load_dwordx4 v23, s[40:43], s63 offen offset:1024 lds
    v_mfma_f32_16x16x32_bf16 v[200:203], v[112:115], v[84:87], v[200:203]
    ds_read_b64_tr_b16 v[148:149], v33 offset:36864
    ds_read_b64_tr_b16 v[150:151], v33 offset:37376
    v_mfma_f32_16x16x32_bf16 v[224:227], v[112:115], v[88:91], v[224:227]
    ds_read_b64_tr_b16 v[152:153], v30 offset:38912
    ds_read_b64_tr_b16 v[154:155], v30 offset:39424
    v_mfma_f32_16x16x32_bf16 v[248:251], v[112:115], v[92:95], v[248:251]
    ds_read_b64_tr_b16 v[156:157], v31 offset:38912
    ds_read_b64_tr_b16 v[158:159], v31 offset:39424
    v_mfma_f32_16x16x32_bf16 v[252:255], v[116:119], v[92:95], v[252:255]
    buffer_load_dwordx4 v24, s[40:43], s63 offen offset:2048 lds
    v_mfma_f32_16x16x32_bf16 v[228:231], v[116:119], v[88:91], v[228:231]
    ds_read_b64_tr_b16 v[74:75], v4 offset:2688
    s_add_u32 m0, s65, 3072
    v_mfma_f32_16x16x32_bf16 v[204:207], v[116:119], v[84:87], v[204:207]
    s_add_u32 s61, s61, 1
    s_mul_i32 s77, s78, 192
    s_add_u32 s77, s77, s68
    v_mfma_f32_16x16x32_bf16 v[180:183], v[116:119], v[80:83], v[180:183]
    buffer_load_dwordx4 v25, s[40:43], s63 offen offset:0 lds
    buffer_load_dwordx4 v26, s[40:43], s63 offen offset:1024 lds
    s_cmp_eq_u32 s61, 10
    s_cselect_b32 s61, 0, s61
    buffer_load_dwordx4 v27, s[40:43], s63 offen offset:2048 lds
    v_accvgpr_read_b32 v76, a0
    v_accvgpr_read_b32 v77, a4
    v_accvgpr_read_b32 v78, a8
    v_accvgpr_read_b32 v79, a12
    v_accvgpr_read_b32 v52, a16
    v_accvgpr_read_b32 v53, a20
    s_bitcmp1_b32 s75, 30
    s_cbranch_scc1 L_Fopt1
    buffer_store_dwordx4 v[76:79], v50, s[44:47], s75 offen sc1
L_Fopt1:
    s_bitcmp1_b32 s75, 30
    s_cbranch_scc1 L_Fopt2
    buffer_store_dwordx2 v[52:53], v51, s[44:47], s75 offen offset:256 sc1
L_Fopt2:
    s_waitcnt vmcnt(10) lgkmcnt(0)
    s_barrier
    v_mfma_f32_16x16x32_bf16 v[160:163], v[136:139], v[120:123], v[160:163]
    ds_read_b64_tr_b16 v[96:97], v30 offset:49152
    ds_read_b64_tr_b16 v[98:99], v30 offset:49664
    v_mfma_f32_16x16x32_bf16 v[184:187], v[136:139], v[124:127], v[184:187]
    ds_read_b128 v[80:83], v28 offset:32768
    ds_read_b128 v[84:87], v28 offset:34816
    v_mfma_f32_16x16x32_bf16 v[208:211], v[136:139], v[128:131], v[208:211]
    s_add_u32 m0, s64, 16384
    s_lshl_b32 s62, s61, 7
    s_lshl_b32 s77, s77, 12
    v_mfma_f32_16x16x32_bf16 v[232:235], v[136:139], v[132:135], v[232:235]
    buffer_load_dwordx4 v18, s[36:39], s62 offen offset:0 lds
    v_mfma_f32_16x16x32_bf16 v[236:239], v[140:143], v[132:135], v[236:239]
    ds_read_b128 v[88:91], v28 offset:36864
    ds_read_b128 v[92:95], v28 offset:38912
    v_mfma_f32_16x16x32_bf16 v[212:215], v[140:143], v[128:131], v[212:215]
    s_add_u32 s77, s77, 5242880
    s_lshl1_add_u32 s80, s78, s73
    s_lshl3_add_u32 s80, s80, s67
    v_mfma_f32_16x16x32_bf16 v[188:191], v[140:143], v[124:127], v[188:191]
    ds_read_b64_tr_b16 v[100:101], v31 offset:49152
    ds_read_b64_tr_b16 v[102:103], v31 offset:49664
    v_mfma_f32_16x16x32_bf16 v[164:167], v[140:143], v[120:123], v[164:167]
    buffer_load_dwordx4 v19, s[36:39], s62 offen offset:1024 lds
    v_mfma_f32_16x16x32_bf16 v[168:171], v[144:147], v[120:123], v[168:171]
    s_lshl1_add_u32 s80, s80, s74
    s_lshl_b32 s80, s80, 2
    v_perm_b32 v56, v36, v34, s6
    v_mfma_f32_16x16x32_bf16 v[192:195], v[144:147], v[124:127], v[192:195]
    ds_read_b64_tr_b16 v[104:105], v32 offset:49152
    ds_read_b64_tr_b16 v[106:107], v32 offset:49664
    v_mfma_f32_16x16x32_bf16 v[216:219], v[144:147], v[128:131], v[216:219]
    v_perm_b32 v57, v40, v38, s6
    v_perm_b32 v58, v44, v42, s6
    v_mfma_f32_16x16x32_bf16 v[240:243], v[144:147], v[132:135], v[240:243]
    buffer_load_dwordx4 v20, s[36:39], s62 offen offset:2048 lds
    v_mfma_f32_16x16x32_bf16 v[244:247], v[148:151], v[132:135], v[244:247]
    ds_read_b64_tr_b16 v[108:109], v33 offset:49152
    ds_read_b64_tr_b16 v[110:111], v33 offset:49664
    v_mfma_f32_16x16x32_bf16 v[220:223], v[148:151], v[128:131], v[220:223]
    v_perm_b32 v59, v48, v46, s6
    v_mfma_f32_16x16x32_bf16 v[196:199], v[148:151], v[124:127], v[196:199]
    s_bitcmp1_b32 s4, 30
    s_cbranch_scc1 L_Fopt3
    buffer_store_dwordx4 v[56:59], v15, s[44:47], s4 offen offset:0 sc1
L_Fopt3:
    v_mfma_f32_16x16x32_bf16 v[172:175], v[148:151], v[120:123], v[172:175]
    ds_read_b64_tr_b16 v[112:113], v30 offset:51200
    ds_read_b64_tr_b16 v[114:115], v30 offset:51712
    v_mfma_f32_16x16x32_bf16 v[176:179], v[152:155], v[120:123], v[176:179]
    buffer_load_dwordx4 v21, s[36:39], s62 offen offset:3072 lds
    v_mfma_f32_16x16x32_bf16 v[200:203], v[152:155], v[124:127], v[200:203]
    ds_read_b64_tr_b16 v[116:117], v31 offset:51200
    s_add_u32 m0, s65, 24576
    v_mfma_f32_16x16x32_bf16 v[224:227], v[152:155], v[128:131], v[224:227]
    ds_read_b64_tr_b16 v[118:119], v31 offset:51712
    s_mul_i32 s63, s61, s71
    v_mfma_f32_16x16x32_bf16 v[248:251], v[152:155], v[132:135], v[248:251]
    v_perm_b32 v60, v36, v34, s7
    v_perm_b32 v61, v40, v38, s7
    v_mfma_f32_16x16x32_bf16 v[252:255], v[156:159], v[132:135], v[252:255]
    buffer_load_dwordx4 v22, s[40:43], s63 offen offset:0 lds
    v_mfma_f32_16x16x32_bf16 v[228:231], v[156:159], v[128:131], v[228:231]
    v_perm_b32 v62, v44, v42, s7
    v_perm_b32 v63, v48, v46, s7
    v_mfma_f32_16x16x32_bf16 v[204:207], v[156:159], v[124:127], v[204:207]
    s_bitcmp1_b32 s4, 30
    s_cbranch_scc1 L_Fopt4
    buffer_store_dwordx4 v[60:63], v15, s[44:47], s4 offen offset:1024 sc1
L_Fopt4:
    v_mfma_f32_16x16x32_bf16 v[180:183], v[156:159], v[120:123], v[180:183]
    s_waitcnt lgkmcnt(0)
    v_mfma_f32_16x16x32_bf16 v[160:163], v[96:99], v[80:83], v[160:163]
    ds_read_b64_tr_b16 v[136:137], v30 offset:61440
    ds_read_b64_tr_b16 v[138:139], v30 offset:61952
    v_mfma_f32_16x16x32_bf16 v[184:187], v[96:99], v[84:87], v[184:187]
    ds_read_b128 v[120:123], v29 offset:32768
    ds_read_b128 v[124:127], v29 offset:34816
    v_mfma_f32_16x16x32_bf16 v[208:211], v[96:99], v[88:91], v[208:211]
    buffer_load_dwordx4 v23, s[40:43], s63 offen offset:1024 lds
    v_mfma_f32_16x16x32_bf16 v[232:235], v[96:99], v[92:95], v[232:235]
    v_and_b32 v12, 7, v0
    v_lshlrev_b32 v12, 3, v12
    v_mfma_f32_16x16x32_bf16 v[236:239], v[100:103], v[92:95], v[236:239]
    ds_read_b128 v[128:131], v29 offset:36864
    ds_read_b128 v[132:135], v29 offset:38912
    v_mfma_f32_16x16x32_bf16 v[212:215], v[100:103], v[88:91], v[212:215]
    v_add_u32 v12, 162816, v12
    v_perm_b32 v64, v37, v35, s6
    v_mfma_f32_16x16x32_bf16 v[188:191], v[100:103], v[84:87], v[188:191]
    ds_read_b64 v[8:9], v12
    v_mov_b32 v16, s66
    v_mfma_f32_16x16x32_bf16 v[164:167], v[100:103], v[80:83], v[164:167]
    buffer_load_dwordx4 v24, s[40:43], s63 offen offset:2048 lds
    v_mfma_f32_16x16x32_bf16 v[168:171], v[104:107], v[80:83], v[168:171]
    ds_read_b64_tr_b16 v[140:141], v31 offset:61440
    ds_read_b64_tr_b16 v[142:143], v31 offset:61952
    v_mfma_f32_16x16x32_bf16 v[192:195], v[104:107], v[84:87], v[192:195]
    ds_read_b64_tr_b16 v[144:145], v32 offset:61440
    ds_read_b64_tr_b16 v[146:147], v32 offset:61952
    v_mfma_f32_16x16x32_bf16 v[216:219], v[104:107], v[88:91], v[216:219]
    s_add_u32 m0, s65, 27648
    s_add_u32 s61, s61, 1
    v_mov_b32 v10, s66
    v_mfma_f32_16x16x32_bf16 v[240:243], v[104:107], v[92:95], v[240:243]
    buffer_load_dwordx4 v25, s[40:43], s63 offen offset:0 lds
    v_mfma_f32_16x16x32_bf16 v[244:247], v[108:111], v[92:95], v[244:247]
    ds_read_b64_tr_b16 v[148:149], v33 offset:61440
    ds_read_b64_tr_b16 v[150:151], v33 offset:61952
    v_mfma_f32_16x16x32_bf16 v[220:223], v[108:111], v[88:91], v[220:223]
    v_mov_b32 v11, s66
    v_lshrrev_b32 v12, 3, v0
    v_mfma_f32_16x16x32_bf16 v[196:199], v[108:111], v[84:87], v[196:199]
    ds_read_b64_tr_b16 v[152:153], v30 offset:63488
    ds_read_b64_tr_b16 v[154:155], v30 offset:64000
    v_mfma_f32_16x16x32_bf16 v[172:175], v[108:111], v[80:83], v[172:175]
    v_lshlrev_b32 v12, 25, v12
    v_lshl_add_u32 v12, v0, 4, v12
    v_mfma_f32_16x16x32_bf16 v[176:179], v[112:115], v[80:83], v[176:179]
    buffer_load_dwordx4 v26, s[40:43], s63 offen offset:1024 lds
    v_mfma_f32_16x16x32_bf16 v[200:203], v[112:115], v[84:87], v[200:203]
    ds_read_b64_tr_b16 v[156:157], v31 offset:63488
    ds_read_b64_tr_b16 v[158:159], v31 offset:64000
    v_mfma_f32_16x16x32_bf16 v[224:227], v[112:115], v[88:91], v[224:227]
    s_cmp_eq_u32 s61, 10
    s_cselect_b32 s61, 0, s61
    s_lshl4_add_u32 s67, s3, s22
    v_mfma_f32_16x16x32_bf16 v[248:251], v[112:115], v[92:95], v[248:251]
    s_lshl_b32 s67, s67, 7
    s_add_u32 s67, s67, 32768
    v_perm_b32 v65, v41, v39, s6
    v_mfma_f32_16x16x32_bf16 v[252:255], v[116:119], v[92:95], v[252:255]
    buffer_load_dwordx4 v27, s[40:43], s63 offen offset:2048 lds
    v_mfma_f32_16x16x32_bf16 v[228:231], v[116:119], v[88:91], v[228:231]
    v_perm_b32 v66, v45, v43, s6
    v_perm_b32 v67, v49, v47, s6
    v_mfma_f32_16x16x32_bf16 v[204:207], v[116:119], v[84:87], v[204:207]
    s_bitcmp1_b32 s4, 30
    s_cbranch_scc1 L_Fopt5
    buffer_store_dwordx4 v[64:67], v15, s[44:47], s4 offen offset:2048 sc1
L_Fopt5:
    v_mfma_f32_16x16x32_bf16 v[180:183], v[116:119], v[80:83], v[180:183]
    v_perm_b32 v68, v37, v35, s7
    v_perm_b32 v69, v41, v39, s7
    v_perm_b32 v70, v45, v43, s7
    v_perm_b32 v71, v49, v47, s7
    s_bitcmp1_b32 s4, 30
    s_cbranch_scc1 L_Fopt6
    buffer_store_dwordx4 v[68:71], v15, s[44:47], s4 offen offset:3072 sc1
L_Fopt6:
    s_add_u32 s4, s4, 4096
    s_bitcmp1_b32 s4, 30
    s_cbranch_scc1 L_Fopt7
    buffer_store_dwordx4 v[72:75], v15, s[44:47], s4 offen offset:0 sc1
L_Fopt7:
    s_waitcnt vmcnt(10) lgkmcnt(0)
    s_barrier
    v_mfma_f32_16x16x32_bf16 v[160:163], v[136:139], v[120:123], v[160:163]
    s_cmp_lg_u32 s60, 0
    s_cbranch_scc1 L_Fopt8
    buffer_store_dwordx4 v[8:11], v12, s[44:47], s67 offen sc1
L_Fopt8:
    v_mfma_f32_16x16x32_bf16 v[184:187], v[136:139], v[124:127], v[184:187]
    ds_read_b64_tr_b16 v[96:97], v30 offset:0
    ds_read_b64_tr_b16 v[98:99], v30 offset:512
    v_mfma_f32_16x16x32_bf16 v[208:211], v[136:139], v[128:131], v[208:211]
    ds_read_b128 v[80:83], v28 offset:0
    s_add_u32 m0, s64, 32768
    v_mfma_f32_16x16x32_bf16 v[232:235], v[136:139], v[132:135], v[232:235]
    ds_read_b128 v[84:87], v28 offset:2048
    s_lshl_b32 s62, s61, 7
    v_mfma_f32_16x16x32_bf16 v[236:239], v[140:143], v[132:135], v[236:239]
    buffer_load_dwordx4 v18, s[36:39], s62 offen offset:0 lds
    v_mfma_f32_16x16x32_bf16 v[212:215], v[140:143], v[128:131], v[212:215]
    ds_read_b128 v[88:91], v28 offset:4096
    v_mfma_f32_16x16x32_bf16 v[188:191], v[140:143], v[124:127], v[188:191]
    ds_read_b128 v[92:95], v28 offset:6144
    v_mfma_f32_16x16x32_bf16 v[164:167], v[140:143], v[120:123], v[164:167]
    buffer_load_dwordx4 v19, s[36:39], s62 offen offset:1024 lds
    v_mfma_f32_16x16x32_bf16 v[168:171], v[144:147], v[120:123], v[168:171]
    ds_read_b64_tr_b16 v[100:101], v31 offset:0
    v_mfma_f32_16x16x32_bf16 v[192:195], v[144:147], v[124:127], v[192:195]
    ds_read_b64_tr_b16 v[102:103], v31 offset:512
    v_mfma_f32_16x16x32_bf16 v[216:219], v[144:147], v[128:131], v[216:219]
    ds_read_b64_tr_b16 v[104:105], v32 offset:0
    v_mfma_f32_16x16x32_bf16 v[240:243], v[144:147], v[132:135], v[240:243]
    buffer_load_dwordx4 v20, s[36:39], s62 offen offset:2048 lds
    v_mfma_f32_16x16x32_bf16 v[244:247], v[148:151], v[132:135], v[244:247]
    ds_read_b64_tr_b16 v[106:107], v32 offset:512
    v_mfma_f32_16x16x32_bf16 v[220:223], v[148:151], v[128:131], v[220:223]
    ds_read_b64_tr_b16 v[108:109], v33 offset:0
    v_mfma_f32_16x16x32_bf16 v[196:199], v[148:151], v[124:127], v[196:199]
    ds_read_b64_tr_b16 v[110:111], v33 offset:512
    v_mfma_f32_16x16x32_bf16 v[172:175], v[148:151], v[120:123], v[172:175]
    ds_read_b64_tr_b16 v[112:113], v30 offset:2048
    v_mfma_f32_16x16x32_bf16 v[176:179], v[152:155], v[120:123], v[176:179]
    buffer_load_dwordx4 v21, s[36:39], s62 offen offset:3072 lds
    v_mfma_f32_16x16x32_bf16 v[200:203], v[152:155], v[124:127], v[200:203]
    ds_read_b64_tr_b16 v[114:115], v30 offset:2560
    s_add_u32 m0, s65, 49152
    v_mfma_f32_16x16x32_bf16 v[224:227], v[152:155], v[128:131], v[224:227]
    ds_read_b64_tr_b16 v[116:117], v31 offset:2048
    s_mul_i32 s63, s61, s71
    v_mfma_f32_16x16x32_bf16 v[248:251], v[152:155], v[132:135], v[248:251]
    ds_read_b64_tr_b16 v[118:119], v31 offset:2560
    v_mfma_f32_16x16x32_bf16 v[252:255], v[156:159], v[132:135], v[252:255]
    buffer_load_dwordx4 v22, s[40:43], s63 offen offset:0 lds
    v_mfma_f32_16x16x32_bf16 v[228:231], v[156:159], v[128:131], v[228:231]
    v_mfma_f32_16x16x32_bf16 v[204:207], v[156:159], v[124:127], v[204:207]
    v_mfma_f32_16x16x32_bf16 v[180:183], v[156:159], v[120:123], v[180:183]
    s_waitcnt lgkmcnt(0)
    v_mfma_f32_16x16x32_bf16 v[160:163], v[96:99], v[80:83], v[160:163]
    ds_read_b64_tr_b16 v[136:137], v30 offset:12288
    v_lshrrev_b32 v14, 5, v0
    v_mfma_f32_16x16x32_bf16 v[184:187], v[96:99], v[84:87], v[184:187]
    ds_read_b64_tr_b16 v[138:139], v30 offset:12800
    v_min_u32 v14, 1, v14
    v_mfma_f32_16x16x32_bf16 v[208:211], v[96:99], v[88:91], v[208:211]
    buffer_load_dwordx4 v23, s[40:43], s63 offen offset:1024 lds
    v_mfma_f32_16x16x32_bf16 v[232:235], v[96:99], v[92:95], v[232:235]
    ds_read_b128 v[120:123], v29 offset:0
    v_lshlrev_b32 v14, 25, v14
    v_mfma_f32_16x16x32_bf16 v[236:239], v[100:103], v[92:95], v[236:239]
    ds_read_b128 v[124:127], v29 offset:2048
    v_lshl_add_u32 v14, v0, 2, v14
    v_mfma_f32_16x16x32_bf16 v[212:215], v[100:103], v[88:91], v[212:215]
    ds_read_b128 v[128:131], v29 offset:4096
    s_lshl_b32 s69, s23, 7
    v_mfma_f32_16x16x32_bf16 v[188:191], v[100:103], v[84:87], v[188:191]
    ds_read_b128 v[132:135], v29 offset:6144
    s_add_u32 s69, s69, 98304
    v_mfma_f32_16x16x32_bf16 v[164:167], v[100:103], v[80:83], v[164:167]
    buffer_load_dwordx4 v24, s[40:43], s63 offen offset:2048 lds
    v_mfma_f32_16x16x32_bf16 v[168:171], v[104:107], v[80:83], v[168:171]
    ds_read_b64_tr_b16 v[140:141], v31 offset:12288
    s_add_u32 m0, s65, 52224
    v_mfma_f32_16x16x32_bf16 v[192:195], v[104:107], v[84:87], v[192:195]
    ds_read_b64_tr_b16 v[142:143], v31 offset:12800
    s_add_u32 s61, s61, 1
    v_mfma_f32_16x16x32_bf16 v[216:219], v[104:107], v[88:91], v[216:219]
    ds_read_b64_tr_b16 v[144:145], v32 offset:12288
    v_mfma_f32_16x16x32_bf16 v[240:243], v[104:107], v[92:95], v[240:243]
    buffer_load_dwordx4 v25, s[40:43], s63 offen offset:0 lds
    v_mfma_f32_16x16x32_bf16 v[244:247], v[108:111], v[92:95], v[244:247]
    ds_read_b64_tr_b16 v[146:147], v32 offset:12800
    v_mfma_f32_16x16x32_bf16 v[220:223], v[108:111], v[88:91], v[220:223]
    ds_read_b64_tr_b16 v[148:149], v33 offset:12288
    v_mfma_f32_16x16x32_bf16 v[196:199], v[108:111], v[84:87], v[196:199]
    ds_read_b64_tr_b16 v[150:151], v33 offset:12800
    v_mfma_f32_16x16x32_bf16 v[172:175], v[108:111], v[80:83], v[172:175]
    ds_read_b64_tr_b16 v[152:153], v30 offset:14336
    v_mfma_f32_16x16x32_bf16 v[176:179], v[112:115], v[80:83], v[176:179]
    buffer_load_dwordx4 v26, s[40:43], s63 offen offset:1024 lds
    v_mfma_f32_16x16x32_bf16 v[200:203], v[112:115], v[84:87], v[200:203]
    ds_read_b64_tr_b16 v[154:155], v30 offset:14848
    v_mfma_f32_16x16x32_bf16 v[224:227], v[112:115], v[88:91], v[224:227]
    ds_read_b64_tr_b16 v[156:157], v31 offset:14336
    v_mfma_f32_16x16x32_bf16 v[248:251], v[112:115], v[92:95], v[248:251]
    ds_read_b64_tr_b16 v[158:159], v31 offset:14848
    s_cmp_eq_u32 s61, 10
    s_cselect_b32 s61, 0, s61
    v_mfma_f32_16x16x32_bf16 v[252:255], v[116:119], v[92:95], v[252:255]
    buffer_load_dwordx4 v27, s[40:43], s63 offen offset:2048 lds
    v_mfma_f32_16x16x32_bf16 v[228:231], v[116:119], v[88:91], v[228:231]
    v_mfma_f32_16x16x32_bf16 v[204:207], v[116:119], v[84:87], v[204:207]
    v_mfma_f32_16x16x32_bf16 v[180:183], v[116:119], v[80:83], v[180:183]
    s_waitcnt vmcnt(10) lgkmcnt(0)
    s_barrier
    v_mfma_f32_16x16x32_bf16 v[160:163], v[136:139], v[120:123], v[160:163]
    buffer_store_dword v16, v14, s[44:47], s69 offen sc1
    v_mfma_f32_16x16x32_bf16 v[184:187], v[136:139], v[124:127], v[184:187]
    ds_read_b64_tr_b16 v[96:97], v30 offset:24576
L_FA_pad0:
    s_cbranch_execz L_FA_pad4
    ds_read_b64_tr_b16 v[98:99], v30 offset:25088
    v_mfma_f32_16x16x32_bf16 v[208:211], v[136:139], v[128:131], v[208:211]
    ds_read_b128 v[80:83], v28 offset:16384
    s_add_u32 m0, s64, 0
    v_mfma_f32_16x16x32_bf16 v[232:235], v[136:139], v[132:135], v[232:235]
    ds_read_b128 v[84:87], v28 offset:18432
    s_lshl_b32 s62, s61, 7
    v_mfma_f32_16x16x32_bf16 v[236:239], v[140:143], v[132:135], v[236:239]
    buffer_load_dwordx4 v18, s[36:39], s62 offen offset:0 lds
    v_mfma_f32_16x16x32_bf16 v[212:215], v[140:143], v[128:131], v[212:215]
    ds_read_b128 v[88:91], v28 offset:20480
    v_mfma_f32_16x16x32_bf16 v[188:191], v[140:143], v[124:127], v[188:191]
    ds_read_b128 v[92:95], v28 offset:22528
    v_mfma_f32_16x16x32_bf16 v[164:167], v[140:143], v[120:123], v[164:167]
    buffer_load_dwordx4 v19, s[36:39], s62 offen offset:1024 lds
    v_mfma_f32_16x16x32_bf16 v[168:171], v[144:147], v[120:123], v[168:171]
    ds_read_b64_tr_b16 v[100:101], v31 offset:24576
    v_mfma_f32_16x16x32_bf16 v[192:195], v[144:147], v[124:127], v[192:195]
    ds_read_b64_tr_b16 v[102:103], v31 offset:25088
    v_mfma_f32_16x16x32_bf16 v[216:219], v[144:147], v[128:131], v[216:219]
    ds_read_b64_tr_b16 v[104:105], v32 offset:24576
    v_mfma_f32_16x16x32_bf16 v[240:243], v[144:147], v[132:135], v[240:243]
    buffer_load_dwordx4 v20, s[36:39], s62 offen offset:2048 lds
    v_mfma_f32_16x16x32_bf16 v[244:247], v[148:151], v[132:135], v[244:247]
    ds_read_b64_tr_b16 v[106:107], v32 offset:25088
    v_mfma_f32_16x16x32_bf16 v[220:223], v[148:151], v[128:131], v[220:223]
    ds_read_b64_tr_b16 v[108:109], v33 offset:24576
    v_mfma_f32_16x16x32_bf16 v[196:199], v[148:151], v[124:127], v[196:199]
    ds_read_b64_tr_b16 v[110:111], v33 offset:25088
    v_mfma_f32_16x16x32_bf16 v[172:175], v[148:151], v[120:123], v[172:175]
    ds_read_b64_tr_b16 v[112:113], v30 offset:26624
    v_mfma_f32_16x16x32_bf16 v[176:179], v[152:155], v[120:123], v[176:179]
    buffer_load_dwordx4 v21, s[36:39], s62 offen offset:3072 lds
    v_mfma_f32_16x16x32_bf16 v[200:203], v[152:155], v[124:127], v[200:203]
    ds_read_b64_tr_b16 v[114:115], v30 offset:27136
    s_add_u32 m0, s65, 0
    v_mfma_f32_16x16x32_bf16 v[224:227], v[152:155], v[128:131], v[224:227]
    ds_read_b64_tr_b16 v[116:117], v31 offset:26624
    s_mul_i32 s63, s61, s71
    v_mfma_f32_16x16x32_bf16 v[248:251], v[152:155], v[132:135], v[248:251]
    ds_read_b64_tr_b16 v[118:119], v31 offset:27136
    v_mfma_f32_16x16x32_bf16 v[252:255], v[156:159], v[132:135], v[252:255]
    buffer_load_dwordx4 v22, s[40:43], s63 offen offset:0 lds
    v_mfma_f32_16x16x32_bf16 v[228:231], v[156:159], v[128:131], v[228:231]
    v_mfma_f32_16x16x32_bf16 v[204:207], v[156:159], v[124:127], v[204:207]
    v_mfma_f32_16x16x32_bf16 v[180:183], v[156:159], v[120:123], v[180:183]
    s_waitcnt lgkmcnt(0)
    v_mfma_f32_16x16x32_bf16 v[160:163], v[96:99], v[80:83], v[160:163]
    ds_read_b64_tr_b16 v[136:137], v30 offset:36864
    v_mfma_f32_16x16x32_bf16 v[184:187], v[96:99], v[84:87], v[184:187]
    ds_read_b64_tr_b16 v[138:139], v30 offset:37376
    v_mfma_f32_16x16x32_bf16 v[208:211], v[96:99], v[88:91], v[208:211]
    buffer_load_dwordx4 v23, s[40:43], s63 offen offset:1024 lds
    v_mfma_f32_16x16x32_bf16 v[232:235], v[96:99], v[92:95], v[232:235]
    ds_read_b128 v[120:123], v29 offset:16384
    v_mfma_f32_16x16x32_bf16 v[236:239], v[100:103], v[92:95], v[236:239]
    ds_read_b128 v[124:127], v29 offset:18432
    v_mfma_f32_16x16x32_bf16 v[212:215], v[100:103], v[88:91], v[212:215]
    ds_read_b128 v[128:131], v29 offset:20480
    v_mfma_f32_16x16x32_bf16 v[188:191], v[100:103], v[84:87], v[188:191]
    ds_read_b128 v[132:135], v29 offset:22528
    v_mfma_f32_16x16x32_bf16 v[164:167], v[100:103], v[80:83], v[164:167]
    buffer_load_dwordx4 v24, s[40:43], s63 offen offset:2048 lds
    v_mfma_f32_16x16x32_bf16 v[168:171], v[104:107], v[80:83], v[168:171]
    ds_read_b64_tr_b16 v[140:141], v31 offset:36864
    s_add_u32 m0, s65, 3072
    v_mfma_f32_16x16x32_bf16 v[192:195], v[104:107], v[84:87], v[192:195]
    ds_read_b64_tr_b16 v[142:143], v31 offset:37376
    s_add_u32 s61, s61, 1
    v_mfma_f32_16x16x32_bf16 v[216:219], v[104:107], v[88:91], v[216:219]
    ds_read_b64_tr_b16 v[144:145], v32 offset:36864
    v_mfma_f32_16x16x32_bf16 v[240:243], v[104:107], v[92:95], v[240:243]
    buffer_load_dwordx4 v25, s[40:43], s63 offen offset:0 lds
    v_mfma_f32_16x16x32_bf16 v[244:247], v[108:111], v[92:95], v[244:247]
    ds_read_b64_tr_b16 v[146:147], v32 offset:37376
    v_mfma_f32_16x16x32_bf16 v[220:223], v[108:111], v[88:91], v[220:223]
    ds_read_b64_tr_b16 v[148:149], v33 offset:36864
    v_mfma_f32_16x16x32_bf16 v[196:199], v[108:111], v[84:87], v[196:199]
    ds_read_b64_tr_b16 v[150:151], v33 offset:37376
    v_mfma_f32_16x16x32_bf16 v[172:175], v[108:111], v[80:83], v[172:175]
    ds_read_b64_tr_b16 v[152:153], v30 offset:38912
    v_mfma_f32_16x16x32_bf16 v[176:179], v[112:115], v[80:83], v[176:179]
    buffer_load_dwordx4 v26, s[40:43], s63 offen offset:1024 lds
    v_mfma_f32_16x16x32_bf16 v[200:203], v[112:115], v[84:87], v[200:203]
    ds_read_b64_tr_b16 v[154:155], v30 offset:39424
    v_mfma_f32_16x16x32_bf16 v[224:227], v[112:115], v[88:91], v[224:227]
    ds_read_b64_tr_b16 v[156:157], v31 offset:38912
    v_mfma_f32_16x16x32_bf16 v[248:251], v[112:115], v[92:95], v[248:251]
    ds_read_b64_tr_b16 v[158:159], v31 offset:39424
    s_cmp_eq_u32 s61, 10
    s_cselect_b32 s61, 0, s61
    v_mfma_f32_16x16x32_bf16 v[252:255], v[116:119], v[92:95], v[252:255]
    buffer_load_dwordx4 v27, s[40:43], s63 offen offset:2048 lds
    v_mfma_f32_16x16x32_bf16 v[228:231], v[116:119], v[88:91], v[228:231]
    v_mfma_f32_16x16x32_bf16 v[204:207], v[116:119], v[84:87], v[204:207]
    v_mfma_f32_16x16x32_bf16 v[180:183], v[116:119], v[80:83], v[180:183]
    s_waitcnt vmcnt(11) lgkmcnt(0)
    s_barrier
    v_mfma_f32_16x16x32_bf16 v[160:163], v[136:139], v[120:123], v[160:163]
    ds_read_b64_tr_b16 v[96:97], v30 offset:49152
    s_lshl_b32 s67, s3, 7
    v_mfma_f32_16x16x32_bf16 v[184:187], v[136:139], v[124:127], v[184:187]
    ds_read_b64_tr_b16 v[98:99], v30 offset:49664
    s_add_u32 m0, s64, 16384
    v_mfma_f32_16x16x32_bf16 v[208:211], v[136:139], v[128:131], v[208:211]
    ds_read_b128 v[80:83], v28 offset:32768
    s_lshl_b32 s62, s61, 7
    v_mfma_f32_16x16x32_bf16 v[232:235], v[136:139], v[132:135], v[232:235]
    buffer_load_dwordx4 v18, s[36:39], s62 offen offset:0 lds
    v_mfma_f32_16x16x32_bf16 v[236:239], v[140:143], v[132:135], v[236:239]
    ds_read_b128 v[84:87], v28 offset:34816
    v_add_u32 v12, s67, v0
    v_mfma_f32_16x16x32_bf16 v[212:215], v[140:143], v[128:131], v[212:215]
    ds_read_b128 v[88:91], v28 offset:36864
    v_lshlrev_b32 v12, 4, v12
    v_mfma_f32_16x16x32_bf16 v[188:191], v[140:143], v[124:127], v[188:191]
    ds_read_b128 v[92:95], v28 offset:38912
    v_lshl_add_u32 v13, v2, 4, s22
    v_mfma_f32_16x16x32_bf16 v[164:167], v[140:143], v[120:123], v[164:167]
    buffer_load_dwordx4 v19, s[36:39], s62 offen offset:1024 lds
    v_mfma_f32_16x16x32_bf16 v[168:171], v[144:147], v[120:123], v[168:171]
    ds_read_b64_tr_b16 v[100:101], v31 offset:49152
    v_lshlrev_b32 v13, 7, v13
    v_mfma_f32_16x16x32_bf16 v[192:195], v[144:147], v[124:127], v[192:195]
    ds_read_b64_tr_b16 v[102:103], v31 offset:49664
    v_mfma_f32_16x16x32_bf16 v[216:219], v[144:147], v[128:131], v[216:219]
    ds_read_b64_tr_b16 v[104:105], v32 offset:49152
    v_mfma_f32_16x16x32_bf16 v[240:243], v[144:147], v[132:135], v[240:243]
    buffer_load_dwordx4 v20, s[36:39], s62 offen offset:2048 lds
    v_mfma_f32_16x16x32_bf16 v[244:247], v[148:151], v[132:135], v[244:247]
    ds_read_b64_tr_b16 v[106:107], v32 offset:49664
    v_mfma_f32_16x16x32_bf16 v[220:223], v[148:151], v[128:131], v[220:223]
    ds_read_b64_tr_b16 v[108:109], v33 offset:49152
    v_mfma_f32_16x16x32_bf16 v[196:199], v[148:151], v[124:127], v[196:199]
    ds_read_b64_tr_b16 v[110:111], v33 offset:49664
    v_mfma_f32_16x16x32_bf16 v[172:175], v[148:151], v[120:123], v[172:175]
    ds_read_b64_tr_b16 v[112:113], v30 offset:51200
    v_mfma_f32_16x16x32_bf16 v[176:179], v[152:155], v[120:123], v[176:179]
    buffer_load_dwordx4 v21, s[36:39], s62 offen offset:3072 lds
    v_mfma_f32_16x16x32_bf16 v[200:203], v[152:155], v[124:127], v[200:203]
    ds_read_b64_tr_b16 v[114:115], v30 offset:51712
    s_add_u32 m0, s65, 24576
    v_mfma_f32_16x16x32_bf16 v[224:227], v[152:155], v[128:131], v[224:227]
L_FA_pad1:
    s_cbranch_execz L_FA_pad5
    ds_read_b64_tr_b16 v[116:117], v31 offset:51200
    s_mul_i32 s63, s61, s71
    v_mfma_f32_16x16x32_bf16 v[248:251], v[152:155], v[132:135], v[248:251]
    ds_read_b64_tr_b16 v[118:119], v31 offset:51712
    v_mfma_f32_16x16x32_bf16 v[252:255], v[156:159], v[132:135], v[252:255]
    buffer_load_dwordx4 v22, s[40:43], s63 offen offset:0 lds
    v_mfma_f32_16x16x32_bf16 v[228:231], v[156:159], v[128:131], v[228:231]
    s_cmp_ge_u32 s60, 2
    s_cselect_b64 vcc, -1, 0
    v_mfma_f32_16x16x32_bf16 v[204:207], v[156:159], v[124:127], v[204:207]
    v_mfma_f32_16x16x32_bf16 v[180:183], v[156:159], v[120:123], v[180:183]
    s_waitcnt lgkmcnt(0)
    v_mfma_f32_16x16x32_bf16 v[160:163], v[96:99], v[80:83], v[160:163]
    ds_read_b64_tr_b16 v[136:137], v30 offset:61440
    v_cndmask_b32 v12, v12, v13, vcc
    v_mfma_f32_16x16x32_bf16 v[184:187], v[96:99], v[84:87], v[184:187]
    ds_read_b64_tr_b16 v[138:139], v30 offset:61952
    v_add_u32 v12, 32768, v12
    v_mfma_f32_16x16x32_bf16 v[208:211], v[96:99], v[88:91], v[208:211]
    buffer_load_dwordx4 v23, s[40:43], s63 offen offset:1024 lds
    v_mfma_f32_16x16x32_bf16 v[232:235], v[96:99], v[92:95], v[232:235]
    ds_read_b128 v[120:123], v29 offset:32768
    v_lshlrev_b32 v13, 2, v0
    v_mfma_f32_16x16x32_bf16 v[236:239], v[100:103], v[92:95], v[236:239]
    ds_read_b128 v[124:127], v29 offset:34816
    s_mul_i32 s67, s73, 1024
    v_mfma_f32_16x16x32_bf16 v[212:215], v[100:103], v[88:91], v[212:215]
    ds_read_b128 v[128:131], v29 offset:36864
    s_add_u32 s67, s67, 155648
    v_mfma_f32_16x16x32_bf16 v[188:191], v[100:103], v[84:87], v[188:191]
    ds_read_b128 v[132:135], v29 offset:38912
    v_add_u32 v13, s67, v13
    v_mfma_f32_16x16x32_bf16 v[164:167], v[100:103], v[80:83], v[164:167]
    buffer_load_dwordx4 v24, s[40:43], s63 offen offset:2048 lds
    v_mfma_f32_16x16x32_bf16 v[168:171], v[104:107], v[80:83], v[168:171]
    ds_read_b64_tr_b16 v[140:141], v31 offset:61440
    s_add_u32 m0, s65, 27648
    v_mfma_f32_16x16x32_bf16 v[192:195], v[104:107], v[84:87], v[192:195]
    ds_read_b64_tr_b16 v[142:143], v31 offset:61952
    s_add_u32 s61, s61, 1
    v_mfma_f32_16x16x32_bf16 v[216:219], v[104:107], v[88:91], v[216:219]
    ds_read_b64_tr_b16 v[144:145], v32 offset:61440
    v_mfma_f32_16x16x32_bf16 v[240:243], v[104:107], v[92:95], v[240:243]
    buffer_load_dwordx4 v25, s[40:43], s63 offen offset:0 lds
    v_mfma_f32_16x16x32_bf16 v[244:247], v[108:111], v[92:95], v[244:247]
    ds_read_b64_tr_b16 v[146:147], v32 offset:61952
    v_mfma_f32_16x16x32_bf16 v[220:223], v[108:111], v[88:91], v[220:223]
    ds_read_b64_tr_b16 v[148:149], v33 offset:61440
    v_mfma_f32_16x16x32_bf16 v[196:199], v[108:111], v[84:87], v[196:199]
    ds_read_b64_tr_b16 v[150:151], v33 offset:61952
    v_mfma_f32_16x16x32_bf16 v[172:175], v[108:111], v[80:83], v[172:175]
    ds_read_b64_tr_b16 v[152:153], v30 offset:63488
    v_mfma_f32_16x16x32_bf16 v[176:179], v[112:115], v[80:83], v[176:179]
    buffer_load_dwordx4 v26, s[40:43], s63 offen offset:1024 lds
    v_mfma_f32_16x16x32_bf16 v[200:203], v[112:115], v[84:87], v[200:203]
    ds_read_b64_tr_b16 v[154:155], v30 offset:64000
    v_mfma_f32_16x16x32_bf16 v[224:227], v[112:115], v[88:91], v[224:227]
    ds_read_b64_tr_b16 v[156:157], v31 offset:63488
    v_mfma_f32_16x16x32_bf16 v[248:251], v[112:115], v[92:95], v[248:251]
    ds_read_b64_tr_b16 v[158:159], v31 offset:64000
    s_cmp_eq_u32 s61, 10
    s_cselect_b32 s61, 0, s61
    v_mfma_f32_16x16x32_bf16 v[252:255], v[116:119], v[92:95], v[252:255]
    buffer_load_dwordx4 v27, s[40:43], s63 offen offset:2048 lds
    v_mfma_f32_16x16x32_bf16 v[228:231], v[116:119], v[88:91], v[228:231]
    v_mfma_f32_16x16x32_bf16 v[204:207], v[116:119], v[84:87], v[204:207]
    v_mfma_f32_16x16x32_bf16 v[180:183], v[116:119], v[80:83], v[180:183]
    s_waitcnt vmcnt(10) lgkmcnt(0)
    s_barrier
    v_mfma_f32_16x16x32_bf16 v[160:163], v[136:139], v[120:123], v[160:163]
    buffer_load_dwordx3 v[8:10], v12, s[44:47], 0 offen sc1
    v_mfma_f32_16x16x32_bf16 v[184:187], v[136:139], v[124:127], v[184:187]
    ds_read_b64_tr_b16 v[96:97], v30 offset:0
    ds_read_b64_tr_b16 v[98:99], v30 offset:512
    v_mfma_f32_16x16x32_bf16 v[208:211], v[136:139], v[128:131], v[208:211]
    ds_read_b128 v[80:83], v28 offset:0
    s_add_u32 m0, s64, 32768
    v_mfma_f32_16x16x32_bf16 v[232:235], v[136:139], v[132:135], v[232:235]
    ds_read_b128 v[84:87], v28 offset:2048
    s_lshl_b32 s62, s61, 7
    v_mfma_f32_16x16x32_bf16 v[236:239], v[140:143], v[132:135], v[236:239]
    buffer_load_dwordx4 v18, s[36:39], s62 offen offset:0 lds
    v_mfma_f32_16x16x32_bf16 v[212:215], v[140:143], v[128:131], v[212:215]
    ds_read_b128 v[88:91], v28 offset:4096
    v_mfma_f32_16x16x32_bf16 v[188:191], v[140:143], v[124:127], v[188:191]
    ds_read_b128 v[92:95], v28 offset:6144
    v_mfma_f32_16x16x32_bf16 v[164:167], v[140:143], v[120:123], v[164:167]
    buffer_load_dwordx4 v19, s[36:39], s62 offen offset:1024 lds
    v_mfma_f32_16x16x32_bf16 v[168:171], v[144:147], v[120:123], v[168:171]
    ds_read_b64_tr_b16 v[100:101], v31 offset:0
    v_mfma_f32_16x16x32_bf16 v[192:195], v[144:147], v[124:127], v[192:195]
    ds_read_b64_tr_b16 v[102:103], v31 offset:512
    v_mfma_f32_16x16x32_bf16 v[216:219], v[144:147], v[128:131], v[216:219]
    ds_read_b64_tr_b16 v[104:105], v32 offset:0
    v_mfma_f32_16x16x32_bf16 v[240:243], v[144:147], v[132:135], v[240:243]
    buffer_load_dwordx4 v20, s[36:39], s62 offen offset:2048 lds
    v_mfma_f32_16x16x32_bf16 v[244:247], v[148:151], v[132:135], v[244:247]
    ds_read_b64_tr_b16 v[106:107], v32 offset:512
    v_mfma_f32_16x16x32_bf16 v[220:223], v[148:151], v[128:131], v[220:223]
    ds_read_b64_tr_b16 v[108:109], v33 offset:0
    v_mfma_f32_16x16x32_bf16 v[196:199], v[148:151], v[124:127], v[196:199]
    ds_read_b64_tr_b16 v[110:111], v33 offset:512
    v_mfma_f32_16x16x32_bf16 v[172:175], v[148:151], v[120:123], v[172:175]
    ds_read_b64_tr_b16 v[112:113], v30 offset:2048
    v_mfma_f32_16x16x32_bf16 v[176:179], v[152:155], v[120:123], v[176:179]
    buffer_load_dwordx4 v21, s[36:39], s62 offen offset:3072 lds
    v_mfma_f32_16x16x32_bf16 v[200:203], v[152:155], v[124:127], v[200:203]
    ds_read_b64_tr_b16 v[114:115], v30 offset:2560
    s_add_u32 m0, s65, 49152
    v_mfma_f32_16x16x32_bf16 v[224:227], v[152:155], v[128:131], v[224:227]
    ds_read_b64_tr_b16 v[116:117], v31 offset:2048
    s_mul_i32 s63, s61, s71
    v_mfma_f32_16x16x32_bf16 v[248:251], v[152:155], v[132:135], v[248:251]
    ds_read_b64_tr_b16 v[118:119], v31 offset:2560
    v_mfma_f32_16x16x32_bf16 v[252:255], v[156:159], v[132:135], v[252:255]
    buffer_load_dwordx4 v22, s[40:43], s63 offen offset:0 lds
    v_mfma_f32_16x16x32_bf16 v[228:231], v[156:159], v[128:131], v[228:231]
    v_mfma_f32_16x16x32_bf16 v[204:207], v[156:159], v[124:127], v[204:207]
    v_mfma_f32_16x16x32_bf16 v[180:183], v[156:159], v[120:123], v[180:183]
    s_waitcnt lgkmcnt(0)
    v_mfma_f32_16x16x32_bf16 v[160:163], v[96:99], v[80:83], v[160:163]
    ds_read_b64_tr_b16 v[136:137], v30 offset:12288
    v_and_b32 v14, 7, v0
    v_mfma_f32_16x16x32_bf16 v[184:187], v[96:99], v[84:87], v[184:187]
    ds_read_b64_tr_b16 v[138:139], v30 offset:12800
    v_lshlrev_b32 v14, 10, v14
    v_mfma_f32_16x16x32_bf16 v[208:211], v[96:99], v[88:91], v[208:211]
    buffer_load_dwordx4 v23, s[40:43], s63 offen offset:1024 lds
    v_mfma_f32_16x16x32_bf16 v[232:235], v[96:99], v[92:95], v[232:235]
    ds_read_b128 v[120:123], v29 offset:0
    s_lshl_b32 s69, s60, 6
    v_mfma_f32_16x16x32_bf16 v[236:239], v[100:103], v[92:95], v[236:239]
    ds_read_b128 v[124:127], v29 offset:2048
    s_add_u32 s69, s69, s79
    v_mfma_f32_16x16x32_bf16 v[212:215], v[100:103], v[88:91], v[212:215]
    ds_read_b128 v[128:131], v29 offset:4096
    s_lshl_b32 s69, s69, 7
    v_mfma_f32_16x16x32_bf16 v[188:191], v[100:103], v[84:87], v[188:191]
    ds_read_b128 v[132:135], v29 offset:6144
    s_add_u32 s69, s69, 98304
    v_mfma_f32_16x16x32_bf16 v[164:167], v[100:103], v[80:83], v[164:167]
    buffer_load_dwordx4 v24, s[40:43], s63 offen offset:2048 lds
    v_mfma_f32_16x16x32_bf16 v[168:171], v[104:107], v[80:83], v[168:171]
    ds_read_b64_tr_b16 v[140:141], v31 offset:12288
    s_add_u32 m0, s65, 52224
L_FA_pad2:
    s_cbranch_execz L_FA_pad6
    v_mfma_f32_16x16x32_bf16 v[192:195], v[104:107], v[84:87], v[192:195]
    ds_read_b64_tr_b16 v[142:143], v31 offset:12800
    s_add_u32 s61, s61, 1
    v_mfma_f32_16x16x32_bf16 v[216:219], v[104:107], v[88:91], v[216:219]
    ds_read_b64_tr_b16 v[144:145], v32 offset:12288
    s_mul_i32 s75, s22, 12288
    v_mfma_f32_16x16x32_bf16 v[240:243], v[104:107], v[92:95], v[240:243]
    buffer_load_dwordx4 v25, s[40:43], s63 offen offset:0 lds
    v_mfma_f32_16x16x32_bf16 v[244:247], v[108:111], v[92:95], v[244:247]
    ds_read_b64_tr_b16 v[146:147], v32 offset:12800
    s_add_u32 s75, s75, 163840
    v_mfma_f32_16x16x32_bf16 v[220:223], v[108:111], v[88:91], v[220:223]
    ds_read_b64_tr_b16 v[148:149], v33 offset:12288
    s_lshl_b32 s68, s60, 11
    v_mfma_f32_16x16x32_bf16 v[196:199], v[108:111], v[84:87], v[196:199]
    ds_read_b64_tr_b16 v[150:151], v33 offset:12800
    v_add_u32 v4, s68, v15
    v_mfma_f32_16x16x32_bf16 v[172:175], v[108:111], v[80:83], v[172:175]
    ds_read_b64_tr_b16 v[152:153], v30 offset:14336
    s_add_u32 s68, s68, 122880
    v_mfma_f32_16x16x32_bf16 v[176:179], v[112:115], v[80:83], v[176:179]
    buffer_load_dwordx4 v26, s[40:43], s63 offen offset:1024 lds
    v_mfma_f32_16x16x32_bf16 v[200:203], v[112:115], v[84:87], v[200:203]
    ds_read_b64_tr_b16 v[154:155], v30 offset:14848
    v_add_u32 v5, 1536, v4
    v_mfma_f32_16x16x32_bf16 v[224:227], v[112:115], v[88:91], v[224:227]
    ds_read_b64_tr_b16 v[156:157], v31 offset:14336
    v_lshrrev_b32 v5, 13, v5
    v_mfma_f32_16x16x32_bf16 v[248:251], v[112:115], v[92:95], v[248:251]
    ds_read_b64_tr_b16 v[158:159], v31 offset:14848
    s_cmp_eq_u32 s61, 10
    s_cselect_b32 s61, 0, s61
    v_mfma_f32_16x16x32_bf16 v[252:255], v[116:119], v[92:95], v[252:255]
    buffer_load_dwordx4 v27, s[40:43], s63 offen offset:2048 lds
    v_mfma_f32_16x16x32_bf16 v[228:231], v[116:119], v[88:91], v[228:231]
    v_lshl_add_u32 v5, v5, 26, v4
    v_mfma_f32_16x16x32_bf16 v[204:207], v[116:119], v[84:87], v[204:207]
    v_mfma_f32_16x16x32_bf16 v[180:183], v[116:119], v[80:83], v[180:183]
    s_waitcnt vmcnt(10)
    v_cmp_ne_u32 vcc, s66, v10
    s_cbranch_vccz L_F_f0_ok
    s_mov_b32 s25, 0
L_F_f0_retry:

    buffer_load_dwordx3 v[8:10], v12, s[44:47], 0 offen sc1
    s_add_u32 s25, s25, 1
    s_waitcnt vmcnt(0)
    v_cmp_ne_u32 vcc, s66, v10
    s_cmp_ge_u32 s25, 100000
    s_cbranch_scc1 L_F_f0_ok
    s_cbranch_vccnz L_F_f0_retry
L_F_f0_ok:
    s_waitcnt lgkmcnt(0)
    s_barrier
    v_mfma_f32_16x16x32_bf16 v[160:163], v[136:139], v[120:123], v[160:163]
    buffer_load_dword v11, v14, s[44:47], s69 offen sc1
    v_mfma_f32_16x16x32_bf16 v[184:187], v[136:139], v[124:127], v[184:187]
    ds_read_b64_tr_b16 v[96:97], v30 offset:24576
    ds_read_b64_tr_b16 v[98:99], v30 offset:25088
    v_mfma_f32_16x16x32_bf16 v[208:211], v[136:139], v[128:131], v[208:211]
    ds_read_b128 v[80:83], v28 offset:16384
    ds_read_b128 v[84:87], v28 offset:18432
    v_mfma_f32_16x16x32_bf16 v[232:235], v[136:139], v[132:135], v[232:235]
    s_mov_b32 m0, s68
    v_mfma_f32_16x16x32_bf16 v[236:239], v[140:143], v[132:135], v[236:239]
    buffer_load_dwordx4 v4, s[44:47], s75 offen offset:0 sc1 lds
    v_mfma_f32_16x16x32_bf16 v[212:215], v[140:143], v[128:131], v[212:215]
    ds_read_b128 v[88:91], v28 offset:20480
    ds_read_b128 v[92:95], v28 offset:22528
    v_mfma_f32_16x16x32_bf16 v[188:191], v[140:143], v[124:127], v[188:191]
    ds_read_b64_tr_b16 v[100:101], v31 offset:24576
    ds_read_b64_tr_b16 v[102:103], v31 offset:25088
    v_mfma_f32_16x16x32_bf16 v[164:167], v[140:143], v[120:123], v[164:167]
    s_add_u32 m0, s64, 0
    s_lshl_b32 s62, s61, 7
    v_mfma_f32_16x16x32_bf16 v[168:171], v[144:147], v[120:123], v[168:171]
    buffer_load_dwordx4 v18, s[36:39], s62 offen offset:0 lds
    v_mfma_f32_16x16x32_bf16 v[192:195], v[144:147], v[124:127], v[192:195]
    buffer_load_dwordx4 v19, s[36:39], s62 offen offset:1024 lds
    v_mfma_f32_16x16x32_bf16 v[216:219], v[144:147], v[128:131], v[216:219]
    ds_read_b64_tr_b16 v[104:105], v32 offset:24576
    ds_read_b64_tr_b16 v[106:107], v32 offset:25088
    v_mfma_f32_16x16x32_bf16 v[240:243], v[144:147], v[132:135], v[240:243]
    ds_read_b64_tr_b16 v[108:109], v33 offset:24576
    v_mfma_f32_16x16x32_bf16 v[244:247], v[148:151], v[132:135], v[244:247]
    buffer_load_dwordx4 v20, s[36:39], s62 offen offset:2048 lds
    v_mfma_f32_16x16x32_bf16 v[220:223], v[148:151], v[128:131], v[220:223]
    ds_read_b64_tr_b16 v[110:111], v33 offset:25088
    v_mfma_f32_16x16x32_bf16 v[196:199], v[148:151], v[124:127], v[196:199]
    ds_read_b64_tr_b16 v[112:113], v30 offset:26624
    v_mfma_f32_16x16x32_bf16 v[172:175], v[148:151], v[120:123], v[172:175]
    buffer_load_dwordx4 v21, s[36:39], s62 offen offset:3072 lds
    v_mfma_f32_16x16x32_bf16 v[176:179], v[152:155], v[120:123], v[176:179]
    ds_read_b64_tr_b16 v[114:115], v30 offset:27136
    s_mov_b32 m0, s68
    v_mfma_f32_16x16x32_bf16 v[200:203], v[152:155], v[124:127], v[200:203]
    ds_read_b64_tr_b16 v[116:117], v31 offset:26624
    v_mfma_f32_16x16x32_bf16 v[224:227], v[152:155], v[128:131], v[224:227]
    buffer_load_dwordx4 v5, s[44:47], s75 offen offset:1024 sc1 lds
    v_mfma_f32_16x16x32_bf16 v[248:251], v[152:155], v[132:135], v[248:251]
    ds_read_b64_tr_b16 v[118:119], v31 offset:27136
    s_add_u32 m0, s65, 0
    v_mfma_f32_16x16x32_bf16 v[252:255], v[156:159], v[132:135], v[252:255]
    s_mul_i32 s63, s61, s71
    v_mfma_f32_16x16x32_bf16 v[228:231], v[156:159], v[128:131], v[228:231]
    buffer_load_dwordx4 v22, s[40:43], s63 offen offset:0 lds
    v_mfma_f32_16x16x32_bf16 v[204:207], v[156:159], v[124:127], v[204:207]
    v_mfma_f32_16x16x32_bf16 v[180:183], v[156:159], v[120:123], v[180:183]
    s_waitcnt lgkmcnt(0)
    v_mfma_f32_16x16x32_bf16 v[160:163], v[96:99], v[80:83], v[160:163]
    ds_read_b64_tr_b16 v[136:137], v30 offset:36864
    v_mfma_f32_16x16x32_bf16 v[184:187], v[96:99], v[84:87], v[184:187]
    ds_read_b64_tr_b16 v[138:139], v30 offset:37376
    v_mfma_f32_16x16x32_bf16 v[208:211], v[96:99], v[88:91], v[208:211]
    buffer_load_dwordx4 v23, s[40:43], s63 offen offset:1024 lds
    v_mfma_f32_16x16x32_bf16 v[232:235], v[96:99], v[92:95], v[232:235]
    ds_read_b128 v[120:123], v29 offset:16384
    s_mul_i32 s5, s80, 1280
    v_mfma_f32_16x16x32_bf16 v[236:239], v[100:103], v[92:95], v[236:239]
L_FA_pad3:
    s_cbranch_execz L_FA_pad7
    ds_read_b128 v[124:127], v29 offset:18432
    s_mul_i32 s24, s79, 160
    v_mfma_f32_16x16x32_bf16 v[212:215], v[100:103], v[88:91], v[212:215]
    ds_read_b128 v[128:131], v29 offset:20480
    s_add_u32 s5, s5, s24
    v_mfma_f32_16x16x32_bf16 v[188:191], v[100:103], v[84:87], v[188:191]
    ds_read_b128 v[132:135], v29 offset:22528
    s_mul_i32 s24, s60, 3072
    v_mfma_f32_16x16x32_bf16 v[164:167], v[100:103], v[80:83], v[164:167]
    buffer_load_dwordx4 v24, s[40:43], s63 offen offset:2048 lds
    v_mfma_f32_16x16x32_bf16 v[168:171], v[104:107], v[80:83], v[168:171]
    ds_read_b64_tr_b16 v[140:141], v31 offset:36864
    s_add_u32 m0, s65, 3072
    v_mfma_f32_16x16x32_bf16 v[192:195], v[104:107], v[84:87], v[192:195]
    ds_read_b64_tr_b16 v[142:143], v31 offset:37376
    s_add_u32 s61, s61, 1
    v_mfma_f32_16x16x32_bf16 v[216:219], v[104:107], v[88:91], v[216:219]
    ds_read_b64_tr_b16 v[144:145], v32 offset:36864
    s_add_u32 s24, s24, 131072
    v_mfma_f32_16x16x32_bf16 v[240:243], v[104:107], v[92:95], v[240:243]
    buffer_load_dwordx4 v25, s[40:43], s63 offen offset:0 lds
    v_mfma_f32_16x16x32_bf16 v[244:247], v[108:111], v[92:95], v[244:247]
    ds_read_b64_tr_b16 v[146:147], v32 offset:37376
    v_add_u32 v21, 0, v1
    v_mfma_f32_16x16x32_bf16 v[220:223], v[108:111], v[88:91], v[220:223]
    ds_read_b64_tr_b16 v[148:149], v33 offset:36864
    v_min_u32 v21, 159, v21
    v_mfma_f32_16x16x32_bf16 v[196:199], v[108:111], v[84:87], v[196:199]
    ds_read_b64_tr_b16 v[150:151], v33 offset:37376
    v_mul_u32_u24 v21, 6554, v21
    v_mfma_f32_16x16x32_bf16 v[172:175], v[108:111], v[80:83], v[172:175]
    ds_read_b64_tr_b16 v[152:153], v30 offset:38912
    v_lshrrev_b32 v21, 16, v21
    v_mfma_f32_16x16x32_bf16 v[176:179], v[112:115], v[80:83], v[176:179]
    buffer_load_dwordx4 v26, s[40:43], s63 offen offset:1024 lds
    v_mfma_f32_16x16x32_bf16 v[200:203], v[112:115], v[84:87], v[200:203]
    ds_read_b64_tr_b16 v[154:155], v30 offset:39424
    v_mfma_f32_16x16x32_bf16 v[224:227], v[112:115], v[88:91], v[224:227]
    ds_read_b64_tr_b16 v[156:157], v31 offset:38912
    v_mfma_f32_16x16x32_bf16 v[248:251], v[112:115], v[92:95], v[248:251]
    ds_read_b64_tr_b16 v[158:159], v31 offset:39424
    v_mfma_f32_16x16x32_bf16 v[252:255], v[116:119], v[92:95], v[252:255]
    buffer_load_dwordx4 v27, s[40:43], s63 offen offset:2048 lds
    v_mfma_f32_16x16x32_bf16 v[228:231], v[116:119], v[88:91], v[228:231]
    v_mfma_f32_16x16x32_bf16 v[204:207], v[116:119], v[84:87], v[204:207]
    v_mfma_f32_16x16x32_bf16 v[180:183], v[116:119], v[80:83], v[180:183]
    s_waitcnt vmcnt(12)
    v_cmp_ne_u32 vcc, s66, v11
    s_cbranch_vccz L_F_fw_ok
    s_mov_b32 s25, 0
L_F_fw_retry:

    buffer_load_dword v11, v14, s[44:47], s69 offen sc1
    s_add_u32 s25, s25, 1
    s_waitcnt vmcnt(0)
    v_cmp_ne_u32 vcc, s66, v11
    s_cmp_ge_u32 s25, 100000
    s_cbranch_scc1 L_F_fw_ok
    s_cbranch_vccnz L_F_fw_retry
L_F_fw_ok:
    s_waitcnt lgkmcnt(0)
    s_barrier
    v_mfma_f32_16x16x32_bf16 v[160:163], v[136:139], v[120:123], v[160:163]
    ds_read_b64_tr_b16 v[96:97], v30 offset:49152
    ds_read_b64_tr_b16 v[98:99], v30 offset:49664
    v_mfma_f32_16x16x32_bf16 v[184:187], v[136:139], v[124:127], v[184:187]
    ds_read_b128 v[80:83], v28 offset:32768
    ds_read_b128 v[84:87], v28 offset:34816
    v_mfma_f32_16x16x32_bf16 v[208:211], v[136:139], v[128:131], v[208:211]
    s_add_u32 s81, s76, 0
    s_mul_i32 s67, s74, 192
    s_add_u32 s67, s67, 143360
    v_mfma_f32_16x16x32_bf16 v[232:235], v[136:139], v[132:135], v[232:235]
    buffer_load_dwordx4 a[0:3], v15, s[44:47], s81 offen offset:0 sc1
    v_mfma_f32_16x16x32_bf16 v[236:239], v[140:143], v[132:135], v[236:239]
    ds_read_b128 v[88:91], v28 offset:36864
    ds_read_b128 v[92:95], v28 offset:38912
    v_mfma_f32_16x16x32_bf16 v[212:215], v[140:143], v[128:131], v[212:215]
    v_lshl_add_u32 v14, v3, 3, s67
    v_mul_u32_u24 v18, 1120, v21
    v_mfma_f32_16x16x32_bf16 v[188:191], v[140:143], v[124:127], v[188:191]
    ds_read2_b64 v[22:25], v14 offset0:0 offset1:4
    v_lshrrev_b32 v21, 2, v21
    v_mfma_f32_16x16x32_bf16 v[164:167], v[140:143], v[120:123], v[164:167]
    buffer_load_dwordx4 a[4:7], v15, s[44:47], s81 offen offset:1024 sc1
    v_mfma_f32_16x16x32_bf16 v[168:171], v[144:147], v[120:123], v[168:171]
    ds_read2_b64 v[52:55], v14 offset0:8 offset1:12
    v_mul_u32_u24 v21, 15360, v21
    v_mfma_f32_16x16x32_bf16 v[192:195], v[144:147], v[124:127], v[192:195]
    buffer_load_dwordx4 a[8:11], v15, s[44:47], s81 offen offset:2048 sc1
    v_mfma_f32_16x16x32_bf16 v[216:219], v[144:147], v[128:131], v[216:219]
    ds_read_b64_tr_b16 v[100:101], v31 offset:49152
    ds_read_b64_tr_b16 v[102:103], v31 offset:49664
    v_mfma_f32_16x16x32_bf16 v[240:243], v[144:147], v[132:135], v[240:243]
    ds_read_b64 v[26:27], v14 offset:128
    v_add3_u32 v18, v18, v21, v15
    v_mfma_f32_16x16x32_bf16 v[244:247], v[148:151], v[132:135], v[244:247]
    buffer_load_dwordx4 a[12:15], v15, s[44:47], s81 offen offset:3072 sc1
    v_mfma_f32_16x16x32_bf16 v[220:223], v[148:151], v[128:131], v[220:223]
    ds_read_b64_tr_b16 v[104:105], v32 offset:49152
    ds_read_b64_tr_b16 v[106:107], v32 offset:49664
    v_mfma_f32_16x16x32_bf16 v[196:199], v[148:151], v[124:127], v[196:199]
    ds_read_b64_tr_b16 v[108:109], v33 offset:49152
    ds_read_b64_tr_b16 v[110:111], v33 offset:49664
    v_mfma_f32_16x16x32_bf16 v[172:175], v[148:151], v[120:123], v[172:175]
    ds_read_b64_tr_b16 v[112:113], v30 offset:51200
    ds_read_b64_tr_b16 v[114:115], v30 offset:51712
    v_mfma_f32_16x16x32_bf16 v[176:179], v[152:155], v[120:123], v[176:179]
    ds_read_b64 v[10:11], v14 offset:160
    s_add_u32 s81, s81, 4096
    v_mfma_f32_16x16x32_bf16 v[200:203], v[152:155], v[124:127], v[200:203]
    buffer_load_dwordx4 a[16:19], v15, s[44:47], s81 offen offset:0 sc1
    v_mfma_f32_16x16x32_bf16 v[224:227], v[152:155], v[128:131], v[224:227]
    ds_read_b64_tr_b16 v[116:117], v31 offset:51200
    ds_read_b64_tr_b16 v[118:119], v31 offset:51712
    v_mfma_f32_16x16x32_bf16 v[248:251], v[152:155], v[132:135], v[248:251]
    s_add_u32 s81, s76, 20480
    v_add_u32 v21, 64, v1
    v_min_u32 v21, 159, v21
    v_mfma_f32_16x16x32_bf16 v[252:255], v[156:159], v[132:135], v[252:255]
    buffer_load_dwordx4 a[20:23], v15, s[44:47], s81 offen offset:0 sc1
    v_mfma_f32_16x16x32_bf16 v[228:231], v[156:159], v[128:131], v[228:231]
    buffer_load_dwordx4 a[24:27], v15, s[44:47], s81 offen offset:1024 sc1
    v_mfma_f32_16x16x32_bf16 v[204:207], v[156:159], v[124:127], v[204:207]
    v_mul_u32_u24 v21, 6554, v21
    v_lshrrev_b32 v21, 16, v21
    v_mfma_f32_16x16x32_bf16 v[180:183], v[156:159], v[120:123], v[180:183]
    v_mul_u32_u24 v19, 1120, v21
    v_lshrrev_b32 v21, 2, v21
    s_waitcnt lgkmcnt(0)
    v_mfma_f32_16x16x32_bf16 v[160:163], v[96:99], v[80:83], v[160:163]
    ds_read_b64_tr_b16 v[136:137], v30 offset:61440
    ds_read_b64_tr_b16 v[138:139], v30 offset:61952
    v_mfma_f32_16x16x32_bf16 v[184:187], v[96:99], v[84:87], v[184:187]
    ds_read_b128 v[120:123], v29 offset:32768
    ds_read_b128 v[124:127], v29 offset:34816
    v_mfma_f32_16x16x32_bf16 v[208:211], v[96:99], v[88:91], v[208:211]
    buffer_load_dwordx4 a[28:31], v15, s[44:47], s81 offen offset:2048 sc1
    v_mfma_f32_16x16x32_bf16 v[232:235], v[96:99], v[92:95], v[232:235]
    s_mul_i32 s68, s74, 384
    s_add_u32 s68, s68, 122880
    v_mul_u32_u24 v5, 768, v3
    v_mfma_f32_16x16x32_bf16 v[236:239], v[100:103], v[92:95], v[236:239]
    ds_read_b128 v[128:131], v29 offset:36864
    ds_read_b128 v[132:135], v29 offset:38912
    v_mfma_f32_16x16x32_bf16 v[212:215], v[100:103], v[88:91], v[212:215]
    v_add_u32 v5, s68, v5
    v_add_u32 v7, 6144, v5
    v_mfma_f32_16x16x32_bf16 v[188:191], v[100:103], v[84:87], v[188:191]
L_FA_pad4:
    s_cbranch_execz L_FA_pad8
    buffer_load_dwordx4 a[32:35], v15, s[44:47], s81 offen offset:3072 sc1
    v_mfma_f32_16x16x32_bf16 v[164:167], v[100:103], v[80:83], v[164:167]
    ds_read_b64_tr_b16 v[140:141], v31 offset:61440
    ds_read_b64_tr_b16 v[142:143], v31 offset:61952
    v_mfma_f32_16x16x32_bf16 v[168:171], v[104:107], v[80:83], v[168:171]
    s_add_u32 s81, s81, 4096
    v_min_u32 v7, 130560, v7
    v_lshl_add_u32 v4, v2, 4, v5
    v_mfma_f32_16x16x32_bf16 v[192:195], v[104:107], v[84:87], v[192:195]
    buffer_load_dwordx4 a[36:39], v15, s[44:47], s81 offen offset:0 sc1
    v_mfma_f32_16x16x32_bf16 v[216:219], v[104:107], v[88:91], v[216:219]
    ds_read_b64_tr_b16 v[144:145], v32 offset:61440
    ds_read_b64_tr_b16 v[146:147], v32 offset:61952
    v_mfma_f32_16x16x32_bf16 v[240:243], v[104:107], v[92:95], v[240:243]
    ds_read_b64_tr_b16 v[148:149], v33 offset:61440
    s_add_u32 s81, s76, 40960
    v_mfma_f32_16x16x32_bf16 v[244:247], v[108:111], v[92:95], v[244:247]
    buffer_load_dwordx4 a[40:43], v15, s[44:47], s81 offen offset:0 sc1
    v_mfma_f32_16x16x32_bf16 v[220:223], v[108:111], v[88:91], v[220:223]
    ds_read_b64_tr_b16 v[150:151], v33 offset:61952
    v_lshl_add_u32 v5, v2, 3, v5
    v_mfma_f32_16x16x32_bf16 v[196:199], v[108:111], v[84:87], v[196:199]
    ds_read_b64_tr_b16 v[152:153], v30 offset:63488
    v_lshl_add_u32 v6, v2, 4, v7
    v_mfma_f32_16x16x32_bf16 v[172:175], v[108:111], v[80:83], v[172:175]
    buffer_load_dwordx4 a[44:47], v15, s[44:47], s81 offen offset:1024 sc1
    v_mfma_f32_16x16x32_bf16 v[176:179], v[112:115], v[80:83], v[176:179]
    ds_read_b64_tr_b16 v[154:155], v30 offset:64000
    v_lshl_add_u32 v7, v2, 3, v7
    v_mfma_f32_16x16x32_bf16 v[200:203], v[112:115], v[84:87], v[200:203]
    ds_read_b64_tr_b16 v[156:157], v31 offset:63488
    s_mul_i32 s61, s60, 30720
    v_mfma_f32_16x16x32_bf16 v[224:227], v[112:115], v[88:91], v[224:227]
    buffer_load_dwordx4 a[48:51], v15, s[44:47], s81 offen offset:2048 sc1
    v_mfma_f32_16x16x32_bf16 v[248:251], v[112:115], v[92:95], v[248:251]
    ds_read_b64_tr_b16 v[158:159], v31 offset:64000
    v_mul_u32_u24 v21, 15360, v21
    v_mfma_f32_16x16x32_bf16 v[252:255], v[116:119], v[92:95], v[252:255]
    v_add3_u32 v19, v19, v21, v15
    v_add_u32 v21, 128, v1
    v_mfma_f32_16x16x32_bf16 v[228:231], v[116:119], v[88:91], v[228:231]
    buffer_load_dwordx4 a[52:55], v15, s[44:47], s81 offen offset:3072 sc1
    v_mfma_f32_16x16x32_bf16 v[204:207], v[116:119], v[84:87], v[204:207]
    v_min_u32 v21, 159, v21
    v_mul_u32_u24 v21, 6554, v21
    v_mfma_f32_16x16x32_bf16 v[180:183], v[116:119], v[80:83], v[180:183]
    v_lshrrev_b32 v21, 16, v21
    v_mul_u32_u24 v20, 1120, v21
    v_lshrrev_b32 v21, 2, v21
    v_mul_u32_u24 v21, 15360, v21
    v_add3_u32 v20, v20, v21, v15
    s_waitcnt vmcnt(14) lgkmcnt(0)
    s_barrier
    v_mfma_f32_16x16x32_bf16 v[160:163], v[136:139], v[120:123], v[160:163]
    ds_read_b128 v[34:37], v4 offset:0
    v_mfma_f32_16x16x32_bf16 v[184:187], v[136:139], v[124:127], v[184:187]
    ds_read_b64_tr_b16 v[96:97], v30 offset:0
    ds_read_b64_tr_b16 v[98:99], v30 offset:512
    v_mfma_f32_16x16x32_bf16 v[208:211], v[136:139], v[128:131], v[208:211]
    ds_read_b128 v[80:83], v28 offset:0
    ds_read_b128 v[84:87], v28 offset:2048
    v_mfma_f32_16x16x32_bf16 v[232:235], v[136:139], v[132:135], v[232:235]
    s_add_u32 s81, s81, 4096
    v_mfma_f32_16x16x32_bf16 v[236:239], v[140:143], v[132:135], v[236:239]
    buffer_load_dwordx4 a[56:59], v15, s[44:47], s81 offen offset:0 sc1
    v_mfma_f32_16x16x32_bf16 v[212:215], v[140:143], v[128:131], v[212:215]
    ds_read_b64 v[38:39], v5 offset:256
    s_add_u32 s81, s76, 61440
    v_mfma_f32_16x16x32_bf16 v[188:191], v[140:143], v[124:127], v[188:191]
    buffer_load_dwordx4 a[60:63], v15, s[44:47], s81 offen offset:0 sc1
    v_mfma_f32_16x16x32_bf16 v[164:167], v[140:143], v[120:123], v[164:167]
    ds_read_b128 v[40:43], v4 offset:3072
    v_mfma_f32_16x16x32_bf16 v[168:171], v[144:147], v[120:123], v[168:171]
    ds_read_b128 v[88:91], v28 offset:4096
    ds_read_b128 v[92:95], v28 offset:6144
    v_mfma_f32_16x16x32_bf16 v[192:195], v[144:147], v[124:127], v[192:195]
    buffer_load_dwordx4 a[64:67], v15, s[44:47], s81 offen offset:1024 sc1
    v_mfma_f32_16x16x32_bf16 v[216:219], v[144:147], v[128:131], v[216:219]
    ds_read_b64_tr_b16 v[100:101], v31 offset:0
    ds_read_b64_tr_b16 v[102:103], v31 offset:512
    v_mfma_f32_16x16x32_bf16 v[240:243], v[144:147], v[132:135], v[240:243]
    ds_read_b64 v[44:45], v5 offset:3328
    v_mfma_f32_16x16x32_bf16 v[244:247], v[148:151], v[132:135], v[244:247]
    buffer_load_dwordx4 a[68:71], v15, s[44:47], s81 offen offset:2048 sc1
    v_mfma_f32_16x16x32_bf16 v[220:223], v[148:151], v[128:131], v[220:223]
    ds_read_b64_tr_b16 v[104:105], v32 offset:0
    ds_read_b64_tr_b16 v[106:107], v32 offset:512
    v_mfma_f32_16x16x32_bf16 v[196:199], v[148:151], v[124:127], v[196:199]
    ds_read_b128 v[46:49], v6 offset:0
    v_mfma_f32_16x16x32_bf16 v[172:175], v[148:151], v[120:123], v[172:175]
    buffer_load_dwordx4 a[72:75], v15, s[44:47], s81 offen offset:3072 sc1
    v_mfma_f32_16x16x32_bf16 v[176:179], v[152:155], v[120:123], v[176:179]
    ds_read_b64_tr_b16 v[108:109], v33 offset:0
    ds_read_b64_tr_b16 v[110:111], v33 offset:512
    v_mfma_f32_16x16x32_bf16 v[200:203], v[152:155], v[124:127], v[200:203]
    ds_read_b64_tr_b16 v[112:113], v30 offset:2048
    ds_read_b64_tr_b16 v[114:115], v30 offset:2560
    v_mfma_f32_16x16x32_bf16 v[224:227], v[152:155], v[128:131], v[224:227]
    ds_read_b64 v[50:51], v7 offset:256
    s_add_u32 s81, s81, 4096
    v_mfma_f32_16x16x32_bf16 v[248:251], v[152:155], v[132:135], v[248:251]
    ds_read_b64_tr_b16 v[116:117], v31 offset:2048
    ds_read_b64_tr_b16 v[118:119], v31 offset:2560
    v_mfma_f32_16x16x32_bf16 v[252:255], v[156:159], v[132:135], v[252:255]
    buffer_load_dwordx4 a[76:79], v15, s[44:47], s81 offen offset:0 sc1
    v_mfma_f32_16x16x32_bf16 v[228:231], v[156:159], v[128:131], v[228:231]
    s_add_u32 s81, s76, 81920
    v_mfma_f32_16x16x32_bf16 v[204:207], v[156:159], v[124:127], v[204:207]
    buffer_load_dwordx4 a[80:83], v15, s[44:47], s81 offen offset:0 sc1
    v_mfma_f32_16x16x32_bf16 v[180:183], v[156:159], v[120:123], v[180:183]
    s_waitcnt lgkmcnt(0)
    v_mfma_f32_16x16x32_bf16 v[160:163], v[96:99], v[80:83], v[160:163]
    ds_read_b64_tr_b16 v[136:137], v30 offset:12288
    ds_read_b64_tr_b16 v[138:139], v30 offset:12800
    v_mfma_f32_16x16x32_bf16 v[184:187], v[96:99], v[84:87], v[184:187]
    ds_read_b128 v[120:123], v29 offset:0
    ds_read_b128 v[124:127], v29 offset:2048
    v_mfma_f32_16x16x32_bf16 v[208:211], v[96:99], v[88:91], v[208:211]
    buffer_load_dwordx4 a[84:87], v15, s[44:47], s81 offen offset:1024 sc1
    v_mfma_f32_16x16x32_bf16 v[232:235], v[96:99], v[92:95], v[232:235]
    s_lshl_b32 s67, s73, 8
    s_add_u32 s67, s67, 155648
    v_lshrrev_b32 v6, 2, v2
    v_mfma_f32_16x16x32_bf16 v[236:239], v[100:103], v[92:95], v[236:239]
    ds_write2_b32 v13, v8, v9 offset0:0 offset1:128
    v_mfma_f32_16x16x32_bf16 v[212:215], v[100:103], v[88:91], v[212:215]
    ds_read_b128 v[128:131], v29 offset:4096
    ds_read_b128 v[132:135], v29 offset:6144
    v_mfma_f32_16x16x32_bf16 v[188:191], v[100:103], v[84:87], v[188:191]
    buffer_load_dwordx4 a[88:91], v15, s[44:47], s81 offen offset:2048 sc1
    v_mfma_f32_16x16x32_bf16 v[164:167], v[100:103], v[80:83], v[164:167]
    ds_read_b64_tr_b16 v[140:141], v31 offset:12288
    ds_read_b64_tr_b16 v[142:143], v31 offset:12800
    v_mfma_f32_16x16x32_bf16 v[168:171], v[104:107], v[80:83], v[168:171]
    v_and_b32 v7, 3, v2
    v_lshl_add_u32 v6, v6, 4, v7
    v_mfma_f32_16x16x32_bf16 v[192:195], v[104:107], v[84:87], v[192:195]
    buffer_load_dwordx4 a[92:95], v15, s[44:47], s81 offen offset:3072 sc1
    v_mfma_f32_16x16x32_bf16 v[216:219], v[104:107], v[88:91], v[216:219]
    ds_read_b64_tr_b16 v[144:145], v32 offset:12288
L_FA_pad5:
    s_cbranch_execz L_FA_pad9
    ds_read_b64_tr_b16 v[146:147], v32 offset:12800
    v_mfma_f32_16x16x32_bf16 v[240:243], v[104:107], v[92:95], v[240:243]
    ds_read_b64_tr_b16 v[148:149], v33 offset:12288
    s_add_u32 s81, s81, 4096
    v_mfma_f32_16x16x32_bf16 v[244:247], v[108:111], v[92:95], v[244:247]
    buffer_load_dwordx4 a[96:99], v15, s[44:47], s81 offen offset:0 sc1
    v_mfma_f32_16x16x32_bf16 v[220:223], v[108:111], v[88:91], v[220:223]
    ds_read_b64_tr_b16 v[150:151], v33 offset:12800
    s_add_u32 s81, s76, 102400
    v_mfma_f32_16x16x32_bf16 v[196:199], v[108:111], v[84:87], v[196:199]
    ds_read_b64_tr_b16 v[152:153], v30 offset:14336
    v_lshl_add_u32 v6, v6, 2, s67
    v_mfma_f32_16x16x32_bf16 v[172:175], v[108:111], v[80:83], v[172:175]
    buffer_load_dwordx4 a[100:103], v15, s[44:47], s81 offen offset:0 sc1
    v_mfma_f32_16x16x32_bf16 v[176:179], v[112:115], v[80:83], v[176:179]
    ds_read_b64_tr_b16 v[154:155], v30 offset:14848
    v_add_f32 v34, v34, v40
    v_mfma_f32_16x16x32_bf16 v[200:203], v[112:115], v[84:87], v[200:203]
    ds_read_b64_tr_b16 v[156:157], v31 offset:14336
    v_add_f32 v35, v35, v41
    v_mfma_f32_16x16x32_bf16 v[224:227], v[112:115], v[88:91], v[224:227]
    buffer_load_dwordx4 a[104:107], v15, s[44:47], s81 offen offset:1024 sc1
    v_mfma_f32_16x16x32_bf16 v[248:251], v[112:115], v[92:95], v[248:251]
    ds_read_b64_tr_b16 v[158:159], v31 offset:14848
    v_add_f32 v36, v36, v42
    v_mfma_f32_16x16x32_bf16 v[252:255], v[116:119], v[92:95], v[252:255]
    v_add_f32 v37, v37, v43
    v_add_f32 v38, v38, v44
    v_mfma_f32_16x16x32_bf16 v[228:231], v[116:119], v[88:91], v[228:231]
    buffer_load_dwordx4 a[108:111], v15, s[44:47], s81 offen offset:2048 sc1
    v_mfma_f32_16x16x32_bf16 v[204:207], v[116:119], v[84:87], v[204:207]
    v_add_f32 v39, v39, v45
    v_add_f32 v34, v34, v46
    v_mfma_f32_16x16x32_bf16 v[180:183], v[116:119], v[80:83], v[180:183]
    v_add_f32 v35, v35, v47
    v_add_f32 v36, v36, v48
    v_add_f32 v37, v37, v49
    v_add_f32 v38, v38, v50
    v_add_f32 v39, v39, v51
    v_and_b32 v12, 0xffff0000, v34
    v_sub_f32 v34, v34, v12
    v_cvt_pk_bf16_f32 v34, v12, v34
    v_and_b32 v12, 0xffff0000, v35
    v_sub_f32 v35, v35, v12
    v_cvt_pk_bf16_f32 v35, v12, v35
    v_and_b32 v12, 0xffff0000, v36
    v_sub_f32 v36, v36, v12
    v_cvt_pk_bf16_f32 v36, v12, v36
    v_and_b32 v12, 0xffff0000, v37
    v_sub_f32 v37, v37, v12
    v_cvt_pk_bf16_f32 v37, v12, v37
    v_and_b32 v12, 0xffff0000, v38
    v_sub_f32 v38, v38, v12
    v_cvt_pk_bf16_f32 v38, v12, v38
    v_and_b32 v12, 0xffff0000, v39
    v_sub_f32 v39, v39, v12
    v_cvt_pk_bf16_f32 v39, v12, v39
    s_waitcnt lgkmcnt(0)
    s_barrier
    v_mfma_f32_16x16x32_bf16 v[160:163], v[136:139], v[120:123], v[160:163]
    ds_read2_b32 v[80:81], v6 offset0:0 offset1:128
    v_lshlrev_b32 v88, 16, v22
    v_mfma_f32_16x16x32_bf16 v[184:187], v[136:139], v[124:127], v[184:187]
    s_mov_b32 m0, s24
    v_and_b32 v89, 0xffff0000, v22
    v_lshlrev_b32 v90, 16, v23
    v_mfma_f32_16x16x16_bf16 v[56:59], v[34:35], a[244:245], 0
    buffer_load_dwordx4 v18, s[36:39], s5 offen offset:0 lds
    v_mfma_f32_16x16x32_bf16 v[208:211], v[136:139], v[128:131], v[208:211]
    v_and_b32 v91, 0xffff0000, v23
    v_lshlrev_b32 v92, 16, v24
    v_mfma_f32_16x16x32_bf16 v[232:235], v[136:139], v[132:135], v[232:235]
    buffer_load_dwordx4 a[112:115], v15, s[44:47], s81 offen offset:3072 sc1
    v_mfma_f32_16x16x16_bf16 v[60:63], v[34:35], a[246:247], 0
    ds_read2_b32 v[82:83], v6 offset0:4 offset1:132
    s_add_u32 s81, s81, 4096
    v_mfma_f32_16x16x32_bf16 v[236:239], v[140:143], v[132:135], v[236:239]
    v_and_b32 v93, 0xffff0000, v24
    v_lshlrev_b32 v94, 16, v25
    v_mfma_f32_16x16x32_bf16 v[212:215], v[140:143], v[128:131], v[212:215]
    v_and_b32 v95, 0xffff0000, v25
    v_lshlrev_b32 v96, 16, v52
    v_mfma_f32_16x16x16_bf16 v[64:67], v[36:37], a[244:245], 0
    v_and_b32 v97, 0xffff0000, v52
    v_lshlrev_b32 v98, 16, v53
    v_mfma_f32_16x16x32_bf16 v[188:191], v[140:143], v[124:127], v[188:191]
    v_and_b32 v99, 0xffff0000, v53
    v_lshlrev_b32 v100, 16, v54
    v_mfma_f32_16x16x32_bf16 v[164:167], v[140:143], v[120:123], v[164:167]
    v_and_b32 v101, 0xffff0000, v54
    v_lshlrev_b32 v102, 16, v55
    v_mfma_f32_16x16x16_bf16 v[68:71], v[36:37], a[246:247], 0
    buffer_load_dwordx4 a[116:119], v15, s[44:47], s81 offen offset:0 sc1
    v_mfma_f32_16x16x32_bf16 v[168:171], v[144:147], v[120:123], v[168:171]
    buffer_load_dwordx4 v19, s[36:39], s5 offen offset:1024 lds
    v_mfma_f32_16x16x32_bf16 v[192:195], v[144:147], v[124:127], v[192:195]
    ds_read2_b32 v[84:85], v6 offset0:8 offset1:136
    s_add_u32 s81, s76, 122880
    v_mfma_f32_16x16x16_bf16 v[72:75], v[38:39], a[244:245], 0
    v_and_b32 v103, 0xffff0000, v55
    v_lshlrev_b32 v104, 16, v26
    v_mfma_f32_16x16x32_bf16 v[216:219], v[144:147], v[128:131], v[216:219]
    v_and_b32 v105, 0xffff0000, v26
    v_lshlrev_b32 v106, 16, v27
    v_mfma_f32_16x16x32_bf16 v[240:243], v[144:147], v[132:135], v[240:243]
    v_and_b32 v107, 0xffff0000, v27
    v_lshlrev_b32 v108, 16, v10
    v_mfma_f32_16x16x16_bf16 v[76:79], v[38:39], a[246:247], 0
    buffer_load_dwordx4 a[120:123], v15, s[44:47], s81 offen offset:0 sc1
    v_mfma_f32_16x16x32_bf16 v[244:247], v[148:151], v[132:135], v[244:247]
    ds_read2_b32 v[86:87], v6 offset0:12 offset1:140
    v_and_b32 v109, 0xffff0000, v10
    v_mfma_f32_16x16x32_bf16 v[220:223], v[148:151], v[128:131], v[220:223]
    v_lshlrev_b32 v110, 16, v11
    v_and_b32 v111, 0xffff0000, v11
    v_mfma_f32_16x16x32_bf16 v[196:199], v[148:151], v[124:127], v[196:199]
    v_mfma_f32_16x16x32_bf16 v[172:175], v[148:151], v[120:123], v[172:175]
    buffer_load_dwordx4 v20, s[36:39], s5 offen offset:2048 lds
    v_mfma_f32_16x16x32_bf16 v[176:179], v[152:155], v[120:123], v[176:179]
    v_mfma_f32_16x16x32_bf16 v[200:203], v[152:155], v[124:127], v[200:203]
    v_mfma_f32_16x16x32_bf16 v[224:227], v[152:155], v[128:131], v[224:227]
    buffer_load_dwordx4 a[124:127], v15, s[44:47], s81 offen offset:1024 sc1
    v_mfma_f32_16x16x32_bf16 v[248:251], v[152:155], v[132:135], v[248:251]
    v_mfma_f32_16x16x32_bf16 v[252:255], v[156:159], v[132:135], v[252:255]
    v_mfma_f32_16x16x32_bf16 v[228:231], v[156:159], v[128:131], v[228:231]
    v_mfma_f32_16x16x32_bf16 v[204:207], v[156:159], v[124:127], v[204:207]
    v_mfma_f32_16x16x32_bf16 v[180:183], v[156:159], v[120:123], v[180:183]
    s_mul_i32 s67, s3, 192
    s_lshl1_add_u32 s68, s22, s74
    s_add_u32 s67, s67, s68
    s_lshl1_add_u32 s67, s67, s73
    s_lshl_b32 s67, s67, 11
    s_add_u32 s4, s67, 5242880
    v_mov_b32 v18, 0xbdd2d3e8
    v_mov_b32 v19, 0xc0135761
    s_waitcnt lgkmcnt(1)
    v_pk_fma_f32 v[28:29], v[84:85], v[56:57], v[88:89] op_sel:[1,0,0] op_sel_hi:[1,1,1] neg_lo:[1,0,0] neg_hi:[1,0,0]
    v_pk_fma_f32 v[30:31], v[84:85], v[58:59], v[90:91] op_sel:[1,0,0] op_sel_hi:[1,1,1] neg_lo:[1,0,0] neg_hi:[1,0,0]
    v_pk_fma_f32 v[32:33], v[84:85], v[60:61], v[92:93] op_sel:[1,0,0] op_sel_hi:[1,1,1] neg_lo:[1,0,0] neg_hi:[1,0,0]
    v_pk_fma_f32 v[34:35], v[84:85], v[62:63], v[94:95] op_sel:[1,0,0] op_sel_hi:[1,1,1] neg_lo:[1,0,0] neg_hi:[1,0,0]
    v_pk_fma_f32 v[208:209], v[84:85], v[208:209], v[28:29] op_sel:[0,0,0] op_sel_hi:[0,1,1]
    v_pk_fma_f32 v[210:211], v[84:85], v[210:211], v[30:31] op_sel:[0,0,0] op_sel_hi:[0,1,1]
    v_pk_fma_f32 v[212:213], v[84:85], v[212:213], v[32:33] op_sel:[0,0,0] op_sel_hi:[0,1,1]
    v_pk_fma_f32 v[214:215], v[84:85], v[214:215], v[34:35] op_sel:[0,0,0] op_sel_hi:[0,1,1]
    v_pk_mul_f32 v[28:29], v[208:209], v[208:209]
    buffer_load_dwordx4 a[128:131], v15, s[44:47], s81 offen offset:2048 sc1
    v_pk_mul_f32 v[30:31], v[210:211], v[210:211]
    v_pk_mul_f32 v[32:33], v[212:213], v[212:213]
    v_pk_mul_f32 v[34:35], v[214:215], v[214:215]
    v_pk_fma_f32 v[28:29], v[28:29], v[18:19], v[18:19] op_sel:[0,0,1] op_sel_hi:[1,0,1]
    v_pk_fma_f32 v[30:31], v[30:31], v[18:19], v[18:19] op_sel:[0,0,1] op_sel_hi:[1,0,1]
    v_pk_fma_f32 v[32:33], v[32:33], v[18:19], v[18:19] op_sel:[0,0,1] op_sel_hi:[1,0,1]
    v_pk_fma_f32 v[34:35], v[34:35], v[18:19], v[18:19] op_sel:[0,0,1] op_sel_hi:[1,0,1]
    v_pk_mul_f32 v[28:29], v[28:29], v[208:209]
    s_nop 0
L_FA_pad6:
    s_cbranch_execz L_FA_pad10
    v_pk_mul_f32 v[30:31], v[30:31], v[210:211]
    v_pk_mul_f32 v[32:33], v[32:33], v[212:213]
    v_pk_mul_f32 v[34:35], v[34:35], v[214:215]
    v_exp_f32 v36, v28
    v_exp_f32 v37, v29
    v_exp_f32 v38, v30
    v_exp_f32 v39, v31
    v_exp_f32 v40, v32
    v_exp_f32 v41, v33
    v_exp_f32 v42, v34
    buffer_load_dwordx4 a[132:135], v15, s[44:47], s81 offen offset:3072 sc1
    v_exp_f32 v43, v35
    v_pk_add_f32 v[36:37], v[36:37], 1.0 op_sel_hi:[1,0]
    v_pk_add_f32 v[38:39], v[38:39], 1.0 op_sel_hi:[1,0]
    v_pk_add_f32 v[40:41], v[40:41], 1.0 op_sel_hi:[1,0]
    v_pk_add_f32 v[42:43], v[42:43], 1.0 op_sel_hi:[1,0]
    v_rcp_f32 v36, v36
    v_rcp_f32 v37, v37
    v_rcp_f32 v38, v38
    v_rcp_f32 v39, v39
    v_rcp_f32 v40, v40
    v_rcp_f32 v41, v41
    v_rcp_f32 v42, v42
    v_rcp_f32 v43, v43
    v_pk_mul_f32 v[208:209], v[208:209], v[36:37]
    v_pk_mul_f32 v[210:211], v[210:211], v[38:39]
    v_pk_mul_f32 v[212:213], v[212:213], v[40:41]
    v_pk_mul_f32 v[214:215], v[214:215], v[42:43]
    v_cvt_pk_bf16_f32 v20, v208, v209
    s_add_u32 s81, s81, 4096
    buffer_load_dwordx4 a[136:139], v15, s[44:47], s81 offen offset:0 sc1
    v_cvt_pk_bf16_f32 v21, v210, v211
    v_cvt_pk_bf16_f32 v22, v212, v213
    v_cvt_pk_bf16_f32 v23, v214, v215
    s_add_u32 s24, s4, 393216
    buffer_store_dwordx4 v[20:23], v15, s[44:47], s24 offen offset:0 sc1
    s_waitcnt lgkmcnt(0)
    s_nop 0
    v_pk_fma_f32 v[28:29], v[86:87], v[56:57], v[88:89] op_sel:[1,0,0] op_sel_hi:[1,1,1] neg_lo:[1,0,0] neg_hi:[1,0,0]
    v_pk_fma_f32 v[30:31], v[86:87], v[58:59], v[90:91] op_sel:[1,0,0] op_sel_hi:[1,1,1] neg_lo:[1,0,0] neg_hi:[1,0,0]
    v_pk_fma_f32 v[32:33], v[86:87], v[60:61], v[92:93] op_sel:[1,0,0] op_sel_hi:[1,1,1] neg_lo:[1,0,0] neg_hi:[1,0,0]
    v_pk_fma_f32 v[34:35], v[86:87], v[62:63], v[94:95] op_sel:[1,0,0] op_sel_hi:[1,1,1] neg_lo:[1,0,0] neg_hi:[1,0,0]
    v_pk_fma_f32 v[232:233], v[86:87], v[232:233], v[28:29] op_sel:[0,0,0] op_sel_hi:[0,1,1]
    v_pk_fma_f32 v[234:235], v[86:87], v[234:235], v[30:31] op_sel:[0,0,0] op_sel_hi:[0,1,1]
    v_pk_fma_f32 v[236:237], v[86:87], v[236:237], v[32:33] op_sel:[0,0,0] op_sel_hi:[0,1,1]
    v_pk_fma_f32 v[238:239], v[86:87], v[238:239], v[34:35] op_sel:[0,0,0] op_sel_hi:[0,1,1]
    v_pk_mul_f32 v[28:29], v[232:233], v[232:233]
    v_pk_mul_f32 v[30:31], v[234:235], v[234:235]
    v_pk_mul_f32 v[32:33], v[236:237], v[236:237]
    v_pk_mul_f32 v[34:35], v[238:239], v[238:239]
    v_pk_fma_f32 v[28:29], v[28:29], v[18:19], v[18:19] op_sel:[0,0,1] op_sel_hi:[1,0,1]
    s_add_u32 s81, s76, 143360
    buffer_load_dwordx4 a[140:143], v15, s[44:47], s81 offen offset:0 sc1
    v_pk_fma_f32 v[30:31], v[30:31], v[18:19], v[18:19] op_sel:[0,0,1] op_sel_hi:[1,0,1]
    v_pk_fma_f32 v[32:33], v[32:33], v[18:19], v[18:19] op_sel:[0,0,1] op_sel_hi:[1,0,1]
    v_pk_fma_f32 v[34:35], v[34:35], v[18:19], v[18:19] op_sel:[0,0,1] op_sel_hi:[1,0,1]
    v_pk_mul_f32 v[28:29], v[28:29], v[232:233]
    v_pk_mul_f32 v[30:31], v[30:31], v[234:235]
    v_pk_mul_f32 v[32:33], v[32:33], v[236:237]
    v_pk_mul_f32 v[34:35], v[34:35], v[238:239]
    v_exp_f32 v36, v28
    v_exp_f32 v37, v29
    v_exp_f32 v38, v30
    v_exp_f32 v39, v31
    v_exp_f32 v40, v32
    v_exp_f32 v41, v33
    v_exp_f32 v42, v34
    v_exp_f32 v43, v35
    v_pk_add_f32 v[36:37], v[36:37], 1.0 op_sel_hi:[1,0]
    v_pk_add_f32 v[38:39], v[38:39], 1.0 op_sel_hi:[1,0]
    v_pk_add_f32 v[40:41], v[40:41], 1.0 op_sel_hi:[1,0]
    buffer_load_dwordx4 a[144:147], v15, s[44:47], s81 offen offset:1024 sc1
    v_pk_add_f32 v[42:43], v[42:43], 1.0 op_sel_hi:[1,0]
    v_rcp_f32 v36, v36
    v_rcp_f32 v37, v37
    v_rcp_f32 v38, v38
    v_rcp_f32 v39, v39
    v_rcp_f32 v40, v40
    v_rcp_f32 v41, v41
    v_rcp_f32 v42, v42
    v_rcp_f32 v43, v43
    v_pk_mul_f32 v[232:233], v[232:233], v[36:37]
    v_pk_mul_f32 v[234:235], v[234:235], v[38:39]
    v_pk_mul_f32 v[236:237], v[236:237], v[40:41]
    v_pk_mul_f32 v[238:239], v[238:239], v[42:43]
    v_cvt_pk_bf16_f32 v44, v232, v233
    v_cvt_pk_bf16_f32 v45, v234, v235
    v_cvt_pk_bf16_f32 v46, v236, v237
    v_cvt_pk_bf16_f32 v47, v238, v239
    buffer_store_dwordx4 v[44:47], v15, s[44:47], s24 offen offset:1024 sc1
    buffer_load_dwordx4 a[148:151], v15, s[44:47], s81 offen offset:2048 sc1
    v_pk_fma_f32 v[28:29], v[84:85], v[64:65], v[96:97] op_sel:[1,0,0] op_sel_hi:[1,1,1] neg_lo:[1,0,0] neg_hi:[1,0,0]
    v_pk_fma_f32 v[30:31], v[84:85], v[66:67], v[98:99] op_sel:[1,0,0] op_sel_hi:[1,1,1] neg_lo:[1,0,0] neg_hi:[1,0,0]
    v_pk_fma_f32 v[32:33], v[84:85], v[68:69], v[100:101] op_sel:[1,0,0] op_sel_hi:[1,1,1] neg_lo:[1,0,0] neg_hi:[1,0,0]
    v_pk_fma_f32 v[34:35], v[84:85], v[70:71], v[102:103] op_sel:[1,0,0] op_sel_hi:[1,1,1] neg_lo:[1,0,0] neg_hi:[1,0,0]
    v_pk_fma_f32 v[216:217], v[84:85], v[216:217], v[28:29] op_sel:[0,0,0] op_sel_hi:[0,1,1]
    v_pk_fma_f32 v[218:219], v[84:85], v[218:219], v[30:31] op_sel:[0,0,0] op_sel_hi:[0,1,1]
    v_pk_fma_f32 v[220:221], v[84:85], v[220:221], v[32:33] op_sel:[0,0,0] op_sel_hi:[0,1,1]
    v_pk_fma_f32 v[222:223], v[84:85], v[222:223], v[34:35] op_sel:[0,0,0] op_sel_hi:[0,1,1]
    v_pk_mul_f32 v[28:29], v[216:217], v[216:217]
    v_pk_mul_f32 v[30:31], v[218:219], v[218:219]
    v_pk_mul_f32 v[32:33], v[220:221], v[220:221]
    v_pk_mul_f32 v[34:35], v[222:223], v[222:223]
    v_pk_fma_f32 v[28:29], v[28:29], v[18:19], v[18:19] op_sel:[0,0,1] op_sel_hi:[1,0,1]
    v_pk_fma_f32 v[30:31], v[30:31], v[18:19], v[18:19] op_sel:[0,0,1] op_sel_hi:[1,0,1]
    v_pk_fma_f32 v[32:33], v[32:33], v[18:19], v[18:19] op_sel:[0,0,1] op_sel_hi:[1,0,1]
    v_pk_fma_f32 v[34:35], v[34:35], v[18:19], v[18:19] op_sel:[0,0,1] op_sel_hi:[1,0,1]
    v_pk_mul_f32 v[28:29], v[28:29], v[216:217]
    v_pk_mul_f32 v[30:31], v[30:31], v[218:219]
    buffer_load_dwordx4 a[152:155], v15, s[44:47], s81 offen offset:3072 sc1
    v_pk_mul_f32 v[32:33], v[32:33], v[220:221]
    v_pk_mul_f32 v[34:35], v[34:35], v[222:223]
    v_exp_f32 v36, v28
    v_exp_f32 v37, v29
    v_exp_f32 v38, v30
    v_exp_f32 v39, v31
    v_exp_f32 v40, v32
    v_exp_f32 v41, v33
    v_exp_f32 v42, v34
    v_exp_f32 v43, v35
    v_pk_add_f32 v[36:37], v[36:37], 1.0 op_sel_hi:[1,0]
    v_pk_add_f32 v[38:39], v[38:39], 1.0 op_sel_hi:[1,0]
    v_pk_add_f32 v[40:41], v[40:41], 1.0 op_sel_hi:[1,0]
    v_pk_add_f32 v[42:43], v[42:43], 1.0 op_sel_hi:[1,0]
L_FA_pad7:
    s_cbranch_execz L_FA_ret
    v_rcp_f32 v36, v36
    v_rcp_f32 v37, v37
    v_rcp_f32 v38, v38
    v_rcp_f32 v39, v39
    s_add_u32 s81, s81, 4096
    buffer_load_dwordx4 a[156:159], v15, s[44:47], s81 offen offset:0 sc1
    v_rcp_f32 v40, v40
    v_rcp_f32 v41, v41
    v_rcp_f32 v42, v42
    v_rcp_f32_e64 v43, v43
    v_pk_mul_f32 v[216:217], v[216:217], v[36:37]
    v_pk_mul_f32 v[218:219], v[218:219], v[38:39]
    v_pk_mul_f32 v[220:221], v[220:221], v[40:41]
    v_pk_mul_f32 v[222:223], v[222:223], v[42:43]
    v_cvt_pk_bf16_f32 v20, v216, v217
    v_cvt_pk_bf16_f32 v21, v218, v219
    v_cvt_pk_bf16_f32 v22, v220, v221
    v_cvt_pk_bf16_f32 v23, v222, v223
    s_add_u32 s24, s4, 466944
    buffer_store_dwordx4 v[20:23], v15, s[44:47], s24 offen offset:0 sc1
    v_pk_fma_f32 v[28:29], v[86:87], v[64:65], v[96:97] op_sel:[1,0,0] op_sel_hi:[1,1,1] neg_lo:[1,0,0] neg_hi:[1,0,0]
    v_pk_fma_f32 v[30:31], v[86:87], v[66:67], v[98:99] op_sel:[1,0,0] op_sel_hi:[1,1,1] neg_lo:[1,0,0] neg_hi:[1,0,0]
    v_pk_fma_f32 v[32:33], v[86:87], v[68:69], v[100:101] op_sel:[1,0,0] op_sel_hi:[1,1,1] neg_lo:[1,0,0] neg_hi:[1,0,0]
    v_pk_fma_f32 v[34:35], v[86:87], v[70:71], v[102:103] op_sel:[1,0,0] op_sel_hi:[1,1,1] neg_lo:[1,0,0] neg_hi:[1,0,0]
    s_add_u32 s81, s76, 163840
    buffer_load_dwordx4 a[160:163], v15, s[44:47], s81 offen offset:0 sc1
    v_pk_fma_f32 v[240:241], v[86:87], v[240:241], v[28:29] op_sel:[0,0,0] op_sel_hi:[0,1,1]
    v_pk_fma_f32 v[242:243], v[86:87], v[242:243], v[30:31] op_sel:[0,0,0] op_sel_hi:[0,1,1]
    v_pk_fma_f32 v[244:245], v[86:87], v[244:245], v[32:33] op_sel:[0,0,0] op_sel_hi:[0,1,1]
    v_pk_fma_f32 v[246:247], v[86:87], v[246:247], v[34:35] op_sel:[0,0,0] op_sel_hi:[0,1,1]
    v_pk_mul_f32 v[28:29], v[240:241], v[240:241]
    v_pk_mul_f32 v[30:31], v[242:243], v[242:243]
    v_pk_mul_f32 v[32:33], v[244:245], v[244:245]
    v_pk_mul_f32 v[34:35], v[246:247], v[246:247]
    v_pk_fma_f32 v[28:29], v[28:29], v[18:19], v[18:19] op_sel:[0,0,1] op_sel_hi:[1,0,1]
    v_pk_fma_f32 v[30:31], v[30:31], v[18:19], v[18:19] op_sel:[0,0,1] op_sel_hi:[1,0,1]
    v_pk_fma_f32 v[32:33], v[32:33], v[18:19], v[18:19] op_sel:[0,0,1] op_sel_hi:[1,0,1]
    v_pk_fma_f32 v[34:35], v[34:35], v[18:19], v[18:19] op_sel:[0,0,1] op_sel_hi:[1,0,1]
    v_pk_mul_f32 v[28:29], v[28:29], v[240:241]
    v_pk_mul_f32 v[30:31], v[30:31], v[242:243]
    v_pk_mul_f32 v[32:33], v[32:33], v[244:245]
    v_pk_mul_f32 v[34:35], v[34:35], v[246:247]
    v_exp_f32 v36, v28
    v_exp_f32 v37, v29
    buffer_load_dwordx4 a[164:167], v15, s[44:47], s81 offen offset:1024 sc1
    v_exp_f32 v38, v30
    v_exp_f32 v39, v31
    v_exp_f32 v40, v32
    v_exp_f32 v41, v33
    v_exp_f32 v42, v34
    v_exp_f32 v43, v35
    v_pk_add_f32 v[36:37], v[36:37], 1.0 op_sel_hi:[1,0]
    v_pk_add_f32 v[38:39], v[38:39], 1.0 op_sel_hi:[1,0]
    v_pk_add_f32 v[40:41], v[40:41], 1.0 op_sel_hi:[1,0]
    v_pk_add_f32 v[42:43], v[42:43], 1.0 op_sel_hi:[1,0]
    v_rcp_f32 v36, v36
    v_rcp_f32 v37, v37
    v_rcp_f32 v38, v38
    v_rcp_f32 v39, v39
    v_rcp_f32 v40, v40
    v_rcp_f32 v41, v41
    v_rcp_f32 v42, v42
    v_rcp_f32 v43, v43
    buffer_load_dwordx4 a[168:171], v15, s[44:47], s81 offen offset:2048 sc1
    v_pk_mul_f32 v[240:241], v[240:241], v[36:37]
    v_pk_mul_f32 v[242:243], v[242:243], v[38:39]
    v_pk_mul_f32 v[244:245], v[244:245], v[40:41]
    v_pk_mul_f32 v[246:247], v[246:247], v[42:43]
    v_cvt_pk_bf16_f32 v44, v240, v241
    v_cvt_pk_bf16_f32 v45, v242, v243
    v_cvt_pk_bf16_f32 v46, v244, v245
    v_cvt_pk_bf16_f32 v47, v246, v247
    buffer_store_dwordx4 v[44:47], v15, s[44:47], s24 offen offset:1024 sc1
    v_pk_fma_f32 v[28:29], v[84:85], v[72:73], v[104:105] op_sel:[1,0,0] op_sel_hi:[1,1,1] neg_lo:[1,0,0] neg_hi:[1,0,0]
    v_pk_fma_f32 v[30:31], v[84:85], v[74:75], v[106:107] op_sel:[1,0,0] op_sel_hi:[1,1,1] neg_lo:[1,0,0] neg_hi:[1,0,0]
    v_pk_fma_f32 v[32:33], v[84:85], v[76:77], v[108:109] op_sel:[1,0,0] op_sel_hi:[1,1,1] neg_lo:[1,0,0] neg_hi:[1,0,0]
    v_pk_fma_f32 v[34:35], v[84:85], v[78:79], v[110:111] op_sel:[1,0,0] op_sel_hi:[1,1,1] neg_lo:[1,0,0] neg_hi:[1,0,0]
    v_pk_fma_f32 v[224:225], v[84:85], v[224:225], v[28:29] op_sel:[0,0,0] op_sel_hi:[0,1,1]
    v_pk_fma_f32 v[226:227], v[84:85], v[226:227], v[30:31] op_sel:[0,0,0] op_sel_hi:[0,1,1]
    v_pk_fma_f32 v[228:229], v[84:85], v[228:229], v[32:33] op_sel:[0,0,0] op_sel_hi:[0,1,1]
    v_pk_fma_f32 v[230:231], v[84:85], v[230:231], v[34:35] op_sel:[0,0,0] op_sel_hi:[0,1,1]
    v_pk_mul_f32 v[28:29], v[224:225], v[224:225]
    buffer_load_dwordx4 a[172:175], v15, s[44:47], s81 offen offset:3072 sc1
    v_pk_mul_f32 v[30:31], v[226:227], v[226:227]
    v_pk_mul_f32 v[32:33], v[228:229], v[228:229]
    v_pk_mul_f32 v[34:35], v[230:231], v[230:231]
    v_pk_fma_f32 v[28:29], v[28:29], v[18:19], v[18:19] op_sel:[0,0,1] op_sel_hi:[1,0,1]
    v_pk_fma_f32 v[30:31], v[30:31], v[18:19], v[18:19] op_sel:[0,0,1] op_sel_hi:[1,0,1]
    v_pk_fma_f32 v[32:33], v[32:33], v[18:19], v[18:19] op_sel:[0,0,1] op_sel_hi:[1,0,1]
    v_pk_fma_f32 v[34:35], v[34:35], v[18:19], v[18:19] op_sel:[0,0,1] op_sel_hi:[1,0,1]
    v_pk_mul_f32 v[28:29], v[28:29], v[224:225]
    v_pk_mul_f32 v[30:31], v[30:31], v[226:227]
    v_pk_mul_f32 v[32:33], v[32:33], v[228:229]
    v_pk_mul_f32 v[34:35], v[34:35], v[230:231]
    v_exp_f32 v36, v28
    v_exp_f32 v37, v29
    v_exp_f32 v38, v30
    v_exp_f32 v39, v31
    v_exp_f32 v40, v32
    v_exp_f32 v41, v33
    v_exp_f32 v42, v34
    s_add_u32 s81, s81, 4096
    buffer_load_dwordx4 a[176:179], v15, s[44:47], s81 offen offset:0 sc1
    v_exp_f32 v43, v35
    v_pk_add_f32 v[36:37], v[36:37], 1.0 op_sel_hi:[1,0]
    v_pk_add_f32 v[38:39], v[38:39], 1.0 op_sel_hi:[1,0]
    v_pk_add_f32 v[40:41], v[40:41], 1.0 op_sel_hi:[1,0]
    v_pk_add_f32 v[42:43], v[42:43], 1.0 op_sel_hi:[1,0]
    v_rcp_f32 v36, v36
    v_rcp_f32 v37, v37
    v_rcp_f32 v38, v38
    v_rcp_f32 v39, v39
    v_rcp_f32 v40, v40
    v_rcp_f32 v41, v41
    v_rcp_f32 v42, v42
    v_rcp_f32 v43, v43
    v_pk_mul_f32 v[224:225], v[224:225], v[36:37]
    v_pk_mul_f32 v[226:227], v[226:227], v[38:39]
    v_pk_mul_f32 v[228:229], v[228:229], v[40:41]
    v_pk_mul_f32 v[230:231], v[230:231], v[42:43]
    v_cvt_pk_bf16_f32 v20, v224, v225
    s_add_u32 s81, s76, 184320
    buffer_load_dwordx4 a[180:183], v15, s[44:47], s81 offen offset:0 sc1
    v_cvt_pk_bf16_f32 v21, v226, v227
    v_cvt_pk_bf16_f32 v22, v228, v229
    v_cvt_pk_bf16_f32 v23, v230, v231
    s_add_u32 s24, s4, 540672
    buffer_store_dwordx4 v[20:23], v15, s[44:47], s24 offen offset:0 sc1
    v_pk_fma_f32 v[28:29], v[86:87], v[72:73], v[104:105] op_sel:[1,0,0] op_sel_hi:[1,1,1] neg_lo:[1,0,0] neg_hi:[1,0,0]
    v_pk_fma_f32 v[30:31], v[86:87], v[74:75], v[106:107] op_sel:[1,0,0] op_sel_hi:[1,1,1] neg_lo:[1,0,0] neg_hi:[1,0,0]
    v_pk_fma_f32 v[32:33], v[86:87], v[76:77], v[108:109] op_sel:[1,0,0] op_sel_hi:[1,1,1] neg_lo:[1,0,0] neg_hi:[1,0,0]
    v_pk_fma_f32 v[34:35], v[86:87], v[78:79], v[110:111] op_sel:[1,0,0] op_sel_hi:[1,1,1] neg_lo:[1,0,0] neg_hi:[1,0,0]
    v_pk_fma_f32 v[248:249], v[86:87], v[248:249], v[28:29] op_sel:[0,0,0] op_sel_hi:[0,1,1]
    v_pk_fma_f32 v[250:251], v[86:87], v[250:251], v[30:31] op_sel:[0,0,0] op_sel_hi:[0,1,1]
    v_pk_fma_f32 v[252:253], v[86:87], v[252:253], v[32:33] op_sel:[0,0,0] op_sel_hi:[0,1,1]
    v_pk_fma_f32 v[254:255], v[86:87], v[254:255], v[34:35] op_sel:[0,0,0] op_sel_hi:[0,1,1]
    v_pk_mul_f32 v[28:29], v[248:249], v[248:249]
    v_pk_mul_f32 v[30:31], v[250:251], v[250:251]
    v_pk_mul_f32 v[32:33], v[252:253], v[252:253]
    v_pk_mul_f32 v[34:35], v[254:255], v[254:255]
    v_pk_fma_f32 v[28:29], v[28:29], v[18:19], v[18:19] op_sel:[0,0,1] op_sel_hi:[1,0,1]
    buffer_load_dwordx4 a[184:187], v15, s[44:47], s81 offen offset:1024 sc1
    v_pk_fma_f32 v[30:31], v[30:31], v[18:19], v[18:19] op_sel:[0,0,1] op_sel_hi:[1,0,1]
    v_pk_fma_f32 v[32:33], v[32:33], v[18:19], v[18:19] op_sel:[0,0,1] op_sel_hi:[1,0,1]
    v_pk_fma_f32 v[34:35], v[34:35], v[18:19], v[18:19] op_sel:[0,0,1] op_sel_hi:[1,0,1]
    v_pk_mul_f32 v[28:29], v[28:29], v[248:249]
    v_pk_mul_f32 v[30:31], v[30:31], v[250:251]
    v_pk_mul_f32 v[32:33], v[32:33], v[252:253]
    v_pk_mul_f32 v[34:35], v[34:35], v[254:255]
    v_exp_f32 v36, v28
    v_exp_f32 v37, v29
    v_exp_f32 v38, v30
    v_exp_f32 v39, v31
    v_exp_f32 v40, v32
    v_exp_f32 v41, v33
    v_exp_f32 v42, v34
    v_exp_f32 v43, v35
    v_pk_add_f32 v[36:37], v[36:37], 1.0 op_sel_hi:[1,0]
    v_pk_add_f32 v[38:39], v[38:39], 1.0 op_sel_hi:[1,0]
    s_nop 0
L_FA_pad8:
    s_cbranch_execz L_FA_ret
    v_pk_add_f32 v[40:41], v[40:41], 1.0 op_sel_hi:[1,0]
    buffer_load_dwordx4 a[188:191], v15, s[44:47], s81 offen offset:2048 sc1
    v_pk_add_f32 v[42:43], v[42:43], 1.0 op_sel_hi:[1,0]
    v_rcp_f32 v36, v36
    v_rcp_f32 v37, v37
    v_rcp_f32 v38, v38
    v_rcp_f32 v39, v39
    v_rcp_f32 v40, v40
    v_rcp_f32 v41, v41
    v_rcp_f32 v42, v42
    v_rcp_f32 v43, v43
    v_pk_mul_f32 v[248:249], v[248:249], v[36:37]
    v_pk_mul_f32 v[250:251], v[250:251], v[38:39]
    v_pk_mul_f32 v[252:253], v[252:253], v[40:41]
    v_pk_mul_f32 v[254:255], v[254:255], v[42:43]
    v_cvt_pk_bf16_f32 v44, v248, v249
    v_cvt_pk_bf16_f32 v45, v250, v251
    v_cvt_pk_bf16_f32 v46, v252, v253
    v_cvt_pk_bf16_f32 v47, v254, v255
    buffer_store_dwordx4 v[44:47], v15, s[44:47], s24 offen offset:1024 sc1
    v_pk_fma_f32 v[28:29], v[80:81], v[56:57], v[88:89] op_sel:[1,0,0] op_sel_hi:[1,1,1] neg_lo:[1,0,0] neg_hi:[1,0,0]
    buffer_load_dwordx4 a[192:195], v15, s[44:47], s81 offen offset:3072 sc1
    v_pk_fma_f32 v[30:31], v[80:81], v[58:59], v[90:91] op_sel:[1,0,0] op_sel_hi:[1,1,1] neg_lo:[1,0,0] neg_hi:[1,0,0]
    v_pk_fma_f32 v[32:33], v[80:81], v[60:61], v[92:93] op_sel:[1,0,0] op_sel_hi:[1,1,1] neg_lo:[1,0,0] neg_hi:[1,0,0]
    v_pk_fma_f32 v[34:35], v[80:81], v[62:63], v[94:95] op_sel:[1,0,0] op_sel_hi:[1,1,1] neg_lo:[1,0,0] neg_hi:[1,0,0]
    v_pk_fma_f32 v[160:161], v[80:81], v[160:161], v[28:29] op_sel:[0,0,0] op_sel_hi:[0,1,1]
    v_pk_fma_f32 v[162:163], v[80:81], v[162:163], v[30:31] op_sel:[0,0,0] op_sel_hi:[0,1,1]
    v_pk_fma_f32 v[164:165], v[80:81], v[164:165], v[32:33] op_sel:[0,0,0] op_sel_hi:[0,1,1]
    v_pk_fma_f32 v[166:167], v[80:81], v[166:167], v[34:35] op_sel:[0,0,0] op_sel_hi:[0,1,1]
    v_pk_mul_f32 v[28:29], v[160:161], v[160:161]
    v_pk_mul_f32 v[30:31], v[162:163], v[162:163]
    v_pk_mul_f32 v[32:33], v[164:165], v[164:165]
    v_pk_mul_f32 v[34:35], v[166:167], v[166:167]
    v_pk_fma_f32 v[28:29], v[28:29], v[18:19], v[18:19] op_sel:[0,0,1] op_sel_hi:[1,0,1]
    v_pk_fma_f32 v[30:31], v[30:31], v[18:19], v[18:19] op_sel:[0,0,1] op_sel_hi:[1,0,1]
    v_pk_fma_f32 v[32:33], v[32:33], v[18:19], v[18:19] op_sel:[0,0,1] op_sel_hi:[1,0,1]
    v_pk_fma_f32 v[34:35], v[34:35], v[18:19], v[18:19] op_sel:[0,0,1] op_sel_hi:[1,0,1]
    v_pk_mul_f32 v[28:29], v[28:29], v[160:161]
    v_pk_mul_f32 v[30:31], v[30:31], v[162:163]
    v_pk_mul_f32 v[32:33], v[32:33], v[164:165]
    s_add_u32 s81, s81, 4096
    buffer_load_dwordx4 a[196:199], v15, s[44:47], s81 offen offset:0 sc1
    v_pk_mul_f32 v[34:35], v[34:35], v[166:167]
    v_exp_f32 v36, v28
    v_exp_f32 v37, v29
    v_exp_f32 v38, v30
    v_exp_f32 v39, v31
    v_exp_f32 v40, v32
    v_exp_f32 v41, v33
    v_exp_f32 v42, v34
    v_exp_f32 v43, v35
    v_pk_add_f32 v[36:37], v[36:37], 1.0 op_sel_hi:[1,0]
    v_pk_add_f32 v[38:39], v[38:39], 1.0 op_sel_hi:[1,0]
    v_pk_add_f32 v[40:41], v[40:41], 1.0 op_sel_hi:[1,0]
    v_pk_add_f32 v[42:43], v[42:43], 1.0 op_sel_hi:[1,0]
    v_rcp_f32 v36, v36
    v_rcp_f32 v37, v37
    v_rcp_f32 v38, v38
    v_rcp_f32 v39, v39
    v_rcp_f32 v40, v40
    s_add_u32 s81, s76, 204800
    buffer_load_dwordx4 a[200:203], v15, s[44:47], s81 offen offset:0 sc1
    v_rcp_f32 v41, v41
    v_rcp_f32 v42, v42
    v_rcp_f32 v43, v43
    v_pk_mul_f32 v[160:161], v[160:161], v[36:37]
    v_pk_mul_f32 v[162:163], v[162:163], v[38:39]
    v_pk_mul_f32 v[164:165], v[164:165], v[40:41]
    v_pk_mul_f32 v[166:167], v[166:167], v[42:43]
    v_cvt_pk_bf16_f32 v20, v160, v161
    v_cvt_pk_bf16_f32 v21, v162, v163
    v_cvt_pk_bf16_f32 v22, v164, v165
    v_cvt_pk_bf16_f32 v23, v166, v167
    s_add_u32 s24, s4, 0
    s_nop 0
    buffer_store_dwordx4 v[20:23], v15, s[44:47], s24 offen offset:0 sc1
    v_pk_fma_f32 v[28:29], v[82:83], v[56:57], v[88:89] op_sel:[1,0,0] op_sel_hi:[1,1,1] neg_lo:[1,0,0] neg_hi:[1,0,0]
    v_pk_fma_f32 v[30:31], v[82:83], v[58:59], v[90:91] op_sel:[1,0,0] op_sel_hi:[1,1,1] neg_lo:[1,0,0] neg_hi:[1,0,0]
    v_pk_fma_f32 v[32:33], v[82:83], v[60:61], v[92:93] op_sel:[1,0,0] op_sel_hi:[1,1,1] neg_lo:[1,0,0] neg_hi:[1,0,0]
    v_pk_fma_f32 v[34:35], v[82:83], v[62:63], v[94:95] op_sel:[1,0,0] op_sel_hi:[1,1,1] neg_lo:[1,0,0] neg_hi:[1,0,0]
    v_pk_fma_f32 v[184:185], v[82:83], v[184:185], v[28:29] op_sel:[0,0,0] op_sel_hi:[0,1,1]
    buffer_load_dwordx4 a[204:207], v15, s[44:47], s81 offen offset:1024 sc1
    v_pk_fma_f32 v[186:187], v[82:83], v[186:187], v[30:31] op_sel:[0,0,0] op_sel_hi:[0,1,1]
    v_pk_fma_f32 v[188:189], v[82:83], v[188:189], v[32:33] op_sel:[0,0,0] op_sel_hi:[0,1,1]
    v_pk_fma_f32 v[190:191], v[82:83], v[190:191], v[34:35] op_sel:[0,0,0] op_sel_hi:[0,1,1]
    v_pk_mul_f32 v[28:29], v[184:185], v[184:185]
    v_pk_mul_f32 v[30:31], v[186:187], v[186:187]
    v_pk_mul_f32 v[32:33], v[188:189], v[188:189]
    v_pk_mul_f32 v[34:35], v[190:191], v[190:191]
    v_pk_fma_f32 v[28:29], v[28:29], v[18:19], v[18:19] op_sel:[0,0,1] op_sel_hi:[1,0,1]
    v_pk_fma_f32 v[30:31], v[30:31], v[18:19], v[18:19] op_sel:[0,0,1] op_sel_hi:[1,0,1]
    v_pk_fma_f32 v[32:33], v[32:33], v[18:19], v[18:19] op_sel:[0,0,1] op_sel_hi:[1,0,1]
    v_pk_fma_f32 v[34:35], v[34:35], v[18:19], v[18:19] op_sel:[0,0,1] op_sel_hi:[1,0,1]
    v_pk_mul_f32 v[28:29], v[28:29], v[184:185]
    v_pk_mul_f32 v[30:31], v[30:31], v[186:187]
    v_pk_mul_f32 v[32:33], v[32:33], v[188:189]
    v_pk_mul_f32 v[34:35], v[34:35], v[190:191]
    v_exp_f32 v36, v28
    v_exp_f32 v37, v29
    v_exp_f32 v38, v30
    buffer_load_dwordx4 a[208:211], v15, s[44:47], s81 offen offset:2048 sc1
    v_exp_f32 v39, v31
    v_exp_f32 v40, v32
    v_exp_f32 v41, v33
    v_exp_f32 v42, v34
    v_exp_f32 v43, v35
    v_pk_add_f32 v[36:37], v[36:37], 1.0 op_sel_hi:[1,0]
    v_pk_add_f32 v[38:39], v[38:39], 1.0 op_sel_hi:[1,0]
    v_pk_add_f32 v[40:41], v[40:41], 1.0 op_sel_hi:[1,0]
    v_pk_add_f32 v[42:43], v[42:43], 1.0 op_sel_hi:[1,0]
    v_rcp_f32 v36, v36
    v_rcp_f32 v37, v37
    v_rcp_f32 v38, v38
    v_rcp_f32 v39, v39
    v_rcp_f32 v40, v40
    v_rcp_f32 v41, v41
    v_rcp_f32 v42, v42
    v_rcp_f32 v43, v43
    v_pk_mul_f32 v[184:185], v[184:185], v[36:37]
    buffer_load_dwordx4 a[212:215], v15, s[44:47], s81 offen offset:3072 sc1
    v_pk_mul_f32 v[186:187], v[186:187], v[38:39]
    v_pk_mul_f32 v[188:189], v[188:189], v[40:41]
    v_pk_mul_f32 v[190:191], v[190:191], v[42:43]
    v_cvt_pk_bf16_f32 v44, v184, v185
    v_cvt_pk_bf16_f32 v45, v186, v187
    v_cvt_pk_bf16_f32 v46, v188, v189
    v_cvt_pk_bf16_f32 v47, v190, v191
    s_lshl4_add_u32 s5, s3, s22
    s_lshl_b32 s5, s5, 7
    s_add_u32 s5, s5, 65536
    v_lshrrev_b32 v26, 5, v0
    v_min_u32 v26, 1, v26
    v_lshlrev_b32 v26, 25, v26
    v_lshl_add_u32 v26, v0, 2, v26
    s_lshl_b32 s68, s78, 11
    s_add_u32 s68, s68, 65536
    v_min_u32 v27, 8, v2
    v_lshl_add_u32 v27, v27, 7, s68
    s_waitcnt vmcnt(7)
    s_barrier
    s_nop 0
    buffer_store_dword v16, v26, s[44:47], s5 offen sc1
    buffer_store_dwordx4 v[44:47], v15, s[44:47], s24 offen offset:1024 sc1
    v_pk_fma_f32 v[28:29], v[80:81], v[64:65], v[96:97] op_sel:[1,0,0] op_sel_hi:[1,1,1] neg_lo:[1,0,0] neg_hi:[1,0,0]
    v_pk_fma_f32 v[30:31], v[80:81], v[66:67], v[98:99] op_sel:[1,0,0] op_sel_hi:[1,1,1] neg_lo:[1,0,0] neg_hi:[1,0,0]
    v_pk_fma_f32 v[32:33], v[80:81], v[68:69], v[100:101] op_sel:[1,0,0] op_sel_hi:[1,1,1] neg_lo:[1,0,0] neg_hi:[1,0,0]
    v_pk_fma_f32 v[34:35], v[80:81], v[70:71], v[102:103] op_sel:[1,0,0] op_sel_hi:[1,1,1] neg_lo:[1,0,0] neg_hi:[1,0,0]
    v_pk_fma_f32 v[168:169], v[80:81], v[168:169], v[28:29] op_sel:[0,0,0] op_sel_hi:[0,1,1]
    v_pk_fma_f32 v[170:171], v[80:81], v[170:171], v[30:31] op_sel:[0,0,0] op_sel_hi:[0,1,1]
    v_pk_fma_f32 v[172:173], v[80:81], v[172:173], v[32:33] op_sel:[0,0,0] op_sel_hi:[0,1,1]
    v_pk_fma_f32 v[174:175], v[80:81], v[174:175], v[34:35] op_sel:[0,0,0] op_sel_hi:[0,1,1]
    v_pk_mul_f32 v[28:29], v[168:169], v[168:169]
    s_add_u32 s81, s81, 4096
    buffer_load_dwordx4 a[216:219], v15, s[44:47], s81 offen offset:0 sc1
    v_pk_mul_f32 v[30:31], v[170:171], v[170:171]
    v_pk_mul_f32 v[32:33], v[172:173], v[172:173]
    v_pk_mul_f32 v[34:35], v[174:175], v[174:175]
    v_pk_fma_f32 v[28:29], v[28:29], v[18:19], v[18:19] op_sel:[0,0,1] op_sel_hi:[1,0,1]
    v_pk_fma_f32 v[30:31], v[30:31], v[18:19], v[18:19] op_sel:[0,0,1] op_sel_hi:[1,0,1]
    v_pk_fma_f32 v[32:33], v[32:33], v[18:19], v[18:19] op_sel:[0,0,1] op_sel_hi:[1,0,1]
    v_pk_fma_f32 v[34:35], v[34:35], v[18:19], v[18:19] op_sel:[0,0,1] op_sel_hi:[1,0,1]
    s_nop 0
L_FA_pad9:
    s_cbranch_execz L_FA_ret
    v_pk_mul_f32 v[28:29], v[28:29], v[168:169]
    v_pk_mul_f32 v[30:31], v[30:31], v[170:171]
    v_pk_mul_f32 v[32:33], v[32:33], v[172:173]
    v_pk_mul_f32 v[34:35], v[34:35], v[174:175]
    v_exp_f32 v36, v28
    v_exp_f32 v37, v29
    v_exp_f32 v38, v30
    v_exp_f32 v39, v31
    v_exp_f32 v40, v32
    v_exp_f32 v41, v33
    v_exp_f32 v42, v34
    s_add_u32 s81, s76, 225280
    buffer_load_dwordx4 a[220:223], v15, s[44:47], s81 offen offset:0 sc1
    v_exp_f32 v43, v35
    v_pk_add_f32 v[36:37], v[36:37], 1.0 op_sel_hi:[1,0]
    v_pk_add_f32 v[38:39], v[38:39], 1.0 op_sel_hi:[1,0]
    v_pk_add_f32 v[40:41], v[40:41], 1.0 op_sel_hi:[1,0]
    v_pk_add_f32 v[42:43], v[42:43], 1.0 op_sel_hi:[1,0]
    v_rcp_f32 v36, v36
    v_rcp_f32 v37, v37
    v_rcp_f32 v38, v38
    v_rcp_f32 v39, v39
    v_rcp_f32 v40, v40
    v_rcp_f32 v41, v41
    v_rcp_f32 v42, v42
    v_rcp_f32 v43, v43
    v_pk_mul_f32 v[168:169], v[168:169], v[36:37]
    v_pk_mul_f32 v[170:171], v[170:171], v[38:39]
    v_pk_mul_f32 v[172:173], v[172:173], v[40:41]
    v_pk_mul_f32 v[174:175], v[174:175], v[42:43]
    v_cvt_pk_bf16_f32 v20, v168, v169
    buffer_load_dwordx4 a[224:227], v15, s[44:47], s81 offen offset:1024 sc1
    v_cvt_pk_bf16_f32 v21, v170, v171
    v_cvt_pk_bf16_f32 v22, v172, v173
    v_cvt_pk_bf16_f32 v23, v174, v175
    s_add_u32 s24, s4, 73728
    buffer_store_dwordx4 v[20:23], v15, s[44:47], s24 offen offset:0 sc1
    v_pk_fma_f32 v[28:29], v[82:83], v[64:65], v[96:97] op_sel:[1,0,0] op_sel_hi:[1,1,1] neg_lo:[1,0,0] neg_hi:[1,0,0]
    v_pk_fma_f32 v[30:31], v[82:83], v[66:67], v[98:99] op_sel:[1,0,0] op_sel_hi:[1,1,1] neg_lo:[1,0,0] neg_hi:[1,0,0]
    v_pk_fma_f32 v[32:33], v[82:83], v[68:69], v[100:101] op_sel:[1,0,0] op_sel_hi:[1,1,1] neg_lo:[1,0,0] neg_hi:[1,0,0]
    v_pk_fma_f32 v[34:35], v[82:83], v[70:71], v[102:103] op_sel:[1,0,0] op_sel_hi:[1,1,1] neg_lo:[1,0,0] neg_hi:[1,0,0]
    v_pk_fma_f32 v[192:193], v[82:83], v[192:193], v[28:29] op_sel:[0,0,0] op_sel_hi:[0,1,1]
    v_pk_fma_f32 v[194:195], v[82:83], v[194:195], v[30:31] op_sel:[0,0,0] op_sel_hi:[0,1,1]
    v_pk_fma_f32 v[196:197], v[82:83], v[196:197], v[32:33] op_sel:[0,0,0] op_sel_hi:[0,1,1]
    v_pk_fma_f32 v[198:199], v[82:83], v[198:199], v[34:35] op_sel:[0,0,0] op_sel_hi:[0,1,1]
    v_pk_mul_f32 v[28:29], v[192:193], v[192:193]
    v_pk_mul_f32 v[30:31], v[194:195], v[194:195]
    v_pk_mul_f32 v[32:33], v[196:197], v[196:197]
    v_pk_mul_f32 v[34:35], v[198:199], v[198:199]
    v_pk_fma_f32 v[28:29], v[28:29], v[18:19], v[18:19] op_sel:[0,0,1] op_sel_hi:[1,0,1]
    buffer_load_dwordx4 a[228:231], v15, s[44:47], s81 offen offset:2048 sc1
    v_pk_fma_f32 v[30:31], v[30:31], v[18:19], v[18:19] op_sel:[0,0,1] op_sel_hi:[1,0,1]
    v_pk_fma_f32 v[32:33], v[32:33], v[18:19], v[18:19] op_sel:[0,0,1] op_sel_hi:[1,0,1]
    v_pk_fma_f32 v[34:35], v[34:35], v[18:19], v[18:19] op_sel:[0,0,1] op_sel_hi:[1,0,1]
    v_pk_mul_f32 v[28:29], v[28:29], v[192:193]
    v_pk_mul_f32 v[30:31], v[30:31], v[194:195]
    v_pk_mul_f32 v[32:33], v[32:33], v[196:197]
    v_pk_mul_f32 v[34:35], v[34:35], v[198:199]
    v_exp_f32 v36, v28
    v_exp_f32 v37, v29
    v_exp_f32 v38, v30
    v_exp_f32 v39, v31
    v_exp_f32 v40, v32
    v_exp_f32 v41, v33
    v_exp_f32 v42, v34
    v_exp_f32 v43, v35
    v_pk_add_f32 v[36:37], v[36:37], 1.0 op_sel_hi:[1,0]
    v_pk_add_f32 v[38:39], v[38:39], 1.0 op_sel_hi:[1,0]
    v_pk_add_f32 v[40:41], v[40:41], 1.0 op_sel_hi:[1,0]
    buffer_load_dwordx4 a[232:235], v15, s[44:47], s81 offen offset:3072 sc1
    v_pk_add_f32 v[42:43], v[42:43], 1.0 op_sel_hi:[1,0]
    v_rcp_f32 v36, v36
    v_rcp_f32 v37, v37
    v_rcp_f32 v38, v38
    v_rcp_f32 v39, v39
    v_rcp_f32 v40, v40
    v_rcp_f32 v41, v41
    v_rcp_f32 v42, v42
    v_rcp_f32 v43, v43
    v_pk_mul_f32 v[192:193], v[192:193], v[36:37]
    v_pk_mul_f32 v[194:195], v[194:195], v[38:39]
    v_pk_mul_f32 v[196:197], v[196:197], v[40:41]
    v_pk_mul_f32 v[198:199], v[198:199], v[42:43]
    v_cvt_pk_bf16_f32 v44, v192, v193
    v_cvt_pk_bf16_f32 v45, v194, v195
    v_cvt_pk_bf16_f32 v46, v196, v197
    v_cvt_pk_bf16_f32 v47, v198, v199
    buffer_store_dwordx4 v[44:47], v15, s[44:47], s24 offen offset:1024 sc1
    s_add_u32 s81, s81, 4096
    buffer_load_dwordx4 a[236:239], v15, s[44:47], s81 offen offset:0 sc1
    v_pk_fma_f32 v[28:29], v[80:81], v[72:73], v[104:105] op_sel:[1,0,0] op_sel_hi:[1,1,1] neg_lo:[1,0,0] neg_hi:[1,0,0]
    v_pk_fma_f32 v[30:31], v[80:81], v[74:75], v[106:107] op_sel:[1,0,0] op_sel_hi:[1,1,1] neg_lo:[1,0,0] neg_hi:[1,0,0]
    v_pk_fma_f32 v[32:33], v[80:81], v[76:77], v[108:109] op_sel:[1,0,0] op_sel_hi:[1,1,1] neg_lo:[1,0,0] neg_hi:[1,0,0]
    v_pk_fma_f32 v[34:35], v[80:81], v[78:79], v[110:111] op_sel:[1,0,0] op_sel_hi:[1,1,1] neg_lo:[1,0,0] neg_hi:[1,0,0]
    v_pk_fma_f32 v[176:177], v[80:81], v[176:177], v[28:29] op_sel:[0,0,0] op_sel_hi:[0,1,1]
    v_pk_fma_f32 v[178:179], v[80:81], v[178:179], v[30:31] op_sel:[0,0,0] op_sel_hi:[0,1,1]
    v_pk_fma_f32 v[180:181], v[80:81], v[180:181], v[32:33] op_sel:[0,0,0] op_sel_hi:[0,1,1]
    v_pk_fma_f32 v[182:183], v[80:81], v[182:183], v[34:35] op_sel:[0,0,0] op_sel_hi:[0,1,1]
    v_pk_mul_f32 v[28:29], v[176:177], v[176:177]
    v_pk_mul_f32 v[30:31], v[178:179], v[178:179]
    v_pk_mul_f32 v[32:33], v[180:181], v[180:181]
    v_pk_mul_f32 v[34:35], v[182:183], v[182:183]
    v_pk_fma_f32 v[28:29], v[28:29], v[18:19], v[18:19] op_sel:[0,0,1] op_sel_hi:[1,0,1]
    v_pk_fma_f32 v[30:31], v[30:31], v[18:19], v[18:19] op_sel:[0,0,1] op_sel_hi:[1,0,1]
    v_pk_fma_f32 v[32:33], v[32:33], v[18:19], v[18:19] op_sel:[0,0,1] op_sel_hi:[1,0,1]
    v_pk_fma_f32 v[34:35], v[34:35], v[18:19], v[18:19] op_sel:[0,0,1] op_sel_hi:[1,0,1]
    v_pk_mul_f32 v[28:29], v[28:29], v[176:177]
    v_pk_mul_f32 v[30:31], v[30:31], v[178:179]
    s_add_u32 s81, s76, 245760
    buffer_load_dwordx4 a[240:243], v15, s[44:47], s81 offen offset:0 sc1
    v_pk_mul_f32 v[32:33], v[32:33], v[180:181]
    v_pk_mul_f32 v[34:35], v[34:35], v[182:183]
    v_exp_f32 v36, v28
    v_exp_f32 v37, v29
    v_exp_f32 v38, v30
    v_exp_f32 v39, v31
    v_exp_f32 v40, v32
    v_exp_f32 v41, v33
    v_exp_f32 v42, v34
    v_exp_f32 v43, v35
    v_pk_add_f32 v[36:37], v[36:37], 1.0 op_sel_hi:[1,0]
    v_pk_add_f32 v[38:39], v[38:39], 1.0 op_sel_hi:[1,0]
    v_pk_add_f32 v[40:41], v[40:41], 1.0 op_sel_hi:[1,0]
    v_pk_add_f32 v[42:43], v[42:43], 1.0 op_sel_hi:[1,0]
    v_rcp_f32 v36, v36
    v_rcp_f32 v37, v37
    v_rcp_f32 v38, v38
    v_rcp_f32 v39, v39
    buffer_load_dwordx4 a[244:247], v15, s[44:47], s81 offen offset:1024 sc1
    v_rcp_f32 v40, v40
    v_rcp_f32 v41, v41
    v_rcp_f32 v42, v42
    v_rcp_f32 v43, v43
    v_pk_mul_f32 v[176:177], v[176:177], v[36:37]
    v_pk_mul_f32 v[178:179], v[178:179], v[38:39]
    v_pk_mul_f32 v[180:181], v[180:181], v[40:41]
    v_pk_mul_f32 v[182:183], v[182:183], v[42:43]
    v_cvt_pk_bf16_f32 v20, v176, v177
    v_cvt_pk_bf16_f32 v21, v178, v179
    v_cvt_pk_bf16_f32 v22, v180, v181
    v_cvt_pk_bf16_f32 v23, v182, v183
    s_add_u32 s24, s4, 147456
    buffer_store_dwordx4 v[20:23], v15, s[44:47], s24 offen offset:0 sc1
    v_pk_fma_f32 v[28:29], v[82:83], v[72:73], v[104:105] op_sel:[1,0,0] op_sel_hi:[1,1,1] neg_lo:[1,0,0] neg_hi:[1,0,0]
    v_pk_fma_f32 v[30:31], v[82:83], v[74:75], v[106:107] op_sel:[1,0,0] op_sel_hi:[1,1,1] neg_lo:[1,0,0] neg_hi:[1,0,0]
    v_pk_fma_f32 v[32:33], v[82:83], v[76:77], v[108:109] op_sel:[1,0,0] op_sel_hi:[1,1,1] neg_lo:[1,0,0] neg_hi:[1,0,0]
    v_pk_fma_f32 v[34:35], v[82:83], v[78:79], v[110:111] op_sel:[1,0,0] op_sel_hi:[1,1,1] neg_lo:[1,0,0] neg_hi:[1,0,0]
    buffer_load_dwordx4 a[248:251], v15, s[44:47], s81 offen offset:2048 sc1
    v_pk_fma_f32 v[200:201], v[82:83], v[200:201], v[28:29] op_sel:[0,0,0] op_sel_hi:[0,1,1]
    v_pk_fma_f32 v[202:203], v[82:83], v[202:203], v[30:31] op_sel:[0,0,0] op_sel_hi:[0,1,1]
    v_pk_fma_f32 v[204:205], v[82:83], v[204:205], v[32:33] op_sel:[0,0,0] op_sel_hi:[0,1,1]
    v_pk_fma_f32 v[206:207], v[82:83], v[206:207], v[34:35] op_sel:[0,0,0] op_sel_hi:[0,1,1]
    v_pk_mul_f32 v[28:29], v[200:201], v[200:201]
    v_pk_mul_f32 v[30:31], v[202:203], v[202:203]
    v_pk_mul_f32 v[32:33], v[204:205], v[204:205]
    v_pk_mul_f32 v[34:35], v[206:207], v[206:207]
    v_pk_fma_f32 v[28:29], v[28:29], v[18:19], v[18:19] op_sel:[0,0,1] op_sel_hi:[1,0,1]
    v_pk_fma_f32 v[30:31], v[30:31], v[18:19], v[18:19] op_sel:[0,0,1] op_sel_hi:[1,0,1]
    v_pk_fma_f32 v[32:33], v[32:33], v[18:19], v[18:19] op_sel:[0,0,1] op_sel_hi:[1,0,1]
    s_nop 0
L_FA_pad10:
    s_cbranch_execz L_FA_ret
    v_pk_fma_f32 v[34:35], v[34:35], v[18:19], v[18:19] op_sel:[0,0,1] op_sel_hi:[1,0,1]
    v_pk_mul_f32 v[28:29], v[28:29], v[200:201]
    v_pk_mul_f32 v[30:31], v[30:31], v[202:203]
    v_pk_mul_f32 v[32:33], v[32:33], v[204:205]
    v_pk_mul_f32 v[34:35], v[34:35], v[206:207]
    v_exp_f32 v36, v28
    v_exp_f32 v37, v29
    buffer_load_dwordx4 a[252:255], v15, s[44:47], s81 offen offset:3072 sc1
    v_exp_f32 v38, v30
    v_exp_f32 v39, v31
    v_exp_f32 v40, v32
    v_exp_f32 v41, v33
    v_exp_f32 v42, v34
    v_exp_f32 v43, v35
    v_pk_add_f32 v[36:37], v[36:37], 1.0 op_sel_hi:[1,0]
    v_pk_add_f32 v[38:39], v[38:39], 1.0 op_sel_hi:[1,0]
    v_pk_add_f32 v[40:41], v[40:41], 1.0 op_sel_hi:[1,0]
    v_pk_add_f32 v[42:43], v[42:43], 1.0 op_sel_hi:[1,0]
    v_rcp_f32 v36, v36
    v_rcp_f32 v37, v37
    v_rcp_f32 v38, v38
    v_rcp_f32 v39, v39
    v_rcp_f32 v40, v40
    v_rcp_f32 v41, v41
    v_rcp_f32 v42, v42
    v_rcp_f32 v43, v43
    v_pk_mul_f32 v[200:201], v[200:201], v[36:37]
    v_pk_mul_f32 v[202:203], v[202:203], v[38:39]
    v_pk_mul_f32 v[204:205], v[204:205], v[40:41]
    v_pk_mul_f32 v[206:207], v[206:207], v[42:43]
    v_cvt_pk_bf16_f32 v44, v200, v201
    v_cvt_pk_bf16_f32 v45, v202, v203
    v_cvt_pk_bf16_f32 v46, v204, v205
    v_cvt_pk_bf16_f32 v47, v206, v207
    buffer_load_dword v8, v27, s[44:47], 0 offen sc1
    buffer_store_dwordx4 v[44:47], v15, s[44:47], s24 offen offset:1024 sc1
    s_cmp_eq_u32 s22, 8
    s_cbranch_scc1 L_G_start
    s_add_u32 s67, s60, 0
    s_add_u32 s81, s81, 4096
    buffer_load_dwordx4 v[28:31], v15, s[44:47], s81 offen offset:0 sc1
    s_and_b32 s67, s67, 3
    s_lshl_b32 s68, s67, 10
    v_add_u32 v1, s68, v15
    s_add_u32 s67, s60, 1
    s_and_b32 s67, s67, 3
    s_lshl_b32 s68, s67, 10
    v_add_u32 v18, s68, v15
    s_add_u32 s67, s60, 2
    s_and_b32 s67, s67, 3
    s_mul_i32 s81, s73, 10240
    s_sub_u32 s81, s76, s81
    s_add_u32 s81, s81, 266240
    buffer_load_dwordx4 v[236:239], v15, s[44:47], s81 offen offset:0 sc1
    s_mul_i32 s68, s67, 30720
    s_add_u32 s68, s68, 0
    v_add_u32 v21, s68, v15
    s_add_u32 s67, s60, 2
    s_and_b32 s67, s67, 3
    s_lshl_b32 s68, s67, 10
    v_add_u32 v19, s68, v15
    s_add_u32 s67, s60, 2
    s_and_b32 s67, s67, 3
    buffer_load_dwordx4 v[240:243], v15, s[44:47], s81 offen offset:1024 sc1
    s_mul_i32 s68, s67, 30720
    s_add_u32 s68, s68, 5120
    v_add_u32 v22, s68, v15
    s_add_u32 s67, s60, 3
    s_and_b32 s67, s67, 3
    s_lshl_b32 s68, s67, 10
    v_add_u32 v20, s68, v15
    s_add_u32 s67, s60, 1
    s_and_b32 s67, s67, 3
    buffer_load_dwordx4 v[244:247], v15, s[44:47], s81 offen offset:2048 sc1
    s_mul_i32 s68, s67, 30720
    s_add_u32 s68, s68, 10240
    v_add_u32 v23, s68, v15
    v_add_u32 v24, s61, v15
    s_lshl_b32 s64, s73, 13
    s_sub_u32 s64, s77, s64
    v_lshl_add_u32 v12, v3, 4, s80
    v_bfe_u32 v13, v0, 3, 2
    v_bfe_u32 v14, v0, 1, 2
    buffer_load_dwordx4 v[248:251], v15, s[44:47], s81 offen offset:3072 sc1
    v_lshl_add_u32 v13, v13, 4, v14
    v_and_b32 v14, 1, v0
    v_lshlrev_b32 v14, 2, v14
    v_lshl_add_u32 v13, v13, 4, v14
    s_lshl_b32 s70, s80, 4
    s_add_u32 s70, s70, 32768
    s_lshl_b32 s67, s60, 8
    s_add_u32 m0, s67, 126976
    v_lshl_add_u32 v14, v3, 5, m0
    s_add_u32 s81, s81, 4096
    buffer_load_dwordx4 v[252:255], v15, s[44:47], s81 offen offset:0 sc1
    v_mov_b32 v7, 163328
    v_lshl_add_u32 v6, v2, 3, v7
    v_lshl_add_u32 v7, v2, 1, v7
    s_mul_i32 s69, s60, 3072
    s_add_u32 s69, s69, 131072
    v_mul_u32_u24 v5, 640, v3
    v_add_u32 v5, s69, v5
    v_lshl_add_u32 v4, v2, 3, v5
    v_lshl_add_u32 v5, v2, 1, v5
    s_mov_b64 exec, 0
    s_cmp_eq_u32 s60, 0
    s_cbranch_scc1 L_FB_pad0
    s_cmp_eq_u32 s60, 1
    s_cbranch_scc1 L_FB_pad1
    s_cmp_eq_u32 s60, 2
    s_cbranch_scc1 L_FB_pad2
    s_branch L_FB_pad3
L_FB_ret:
    s_mov_b64 exec, -1
    s_waitcnt vmcnt(7)
    v_cmp_ne_u32 vcc, s66, v8
    s_cbranch_vccz L_F_f1a_ok
    s_mov_b32 s25, 0
L_F_f1a_retry:

    buffer_load_dword v8, v27, s[44:47], 0 offen sc1
    s_add_u32 s25, s25, 1
    s_waitcnt vmcnt(0)
    v_cmp_ne_u32 vcc, s66, v8
    s_cmp_ge_u32 s25, 100000
    s_cbranch_scc1 L_F_f1a_ok
    s_cbranch_vccnz L_F_f1a_retry
L_F_f1a_ok:
    s_nop 0
    s_add_u32 s65, s77, 393216
    buffer_load_dwordx4 v[32:35], v18, s[44:47], s65 offen sc1
    s_add_u32 s65, s77, 409600
    buffer_load_dwordx4 v[36:39], v18, s[44:47], s65 offen sc1
    s_add_u32 s65, s77, 425984
    buffer_load_dwordx4 v[40:43], v18, s[44:47], s65 offen sc1
    s_add_u32 s65, s77, 442368
    buffer_load_dwordx4 v[44:47], v18, s[44:47], s65 offen sc1
    s_add_u32 s65, s77, 458752
    buffer_load_dwordx4 v[48:51], v18, s[44:47], s65 offen sc1
    s_add_u32 s65, s77, 475136
    buffer_load_dwordx4 v[52:55], v18, s[44:47], s65 offen sc1
    s_add_u32 s5, s5, 65536
    s_waitcnt vmcnt(12)
    s_barrier
    s_nop 0
L_FB_pad0:
    s_cbranch_execz L_FB_pad4
    buffer_store_dword v16, v26, s[44:47], s5 offen sc1
    s_add_u32 s65, s77, 491520
    buffer_load_dwordx4 v[56:59], v18, s[44:47], s65 offen sc1
    s_add_u32 s65, s77, 507904
    buffer_load_dwordx4 v[60:63], v18, s[44:47], s65 offen sc1
    s_add_u32 s65, s77, 524288
    buffer_load_dwordx4 v[64:67], v18, s[44:47], s65 offen sc1
    s_waitcnt vmcnt(9)
    v_mfma_f32_16x16x32_bf16 v[116:119], v[32:35], a[0:3], 0
    s_add_u32 s65, s77, 540672
    s_waitcnt vmcnt(8)
    v_mfma_f32_16x16x32_bf16 v[116:119], v[36:39], a[20:23], v[116:119]
    buffer_load_dwordx4 v[68:71], v18, s[44:47], s65 offen sc1
    v_mfma_f32_16x16x32_bf16 v[120:123], v[32:35], a[4:7], 0
    ds_read_b64 v[108:109], v6
    s_add_u32 s65, s77, 557056
    v_mfma_f32_16x16x32_bf16 v[120:123], v[36:39], a[24:27], v[120:123]
    buffer_load_dwordx4 v[72:75], v18, s[44:47], s65 offen sc1
    v_mfma_f32_16x16x32_bf16 v[124:127], v[32:35], a[8:11], 0
    ds_read_u16 v110, v7 offset:128
    s_add_u32 s65, s77, 573440
    v_mfma_f32_16x16x32_bf16 v[124:127], v[36:39], a[28:31], v[124:127]
    ds_read_b64 v[112:113], v6 offset:256
    v_mfma_f32_16x16x32_bf16 v[128:131], v[32:35], a[12:15], 0
    buffer_load_dwordx4 v[76:79], v18, s[44:47], s65 offen sc1
    v_mfma_f32_16x16x32_bf16 v[128:131], v[36:39], a[32:35], v[128:131]
    ds_read_u16 v114, v7 offset:384
    s_add_u32 s65, s77, 589824
    v_mfma_f32_16x16x32_bf16 v[132:135], v[32:35], a[16:19], 0
    ds_read2_b64 v[96:99], v4 offset0:0 offset1:20
    v_mfma_f32_16x16x32_bf16 v[132:135], v[36:39], a[36:39], v[132:135]
    s_waitcnt vmcnt(9)
    v_mfma_f32_16x16x32_bf16 v[116:119], v[40:43], a[40:43], v[116:119]
    buffer_load_dwordx4 v[80:83], v18, s[44:47], s65 offen sc1
    v_mfma_f32_16x16x32_bf16 v[116:119], v[44:47], a[60:63], v[116:119]
    ds_read2_b64 v[100:103], v4 offset0:40 offset1:60
    s_add_u32 s65, s77, 393216
    v_mfma_f32_16x16x32_bf16 v[120:123], v[44:47], a[64:67], v[120:123]
    buffer_load_dwordx4 v[84:87], v19, s[44:47], s65 offen sc1
    v_mfma_f32_16x16x32_bf16 v[120:123], v[40:43], a[44:47], v[120:123]
    ds_read_u16 v104, v5 offset:128
    s_add_u32 s65, s77, 409600
    v_mfma_f32_16x16x32_bf16 v[124:127], v[40:43], a[48:51], v[124:127]
    ds_read_u16 v105, v5 offset:288
    v_mfma_f32_16x16x32_bf16 v[124:127], v[44:47], a[68:71], v[124:127]
    buffer_load_dword v13, s[44:47], s70 offen sc1 lds
    v_mfma_f32_16x16x32_bf16 v[128:131], v[44:47], a[72:75], v[128:131]
    buffer_load_dwordx4 v[88:91], v19, s[44:47], s65 offen sc1
    v_mfma_f32_16x16x32_bf16 v[128:131], v[40:43], a[52:55], v[128:131]
    ds_read_u16 v106, v5 offset:448
    s_add_u32 s65, s77, 425984
    v_mfma_f32_16x16x32_bf16 v[132:135], v[40:43], a[56:59], v[132:135]
    ds_read_u16 v107, v5 offset:608
    v_mfma_f32_16x16x32_bf16 v[132:135], v[44:47], a[76:79], v[132:135]
    s_waitcnt vmcnt(11)
    buffer_load_dwordx4 v[92:95], v19, s[44:47], s65 offen sc1
    s_add_u32 s65, s77, 442368
    buffer_load_dwordx4 v[32:35], v19, s[44:47], s65 offen sc1
    v_mfma_f32_16x16x32_bf16 v[116:119], v[48:51], a[80:83], v[116:119]
    s_add_u32 s65, s77, 458752
    s_waitcnt lgkmcnt(0)
    v_lshlrev_b32 v136, 16, v108
    v_mfma_f32_16x16x32_bf16 v[116:119], v[52:55], a[100:103], v[116:119]
    buffer_load_dwordx4 v[36:39], v19, s[44:47], s65 offen sc1
    v_mfma_f32_16x16x32_bf16 v[120:123], v[52:55], a[104:107], v[120:123]
    s_add_u32 s65, s77, 475136
    v_and_b32 v140, 0xffff0000, v108
    v_lshlrev_b32 v144, 16, v109
    v_mfma_f32_16x16x32_bf16 v[120:123], v[48:51], a[84:87], v[120:123]
    buffer_load_dwordx4 v[40:43], v19, s[44:47], s65 offen sc1
    v_mfma_f32_16x16x32_bf16 v[124:127], v[48:51], a[88:91], v[124:127]
    s_add_u32 s65, s77, 491520
    v_and_b32 v148, 0xffff0000, v109
    v_lshlrev_b32 v152, 16, v110
    v_mfma_f32_16x16x32_bf16 v[124:127], v[52:55], a[108:111], v[124:127]
    buffer_load_dwordx4 v[44:47], v19, s[44:47], s65 offen sc1
    v_mfma_f32_16x16x32_bf16 v[128:131], v[52:55], a[112:115], v[128:131]
    s_add_u32 s65, s77, 507904
    v_lshlrev_b32 v137, 16, v108
    v_and_b32 v141, 0xffff0000, v108
    v_mfma_f32_16x16x32_bf16 v[128:131], v[48:51], a[92:95], v[128:131]
    v_lshlrev_b32 v145, 16, v109
    v_and_b32 v149, 0xffff0000, v109
    v_mfma_f32_16x16x32_bf16 v[132:135], v[48:51], a[96:99], v[132:135]
    v_lshlrev_b32 v153, 16, v110
    v_lshlrev_b32 v138, 16, v108
    v_mfma_f32_16x16x32_bf16 v[132:135], v[52:55], a[116:119], v[132:135]
    s_waitcnt vmcnt(13)
    v_and_b32 v142, 0xffff0000, v108
    v_lshlrev_b32 v146, 16, v109
    v_mfma_f32_16x16x32_bf16 v[116:119], v[56:59], a[120:123], v[116:119]
    buffer_load_dwordx4 v[48:51], v19, s[44:47], s65 offen sc1
    v_mfma_f32_16x16x32_bf16 v[116:119], v[60:63], a[140:143], v[116:119]
    s_add_u32 s65, s77, 524288
    v_and_b32 v150, 0xffff0000, v109
    v_lshlrev_b32 v154, 16, v110
    v_mfma_f32_16x16x32_bf16 v[120:123], v[60:63], a[144:147], v[120:123]
    v_lshlrev_b32 v139, 16, v108
    v_and_b32 v143, 0xffff0000, v108
    v_mfma_f32_16x16x32_bf16 v[120:123], v[56:59], a[124:127], v[120:123]
    v_lshlrev_b32 v147, 16, v109
    v_and_b32 v151, 0xffff0000, v109
    v_mfma_f32_16x16x32_bf16 v[124:127], v[56:59], a[128:131], v[124:127]
    v_lshlrev_b32 v155, 16, v110
    v_lshlrev_b32 v184, 16, v112
    v_mfma_f32_16x16x32_bf16 v[124:127], v[60:63], a[148:151], v[124:127]
    buffer_load_dwordx4 v[52:55], v19, s[44:47], s65 offen sc1
    v_mfma_f32_16x16x32_bf16 v[128:131], v[60:63], a[152:155], v[128:131]
    s_add_u32 s65, s77, 540672
    v_and_b32 v185, 0xffff0000, v112
    v_lshlrev_b32 v186, 16, v113
    v_mfma_f32_16x16x32_bf16 v[128:131], v[56:59], a[132:135], v[128:131]
    v_and_b32 v187, 0xffff0000, v113
    v_lshlrev_b32 v188, 16, v114
    v_mfma_f32_16x16x32_bf16 v[132:135], v[56:59], a[136:139], v[132:135]
    v_lshlrev_b32 v196, 16, v96
    v_and_b32 v200, 0xffff0000, v96
    v_mfma_f32_16x16x32_bf16 v[132:135], v[60:63], a[156:159], v[132:135]
    s_waitcnt vmcnt(13)
    v_lshlrev_b32 v204, 16, v97
    v_and_b32 v208, 0xffff0000, v97
    v_mfma_f32_16x16x32_bf16 v[116:119], v[64:67], a[160:163], v[116:119]
    buffer_load_dwordx4 v[56:59], v19, s[44:47], s65 offen sc1
    v_mfma_f32_16x16x32_bf16 v[116:119], v[68:71], a[180:183], v[116:119]
    s_add_u32 s65, s77, 557056
    v_lshlrev_b32 v212, 16, v104
    v_lshlrev_b32 v197, 16, v98
    v_mfma_f32_16x16x32_bf16 v[120:123], v[68:71], a[184:187], v[120:123]
    v_and_b32 v201, 0xffff0000, v98
    v_lshlrev_b32 v205, 16, v99
    v_mfma_f32_16x16x32_bf16 v[120:123], v[64:67], a[164:167], v[120:123]
    v_and_b32 v209, 0xffff0000, v99
    v_lshlrev_b32 v213, 16, v105
    v_mfma_f32_16x16x32_bf16 v[124:127], v[64:67], a[168:171], v[124:127]
    v_lshlrev_b32 v198, 16, v100
    v_and_b32 v202, 0xffff0000, v100
    v_mfma_f32_16x16x32_bf16 v[124:127], v[68:71], a[188:191], v[124:127]
    buffer_load_dwordx4 v[60:63], v19, s[44:47], s65 offen sc1
    v_mfma_f32_16x16x32_bf16 v[128:131], v[68:71], a[192:195], v[128:131]
    s_add_u32 s65, s77, 573440
    v_lshlrev_b32 v206, 16, v101
    v_and_b32 v210, 0xffff0000, v101
    v_mfma_f32_16x16x32_bf16 v[128:131], v[64:67], a[172:175], v[128:131]
    v_lshlrev_b32 v214, 16, v106
    v_lshlrev_b32 v199, 16, v102
    v_mfma_f32_16x16x32_bf16 v[132:135], v[64:67], a[176:179], v[132:135]
    v_and_b32 v203, 0xffff0000, v102
    v_lshlrev_b32 v207, 16, v103
    v_mfma_f32_16x16x32_bf16 v[132:135], v[68:71], a[196:199], v[132:135]
    s_waitcnt vmcnt(13)
    v_and_b32 v211, 0xffff0000, v103
    v_lshlrev_b32 v215, 16, v107
    v_mfma_f32_16x16x32_bf16 v[116:119], v[72:75], a[200:203], v[116:119]
L_FB_pad1:
    s_cbranch_execz L_FB_pad5
    buffer_load_dwordx4 v[64:67], v19, s[44:47], s65 offen sc1
    v_mfma_f32_16x16x32_bf16 v[116:119], v[76:79], a[220:223], v[116:119]
    s_add_u32 s65, s77, 589824
    s_mov_b32 s56, s32
    s_mov_b32 s57, s33
    v_mfma_f32_16x16x32_bf16 v[120:123], v[76:79], a[224:227], v[120:123]
    s_mov_b32 s58, 5242880
    s_mov_b32 s59, 0x20000
    v_mul_u32_u24 v13, 2560, v12
    v_mfma_f32_16x16x32_bf16 v[120:123], v[72:75], a[204:207], v[120:123]
    v_lshl_add_u32 v4, v2, 4, v13
    v_lshl_add_u32 v5, v2, 2, v13
    v_mfma_f32_16x16x32_bf16 v[124:127], v[72:75], a[208:211], v[124:127]
    v_add_u32 v6, 5120, v4
    v_add_u32 v7, 5120, v5
    v_mfma_f32_16x16x32_bf16 v[124:127], v[76:79], a[228:231], v[124:127]
    buffer_load_dwordx4 v[68:71], v19, s[44:47], s65 offen sc1
    v_mfma_f32_16x16x32_bf16 v[128:131], v[76:79], a[232:235], v[128:131]
    s_add_u32 s65, s77, 393216
    s_mul_i32 s69, s79, 320
    s_lshl2_add_u32 s62, s2, s60
    v_mfma_f32_16x16x32_bf16 v[128:131], v[72:75], a[212:215], v[128:131]
    s_xor_b32 s63, s62, 512
    s_mul_i32 s62, s62, 3072
    s_mul_i32 s63, s63, 3072
    v_mfma_f32_16x16x32_bf16 v[132:135], v[72:75], a[216:219], v[132:135]
    s_add_u32 s62, s62, 19922944
    s_add_u32 s63, s63, 19922944
    v_add_u32 v27, 65536, v27
    v_mfma_f32_16x16x32_bf16 v[132:135], v[76:79], a[236:239], v[132:135]
    s_waitcnt vmcnt(14)
    v_mfma_f32_16x16x32_bf16 v[116:119], v[80:83], a[240:243], v[116:119]
    buffer_load_dwordx4 v[72:75], v20, s[44:47], s65 offen sc1
    v_mfma_f32_16x16x32_bf16 v[120:123], v[80:83], a[244:247], v[120:123]
    s_add_u32 s65, s77, 409600
    v_mfma_f32_16x16x32_bf16 v[124:127], v[80:83], a[248:251], v[124:127]
    v_mfma_f32_16x16x32_bf16 v[128:131], v[80:83], a[252:255], v[128:131]
    v_mfma_f32_16x16x32_bf16 v[132:135], v[80:83], v[28:31], v[132:135]
    s_waitcnt vmcnt(12)
    v_mfma_f32_16x16x32_bf16 v[136:139], v[84:87], a[0:3], v[136:139]
    buffer_load_dwordx4 v[76:79], v20, s[44:47], s65 offen sc1
    v_mfma_f32_16x16x32_bf16 v[136:139], v[88:91], a[20:23], v[136:139]
    s_add_u32 s65, s77, 425984
    v_mfma_f32_16x16x32_bf16 v[140:143], v[84:87], a[4:7], v[140:143]
    v_mfma_f32_16x16x32_bf16 v[140:143], v[88:91], a[24:27], v[140:143]
    ds_write_b128 v24, v[116:119] offset:0
    v_mfma_f32_16x16x32_bf16 v[144:147], v[84:87], a[8:11], v[144:147]
    v_mfma_f32_16x16x32_bf16 v[144:147], v[88:91], a[28:31], v[144:147]
    buffer_load_dwordx4 v[80:83], v20, s[44:47], s65 offen sc1
    v_mfma_f32_16x16x32_bf16 v[148:151], v[84:87], a[12:15], v[148:151]
    s_add_u32 s65, s77, 442368
    v_mfma_f32_16x16x32_bf16 v[148:151], v[88:91], a[32:35], v[148:151]
    ds_write_b128 v24, v[120:123] offset:1024
    v_mfma_f32_16x16x32_bf16 v[152:155], v[84:87], a[16:19], v[152:155]
    v_mfma_f32_16x16x32_bf16 v[152:155], v[88:91], a[36:39], v[152:155]
    s_waitcnt vmcnt(12)
    v_mfma_f32_16x16x32_bf16 v[136:139], v[92:95], a[40:43], v[136:139]
    ds_write_b128 v24, v[124:127] offset:2048
    v_mfma_f32_16x16x32_bf16 v[136:139], v[32:35], a[60:63], v[136:139]
    buffer_load_dwordx4 v[84:87], v20, s[44:47], s65 offen sc1
    v_mfma_f32_16x16x32_bf16 v[140:143], v[32:35], a[64:67], v[140:143]
    s_add_u32 s65, s77, 458752
    v_mfma_f32_16x16x32_bf16 v[140:143], v[92:95], a[44:47], v[140:143]
    ds_read_b128 v[176:179], v14
    v_mfma_f32_16x16x32_bf16 v[144:147], v[92:95], a[48:51], v[144:147]
    ds_write_b128 v24, v[128:131] offset:3072
    v_mfma_f32_16x16x32_bf16 v[144:147], v[32:35], a[68:71], v[144:147]
    ds_read_b128 v[180:183], v14 offset:16
    v_mfma_f32_16x16x32_bf16 v[148:151], v[32:35], a[72:75], v[148:151]
    buffer_load_dwordx4 v[88:91], v20, s[44:47], s65 offen sc1
    v_mfma_f32_16x16x32_bf16 v[148:151], v[92:95], a[52:55], v[148:151]
    ds_write_b128 v24, v[132:135] offset:4096
    v_mfma_f32_16x16x32_bf16 v[152:155], v[92:95], a[56:59], v[152:155]
    s_add_u32 s65, s77, 475136
    v_mfma_f32_16x16x32_bf16 v[152:155], v[32:35], a[76:79], v[152:155]
    s_waitcnt vmcnt(12)
    v_mfma_f32_16x16x32_bf16 v[136:139], v[36:39], a[80:83], v[136:139]
    buffer_load_dwordx4 v[92:95], v20, s[44:47], s65 offen sc1
    v_mfma_f32_16x16x32_bf16 v[136:139], v[40:43], a[100:103], v[136:139]
    v_mfma_f32_16x16x32_bf16 v[140:143], v[40:43], a[104:107], v[140:143]
    v_mfma_f32_16x16x32_bf16 v[140:143], v[36:39], a[84:87], v[140:143]
    v_mfma_f32_16x16x32_bf16 v[144:147], v[36:39], a[88:91], v[144:147]
    s_waitcnt lgkmcnt(0)
    s_barrier
    v_mfma_f32_16x16x32_bf16 v[144:147], v[40:43], a[108:111], v[144:147]
    ds_read_b128 v[156:159], v21 offset:0
    s_add_u32 s65, s77, 491520
    v_mfma_f32_16x16x32_bf16 v[148:151], v[40:43], a[112:115], v[148:151]
    buffer_load_dwordx4 v[32:35], v20, s[44:47], s65 offen sc1
    v_mfma_f32_16x16x32_bf16 v[148:151], v[36:39], a[92:95], v[148:151]
    ds_read_b128 v[160:163], v21 offset:1024
    s_add_u32 s65, s77, 507904
    v_mfma_f32_16x16x32_bf16 v[152:155], v[36:39], a[96:99], v[152:155]
    v_fma_f32 v216, v196, v176, -v177
    v_fma_f32 v220, v200, v176, -v177
    v_mfma_f32_16x16x32_bf16 v[152:155], v[40:43], a[116:119], v[152:155]
    s_waitcnt vmcnt(12)
    v_fma_f32 v224, v204, v176, -v177
    v_fma_f32 v228, v208, v176, -v177
    v_mfma_f32_16x16x32_bf16 v[136:139], v[44:47], a[120:123], v[136:139]
    ds_read_b128 v[164:167], v21 offset:2048
    v_fma_f32 v232, v212, v176, -v177
    v_mfma_f32_16x16x32_bf16 v[136:139], v[48:51], a[140:143], v[136:139]
    ds_read_b128 v[168:171], v21 offset:3072
    v_mul_f32 v216, v216, v184
    v_mfma_f32_16x16x32_bf16 v[140:143], v[48:51], a[144:147], v[140:143]
    buffer_load_dwordx4 v[36:39], v20, s[44:47], s65 offen sc1
    v_mfma_f32_16x16x32_bf16 v[140:143], v[44:47], a[124:127], v[140:143]
    ds_read_b128 v[172:175], v21 offset:4096
    s_add_u32 s65, s77, 524288
    v_mfma_f32_16x16x32_bf16 v[144:147], v[44:47], a[128:131], v[144:147]
    v_mul_f32 v220, v220, v185
    v_mul_f32 v224, v224, v186
    v_mfma_f32_16x16x32_bf16 v[144:147], v[48:51], a[148:151], v[144:147]
    buffer_load_dwordx4 v[40:43], v20, s[44:47], s65 offen sc1
    v_mfma_f32_16x16x32_bf16 v[148:151], v[48:51], a[152:155], v[148:151]
    s_add_u32 s65, s77, 540672
    v_mul_f32 v228, v228, v187
    v_mul_f32 v232, v232, v188
    v_mfma_f32_16x16x32_bf16 v[148:151], v[44:47], a[132:135], v[148:151]
    v_fma_f32 v217, v197, v178, -v179
    v_fma_f32 v221, v201, v178, -v179
    v_mfma_f32_16x16x32_bf16 v[152:155], v[44:47], a[136:139], v[152:155]
    v_fma_f32 v225, v205, v178, -v179
    v_fma_f32 v229, v209, v178, -v179
    v_mfma_f32_16x16x32_bf16 v[152:155], v[48:51], a[156:159], v[152:155]
    s_waitcnt vmcnt(12)
    v_fma_f32 v233, v213, v178, -v179
    v_mul_f32 v217, v217, v184
    v_mfma_f32_16x16x32_bf16 v[136:139], v[52:55], a[160:163], v[136:139]
    buffer_load_dwordx4 v[44:47], v20, s[44:47], s65 offen sc1
    v_mfma_f32_16x16x32_bf16 v[136:139], v[56:59], a[180:183], v[136:139]
    s_add_u32 s65, s77, 557056
    v_mul_f32 v221, v221, v185
    v_mul_f32 v225, v225, v186
    v_mfma_f32_16x16x32_bf16 v[140:143], v[56:59], a[184:187], v[140:143]
    v_mul_f32 v229, v229, v187
    v_mul_f32 v233, v233, v188
    v_mfma_f32_16x16x32_bf16 v[140:143], v[52:55], a[164:167], v[140:143]
    v_fma_f32 v218, v198, v180, -v181
    v_fma_f32 v222, v202, v180, -v181
    v_mfma_f32_16x16x32_bf16 v[144:147], v[52:55], a[168:171], v[144:147]
    v_fma_f32 v226, v206, v180, -v181
    v_fma_f32 v230, v210, v180, -v181
    v_mfma_f32_16x16x32_bf16 v[144:147], v[56:59], a[188:191], v[144:147]
    buffer_load_dwordx4 v[48:51], v20, s[44:47], s65 offen sc1
L_FB_pad2:
    s_cbranch_execz L_FB_pad6
    v_mfma_f32_16x16x32_bf16 v[148:151], v[56:59], a[192:195], v[148:151]
    s_add_u32 s65, s77, 573440
    v_fma_f32 v234, v214, v180, -v181
    v_mul_f32 v218, v218, v184
    v_mfma_f32_16x16x32_bf16 v[148:151], v[52:55], a[172:175], v[148:151]
    v_mul_f32 v222, v222, v185
    v_mul_f32 v226, v226, v186
    v_mfma_f32_16x16x32_bf16 v[152:155], v[52:55], a[176:179], v[152:155]
    v_mul_f32 v230, v230, v187
    v_mul_f32 v234, v234, v188
    v_mfma_f32_16x16x32_bf16 v[152:155], v[56:59], a[196:199], v[152:155]
    s_waitcnt vmcnt(12)
    v_fma_f32 v219, v199, v182, -v183
    v_fma_f32 v223, v203, v182, -v183
    v_mfma_f32_16x16x32_bf16 v[136:139], v[60:63], a[200:203], v[136:139]
    buffer_load_dwordx4 v[52:55], v20, s[44:47], s65 offen sc1
    v_mfma_f32_16x16x32_bf16 v[136:139], v[64:67], a[220:223], v[136:139]
    s_add_u32 s65, s77, 589824
    v_fma_f32 v227, v207, v182, -v183
    v_fma_f32 v231, v211, v182, -v183
    v_mfma_f32_16x16x32_bf16 v[140:143], v[64:67], a[224:227], v[140:143]
    v_fma_f32 v235, v215, v182, -v183
    v_mul_f32 v219, v219, v184
    v_mfma_f32_16x16x32_bf16 v[140:143], v[60:63], a[204:207], v[140:143]
    v_mul_f32 v223, v223, v185
    v_mul_f32 v227, v227, v186
    v_mfma_f32_16x16x32_bf16 v[144:147], v[60:63], a[208:211], v[144:147]
    v_mul_f32 v231, v231, v187
    v_mul_f32 v235, v235, v188
    v_mfma_f32_16x16x32_bf16 v[144:147], v[64:67], a[228:231], v[144:147]
    buffer_load_dwordx4 v[56:59], v20, s[44:47], s65 offen sc1
    v_mfma_f32_16x16x32_bf16 v[148:151], v[64:67], a[232:235], v[148:151]
    s_add_u32 s65, s64, 606208
    v_lshlrev_b32 v176, 16, v108
    v_and_b32 v180, 0xffff0000, v108
    v_mfma_f32_16x16x32_bf16 v[148:151], v[60:63], a[212:215], v[148:151]
    v_lshlrev_b32 v184, 16, v109
    v_and_b32 v188, 0xffff0000, v109
    v_mfma_f32_16x16x32_bf16 v[152:155], v[60:63], a[216:219], v[152:155]
    v_lshlrev_b32 v192, 16, v110
    v_lshlrev_b32 v177, 16, v108
    v_mfma_f32_16x16x32_bf16 v[152:155], v[64:67], a[236:239], v[152:155]
    s_waitcnt vmcnt(13)
    v_and_b32 v181, 0xffff0000, v108
    v_lshlrev_b32 v185, 16, v109
    v_mfma_f32_16x16x32_bf16 v[136:139], v[68:71], a[240:243], v[136:139]
    buffer_load_dwordx4 v[60:63], v20, s[44:47], s65 offen sc1
    v_mfma_f32_16x16x32_bf16 v[140:143], v[68:71], a[244:247], v[140:143]
    s_add_u32 s65, s77, 393216
    v_and_b32 v189, 0xffff0000, v109
    v_lshlrev_b32 v193, 16, v110
    v_mfma_f32_16x16x32_bf16 v[144:147], v[68:71], a[248:251], v[144:147]
    v_lshlrev_b32 v178, 16, v108
    v_and_b32 v182, 0xffff0000, v108
    v_mfma_f32_16x16x32_bf16 v[148:151], v[68:71], a[252:255], v[148:151]
    v_lshlrev_b32 v186, 16, v109
    v_and_b32 v190, 0xffff0000, v109
    v_mfma_f32_16x16x32_bf16 v[152:155], v[68:71], v[28:31], v[152:155]
    s_waitcnt vmcnt(12)
    v_lshlrev_b32 v194, 16, v110
    v_lshlrev_b32 v179, 16, v108
    s_waitcnt lgkmcnt(4)
    v_mfma_f32_16x16x32_bf16 v[156:159], v[72:75], a[0:3], v[156:159]
    buffer_load_dwordx4 v[64:67], v1, s[44:47], s65 offen sc1
    v_mfma_f32_16x16x32_bf16 v[156:159], v[76:79], a[20:23], v[156:159]
    buffer_load_dword v8, v27, s[44:47], 0 offen sc1
    s_waitcnt lgkmcnt(3)
    v_mfma_f32_16x16x32_bf16 v[160:163], v[72:75], a[4:7], v[160:163]
    s_add_u32 s65, s77, 409600
    v_and_b32 v183, 0xffff0000, v108
    v_lshlrev_b32 v187, 16, v109
    v_mfma_f32_16x16x32_bf16 v[160:163], v[76:79], a[24:27], v[160:163]
    ds_write_b128 v24, v[136:139] offset:5120
    s_waitcnt lgkmcnt(3)
    v_mfma_f32_16x16x32_bf16 v[164:167], v[72:75], a[8:11], v[164:167]
    v_and_b32 v191, 0xffff0000, v109
    v_lshlrev_b32 v195, 16, v110
    v_mfma_f32_16x16x32_bf16 v[164:167], v[76:79], a[28:31], v[164:167]
    buffer_load_dwordx4 v[68:71], v1, s[44:47], s65 offen sc1
    s_waitcnt lgkmcnt(2)
    v_mfma_f32_16x16x32_bf16 v[168:171], v[72:75], a[12:15], v[168:171]
    s_add_u32 s65, s77, 425984
    v_mfma_f32_16x16x32_bf16 v[168:171], v[76:79], a[32:35], v[168:171]
    ds_write_b128 v24, v[140:143] offset:6144
    s_waitcnt lgkmcnt(2)
    v_mfma_f32_16x16x32_bf16 v[172:175], v[72:75], a[16:19], v[172:175]
    v_mfma_f32_16x16x32_bf16 v[172:175], v[76:79], a[36:39], v[172:175]
    s_waitcnt vmcnt(13)
    v_mfma_f32_16x16x32_bf16 v[156:159], v[80:83], a[40:43], v[156:159]
    ds_write_b128 v24, v[144:147] offset:7168
    v_mfma_f32_16x16x32_bf16 v[156:159], v[84:87], a[60:63], v[156:159]
    buffer_load_dwordx4 v[72:75], v1, s[44:47], s65 offen sc1
    v_mfma_f32_16x16x32_bf16 v[160:163], v[84:87], a[64:67], v[160:163]
    s_add_u32 s65, s77, 442368
    v_mfma_f32_16x16x32_bf16 v[160:163], v[80:83], a[44:47], v[160:163]
    v_mfma_f32_16x16x32_bf16 v[164:167], v[80:83], a[48:51], v[164:167]
    ds_write_b128 v24, v[148:151] offset:8192
    v_mfma_f32_16x16x32_bf16 v[164:167], v[84:87], a[68:71], v[164:167]
    buffer_load_dwordx4 v[76:79], v1, s[44:47], s65 offen sc1
    v_mfma_f32_16x16x32_bf16 v[168:171], v[84:87], a[72:75], v[168:171]
    s_add_u32 s65, s77, 458752
    v_mfma_f32_16x16x32_bf16 v[168:171], v[80:83], a[52:55], v[168:171]
    ds_write_b128 v24, v[152:155] offset:9216
    v_mfma_f32_16x16x32_bf16 v[172:175], v[80:83], a[56:59], v[172:175]
    v_mfma_f32_16x16x32_bf16 v[172:175], v[84:87], a[76:79], v[172:175]
    s_waitcnt vmcnt(13)
    v_mfma_f32_16x16x32_bf16 v[156:159], v[88:91], a[80:83], v[156:159]
    buffer_load_dwordx4 v[80:83], v1, s[44:47], s65 offen sc1
    v_mfma_f32_16x16x32_bf16 v[156:159], v[92:95], a[100:103], v[156:159]
    v_mfma_f32_16x16x32_bf16 v[160:163], v[92:95], a[104:107], v[160:163]
    v_mfma_f32_16x16x32_bf16 v[160:163], v[88:91], a[84:87], v[160:163]
    v_mfma_f32_16x16x32_bf16 v[164:167], v[88:91], a[88:91], v[164:167]
    s_waitcnt lgkmcnt(0)
    s_barrier
    v_mfma_f32_16x16x32_bf16 v[164:167], v[92:95], a[108:111], v[164:167]
    ds_read_b128 v[96:99], v22 offset:0
    s_add_u32 s65, s77, 475136
    v_mfma_f32_16x16x32_bf16 v[168:171], v[92:95], a[112:115], v[168:171]
    buffer_load_dwordx4 v[84:87], v1, s[44:47], s65 offen sc1
    v_mfma_f32_16x16x32_bf16 v[168:171], v[88:91], a[92:95], v[168:171]
    ds_read_b128 v[100:103], v22 offset:1024
    s_add_u32 s65, s77, 491520
    v_mfma_f32_16x16x32_bf16 v[172:175], v[88:91], a[96:99], v[172:175]
    v_mfma_f32_16x16x32_bf16 v[172:175], v[92:95], a[116:119], v[172:175]
    s_waitcnt vmcnt(13)
    v_mfma_f32_16x16x32_bf16 v[156:159], v[32:35], a[120:123], v[156:159]
    ds_read_b128 v[104:107], v22 offset:2048
    v_mfma_f32_16x16x32_bf16 v[156:159], v[36:39], a[140:143], v[156:159]
    ds_read_b128 v[108:111], v22 offset:3072
    v_mfma_f32_16x16x32_bf16 v[160:163], v[36:39], a[144:147], v[160:163]
    buffer_load_dwordx4 v[88:91], v1, s[44:47], s65 offen sc1
    v_mfma_f32_16x16x32_bf16 v[160:163], v[32:35], a[124:127], v[160:163]
    ds_read_b128 v[112:115], v22 offset:4096
    s_add_u32 s65, s77, 507904
    v_mfma_f32_16x16x32_bf16 v[164:167], v[32:35], a[128:131], v[164:167]
    v_mfma_f32_16x16x32_bf16 v[164:167], v[36:39], a[148:151], v[164:167]
    buffer_load_dwordx4 v[92:95], v1, s[44:47], s65 offen sc1
    v_mfma_f32_16x16x32_bf16 v[168:171], v[36:39], a[152:155], v[168:171]
    s_add_u32 s65, s77, 524288
    v_mfma_f32_16x16x32_bf16 v[168:171], v[32:35], a[132:135], v[168:171]
    v_mfma_f32_16x16x32_bf16 v[172:175], v[32:35], a[136:139], v[172:175]
    v_mfma_f32_16x16x32_bf16 v[172:175], v[36:39], a[156:159], v[172:175]
    s_waitcnt vmcnt(13)
    v_mfma_f32_16x16x32_bf16 v[156:159], v[40:43], a[160:163], v[156:159]
    buffer_load_dwordx4 v[32:35], v1, s[44:47], s65 offen sc1
    v_mfma_f32_16x16x32_bf16 v[156:159], v[44:47], a[180:183], v[156:159]
    s_add_u32 s65, s77, 540672
    v_mfma_f32_16x16x32_bf16 v[160:163], v[44:47], a[184:187], v[160:163]
    v_mfma_f32_16x16x32_bf16 v[160:163], v[40:43], a[164:167], v[160:163]
    v_mfma_f32_16x16x32_bf16 v[164:167], v[40:43], a[168:171], v[164:167]
    v_mfma_f32_16x16x32_bf16 v[164:167], v[44:47], a[188:191], v[164:167]
    buffer_load_dwordx4 v[36:39], v1, s[44:47], s65 offen sc1
    v_mfma_f32_16x16x32_bf16 v[168:171], v[44:47], a[192:195], v[168:171]
L_FB_pad3:
    s_cbranch_execz L_FB_pad7
    s_add_u32 s65, s77, 557056
    v_mfma_f32_16x16x32_bf16 v[168:171], v[40:43], a[172:175], v[168:171]
    v_mfma_f32_16x16x32_bf16 v[172:175], v[40:43], a[176:179], v[172:175]
    v_mfma_f32_16x16x32_bf16 v[172:175], v[44:47], a[196:199], v[172:175]
    s_waitcnt vmcnt(13)
    v_mfma_f32_16x16x32_bf16 v[156:159], v[48:51], a[200:203], v[156:159]
    buffer_load_dwordx4 v[40:43], v1, s[44:47], s65 offen sc1
    v_mfma_f32_16x16x32_bf16 v[156:159], v[52:55], a[220:223], v[156:159]
    s_add_u32 s65, s77, 573440
    v_mfma_f32_16x16x32_bf16 v[160:163], v[52:55], a[224:227], v[160:163]
    v_mfma_f32_16x16x32_bf16 v[160:163], v[48:51], a[204:207], v[160:163]
    v_mfma_f32_16x16x32_bf16 v[164:167], v[48:51], a[208:211], v[164:167]
    v_mfma_f32_16x16x32_bf16 v[164:167], v[52:55], a[228:231], v[164:167]
    buffer_load_dwordx4 v[44:47], v1, s[44:47], s65 offen sc1
    v_mfma_f32_16x16x32_bf16 v[168:171], v[52:55], a[232:235], v[168:171]
    s_add_u32 s65, s77, 589824
    v_mfma_f32_16x16x32_bf16 v[168:171], v[48:51], a[212:215], v[168:171]
    v_mfma_f32_16x16x32_bf16 v[172:175], v[48:51], a[216:219], v[172:175]
    v_mfma_f32_16x16x32_bf16 v[172:175], v[52:55], a[236:239], v[172:175]
    s_waitcnt vmcnt(13)
    v_mfma_f32_16x16x32_bf16 v[156:159], v[56:59], a[240:243], v[156:159]
    buffer_load_dwordx4 v[48:51], v1, s[44:47], s65 offen sc1
    v_mfma_f32_16x16x32_bf16 v[156:159], v[60:63], v[236:239], v[156:159]
    s_add_u32 s65, s64, 606208
    v_mfma_f32_16x16x32_bf16 v[160:163], v[60:63], v[240:243], v[160:163]
    v_mfma_f32_16x16x32_bf16 v[160:163], v[56:59], a[244:247], v[160:163]
    v_mfma_f32_16x16x32_bf16 v[164:167], v[56:59], a[248:251], v[164:167]
    v_mfma_f32_16x16x32_bf16 v[164:167], v[60:63], v[244:247], v[164:167]
    buffer_load_dwordx4 v[52:55], v1, s[44:47], s65 offen sc1
    v_mfma_f32_16x16x32_bf16 v[168:171], v[60:63], v[248:251], v[168:171]
    v_mfma_f32_16x16x32_bf16 v[168:171], v[56:59], a[252:255], v[168:171]
    v_mfma_f32_16x16x32_bf16 v[172:175], v[56:59], v[28:31], v[172:175]
    v_mfma_f32_16x16x32_bf16 v[172:175], v[60:63], v[252:255], v[172:175]
    s_waitcnt vmcnt(12)
    v_cmp_ne_u32 vcc, s66, v8
    s_cbranch_vccz L_F_f1b_ok
    s_mov_b32 s25, 0
L_F_f1b_retry:

    buffer_load_dword v8, v27, s[44:47], 0 offen sc1
    s_add_u32 s25, s25, 1
    s_waitcnt vmcnt(0)
    v_cmp_ne_u32 vcc, s66, v8
    s_cmp_ge_u32 s25, 100000
    s_cbranch_scc1 L_F_f1b_ok
    s_cbranch_vccnz L_F_f1b_retry
L_F_f1b_ok:
    s_waitcnt lgkmcnt(4)
    v_mfma_f32_16x16x32_bf16 v[96:99], v[64:67], a[0:3], v[96:99]
    s_add_u32 s65, s77, 0
    v_mfma_f32_16x16x32_bf16 v[96:99], v[68:71], a[20:23], v[96:99]
    buffer_load_dwordx4 v[56:59], v18, s[44:47], s65 offen sc1
    s_waitcnt lgkmcnt(3)
    v_mfma_f32_16x16x32_bf16 v[100:103], v[64:67], a[4:7], v[100:103]
    s_add_u32 s65, s77, 16384
    v_mfma_f32_16x16x32_bf16 v[100:103], v[68:71], a[24:27], v[100:103]
    ds_write_b128 v24, v[156:159] offset:10240
    s_waitcnt lgkmcnt(3)
    v_mfma_f32_16x16x32_bf16 v[104:107], v[64:67], a[8:11], v[104:107]
    v_mfma_f32_16x16x32_bf16 v[104:107], v[68:71], a[28:31], v[104:107]
    buffer_load_dwordx4 v[60:63], v18, s[44:47], s65 offen sc1
    s_waitcnt lgkmcnt(2)
    v_mfma_f32_16x16x32_bf16 v[108:111], v[64:67], a[12:15], v[108:111]
    s_add_u32 s65, s77, 32768
    v_mfma_f32_16x16x32_bf16 v[108:111], v[68:71], a[32:35], v[108:111]
    ds_write_b128 v24, v[160:163] offset:11264
    s_waitcnt lgkmcnt(2)
    v_mfma_f32_16x16x32_bf16 v[112:115], v[64:67], a[16:19], v[112:115]
    v_mfma_f32_16x16x32_bf16 v[112:115], v[68:71], a[36:39], v[112:115]
    s_waitcnt vmcnt(12)
    v_mfma_f32_16x16x32_bf16 v[96:99], v[72:75], a[40:43], v[96:99]
    ds_write_b128 v24, v[164:167] offset:12288
    v_mfma_f32_16x16x32_bf16 v[96:99], v[76:79], a[60:63], v[96:99]
    buffer_load_dwordx4 v[64:67], v18, s[44:47], s65 offen sc1
    v_mfma_f32_16x16x32_bf16 v[100:103], v[76:79], a[64:67], v[100:103]
    s_add_u32 s65, s77, 49152
    v_mfma_f32_16x16x32_bf16 v[100:103], v[72:75], a[44:47], v[100:103]
    v_mfma_f32_16x16x32_bf16 v[104:107], v[72:75], a[48:51], v[104:107]
    ds_write_b128 v24, v[168:171] offset:13312
    v_mfma_f32_16x16x32_bf16 v[104:107], v[76:79], a[68:71], v[104:107]
    buffer_load_dwordx4 v[68:71], v18, s[44:47], s65 offen sc1
    v_mfma_f32_16x16x32_bf16 v[108:111], v[76:79], a[72:75], v[108:111]
    s_add_u32 s65, s77, 65536
    v_mfma_f32_16x16x32_bf16 v[108:111], v[72:75], a[52:55], v[108:111]
    ds_write_b128 v24, v[172:175] offset:14336
    v_mfma_f32_16x16x32_bf16 v[112:115], v[72:75], a[56:59], v[112:115]
    v_mfma_f32_16x16x32_bf16 v[112:115], v[76:79], a[76:79], v[112:115]
    s_waitcnt vmcnt(12)
    v_mfma_f32_16x16x32_bf16 v[96:99], v[80:83], a[80:83], v[96:99]
    buffer_load_dwordx4 v[72:75], v18, s[44:47], s65 offen sc1
    v_mfma_f32_16x16x32_bf16 v[96:99], v[84:87], a[100:103], v[96:99]
    v_mfma_f32_16x16x32_bf16 v[100:103], v[84:87], a[104:107], v[100:103]
    v_mfma_f32_16x16x32_bf16 v[100:103], v[80:83], a[84:87], v[100:103]
    v_mfma_f32_16x16x32_bf16 v[104:107], v[80:83], a[88:91], v[104:107]
    s_waitcnt lgkmcnt(0)
    s_barrier
    v_mfma_f32_16x16x32_bf16 v[104:107], v[84:87], a[108:111], v[104:107]
    ds_read_b128 v[116:119], v23 offset:0
    s_add_u32 s65, s77, 81920
    v_mfma_f32_16x16x32_bf16 v[108:111], v[84:87], a[112:115], v[108:111]
    buffer_load_dwordx4 v[76:79], v18, s[44:47], s65 offen sc1
    v_mfma_f32_16x16x32_bf16 v[108:111], v[80:83], a[92:95], v[108:111]
    ds_read_b128 v[120:123], v23 offset:1024
    s_add_u32 s65, s77, 98304
    v_mfma_f32_16x16x32_bf16 v[112:115], v[80:83], a[96:99], v[112:115]
    v_lshlrev_b32 v14, 4, v0
    v_lshrrev_b32 v14, v14, v16
    v_mfma_f32_16x16x32_bf16 v[112:115], v[84:87], a[116:119], v[112:115]
    s_waitcnt vmcnt(12)
    v_lshlrev_b32 v14, 16, v14
    v_mov_b32 v147, v14
    v_mfma_f32_16x16x32_bf16 v[96:99], v[88:91], a[120:123], v[96:99]
    ds_read_b128 v[124:127], v23 offset:2048
    s_mov_b32 s68, 0xffff
    v_mfma_f32_16x16x32_bf16 v[96:99], v[92:95], a[140:143], v[96:99]
    ds_read_b128 v[128:131], v23 offset:3072
    v_mfma_f32_16x16x32_bf16 v[100:103], v[92:95], a[144:147], v[100:103]
    buffer_load_dwordx4 v[80:83], v18, s[44:47], s65 offen sc1
    v_mfma_f32_16x16x32_bf16 v[100:103], v[88:91], a[124:127], v[100:103]
    ds_read_b128 v[132:135], v23 offset:4096
L_FB_pad4:
    s_cbranch_execz L_FB_pad8
    s_add_u32 s65, s77, 114688
    v_mfma_f32_16x16x32_bf16 v[104:107], v[88:91], a[128:131], v[104:107]
    v_mfma_f32_16x16x32_bf16 v[104:107], v[92:95], a[148:151], v[104:107]
    buffer_load_dwordx4 v[84:87], v18, s[44:47], s65 offen sc1
    v_mfma_f32_16x16x32_bf16 v[108:111], v[92:95], a[152:155], v[108:111]
    s_add_u32 s65, s77, 131072
    v_mfma_f32_16x16x32_bf16 v[108:111], v[88:91], a[132:135], v[108:111]
    v_mfma_f32_16x16x32_bf16 v[112:115], v[88:91], a[136:139], v[112:115]
    v_mfma_f32_16x16x32_bf16 v[112:115], v[92:95], a[156:159], v[112:115]
    s_waitcnt vmcnt(12)
    v_mfma_f32_16x16x32_bf16 v[96:99], v[32:35], a[160:163], v[96:99]
    buffer_load_dwordx4 v[88:91], v18, s[44:47], s65 offen sc1
    v_mfma_f32_16x16x32_bf16 v[96:99], v[36:39], a[180:183], v[96:99]
    s_add_u32 s65, s77, 147456
    v_mfma_f32_16x16x32_bf16 v[100:103], v[36:39], a[184:187], v[100:103]
    v_mfma_f32_16x16x32_bf16 v[100:103], v[32:35], a[164:167], v[100:103]
    v_mfma_f32_16x16x32_bf16 v[104:107], v[32:35], a[168:171], v[104:107]
    v_mfma_f32_16x16x32_bf16 v[104:107], v[36:39], a[188:191], v[104:107]
    buffer_load_dwordx4 v[92:95], v18, s[44:47], s65 offen sc1
    v_mfma_f32_16x16x32_bf16 v[108:111], v[36:39], a[192:195], v[108:111]
    s_add_u32 s65, s77, 163840
    v_mfma_f32_16x16x32_bf16 v[108:111], v[32:35], a[172:175], v[108:111]
    v_mfma_f32_16x16x32_bf16 v[112:115], v[32:35], a[176:179], v[112:115]
    v_mfma_f32_16x16x32_bf16 v[112:115], v[36:39], a[196:199], v[112:115]
    s_waitcnt vmcnt(12)
    v_mfma_f32_16x16x32_bf16 v[96:99], v[40:43], a[200:203], v[96:99]
    buffer_load_dwordx4 v[32:35], v18, s[44:47], s65 offen sc1
    v_mfma_f32_16x16x32_bf16 v[96:99], v[44:47], a[220:223], v[96:99]
    s_add_u32 s65, s77, 180224
    v_mfma_f32_16x16x32_bf16 v[100:103], v[44:47], a[224:227], v[100:103]
    v_mfma_f32_16x16x32_bf16 v[100:103], v[40:43], a[204:207], v[100:103]
    v_mfma_f32_16x16x32_bf16 v[104:107], v[40:43], a[208:211], v[104:107]
    v_mfma_f32_16x16x32_bf16 v[104:107], v[44:47], a[228:231], v[104:107]
    buffer_load_dwordx4 v[36:39], v18, s[44:47], s65 offen sc1
    v_mfma_f32_16x16x32_bf16 v[108:111], v[44:47], a[232:235], v[108:111]
    s_add_u32 s65, s77, 196608
    v_mfma_f32_16x16x32_bf16 v[108:111], v[40:43], a[212:215], v[108:111]
    v_mfma_f32_16x16x32_bf16 v[112:115], v[40:43], a[216:219], v[112:115]
    v_mfma_f32_16x16x32_bf16 v[112:115], v[44:47], a[236:239], v[112:115]
    s_waitcnt vmcnt(12)
    v_mfma_f32_16x16x32_bf16 v[96:99], v[48:51], a[240:243], v[96:99]
    buffer_load_dwordx4 v[40:43], v18, s[44:47], s65 offen sc1
    v_mfma_f32_16x16x32_bf16 v[96:99], v[52:55], v[236:239], v[96:99]
    s_add_u32 s65, s77, 0
    v_mfma_f32_16x16x32_bf16 v[100:103], v[52:55], v[240:243], v[100:103]
    v_mfma_f32_16x16x32_bf16 v[100:103], v[48:51], a[244:247], v[100:103]
    v_mfma_f32_16x16x32_bf16 v[104:107], v[48:51], a[248:251], v[104:107]
    v_mfma_f32_16x16x32_bf16 v[104:107], v[52:55], v[244:247], v[104:107]
    buffer_load_dwordx4 v[44:47], v19, s[44:47], s65 offen sc1
    v_mfma_f32_16x16x32_bf16 v[108:111], v[52:55], v[248:251], v[108:111]
    s_add_u32 s65, s77, 16384
    v_mfma_f32_16x16x32_bf16 v[108:111], v[48:51], a[252:255], v[108:111]
    v_mfma_f32_16x16x32_bf16 v[112:115], v[48:51], v[28:31], v[112:115]
    v_mfma_f32_16x16x32_bf16 v[112:115], v[52:55], v[252:255], v[112:115]
    s_waitcnt vmcnt(12)
    v_mfma_f32_16x16x32_bf16 v[176:179], v[56:59], a[0:3], v[176:179]
    buffer_load_dwordx4 v[48:51], v19, s[44:47], s65 offen sc1
    v_mfma_f32_16x16x32_bf16 v[176:179], v[60:63], a[20:23], v[176:179]
    s_add_u32 s65, s77, 32768
    v_mfma_f32_16x16x32_bf16 v[180:183], v[56:59], a[4:7], v[180:183]
    v_mfma_f32_16x16x32_bf16 v[180:183], v[60:63], a[24:27], v[180:183]
    s_waitcnt lgkmcnt(4)
    v_add_f32 v96, v96, v116
    v_add_f32 v97, v97, v117
    v_mfma_f32_16x16x32_bf16 v[184:187], v[56:59], a[8:11], v[184:187]
    v_cvt_pk_bf16_f32 v136, v96, v97
    v_add_f32 v98, v98, v118
    v_mfma_f32_16x16x32_bf16 v[184:187], v[60:63], a[28:31], v[184:187]
    buffer_load_dwordx4 v[52:55], v19, s[44:47], s65 offen sc1
    v_mfma_f32_16x16x32_bf16 v[188:191], v[56:59], a[12:15], v[188:191]
    s_add_u32 s65, s77, 49152
    v_add_f32 v99, v99, v119
    v_cvt_pk_bf16_f32 v137, v98, v99
    v_mfma_f32_16x16x32_bf16 v[188:191], v[60:63], a[32:35], v[188:191]
    s_waitcnt lgkmcnt(3)
    v_add_f32 v100, v100, v120
    v_add_f32 v101, v101, v121
    v_mfma_f32_16x16x32_bf16 v[192:195], v[56:59], a[16:19], v[192:195]
    v_cvt_pk_bf16_f32 v138, v100, v101
    v_add_f32 v102, v102, v122
    v_mfma_f32_16x16x32_bf16 v[192:195], v[60:63], a[36:39], v[192:195]
    s_waitcnt vmcnt(12)
    v_cvt_pk_bf16_f32 v139, v102, v102
    v_bfi_b32 v139, s68, v139, v14
    v_mfma_f32_16x16x32_bf16 v[176:179], v[64:67], a[40:43], v[176:179]
    buffer_load_dwordx4 v[56:59], v19, s[44:47], s65 offen sc1
    v_mfma_f32_16x16x32_bf16 v[176:179], v[68:71], a[60:63], v[176:179]
    s_add_u32 s65, s77, 65536
    v_add_f32 v103, v103, v123
    s_waitcnt lgkmcnt(2)
    v_add_f32 v104, v104, v124
    v_mfma_f32_16x16x32_bf16 v[180:183], v[68:71], a[64:67], v[180:183]
    v_cvt_pk_bf16_f32 v140, v103, v104
    v_add_f32 v105, v105, v125
    v_mfma_f32_16x16x32_bf16 v[180:183], v[64:67], a[44:47], v[180:183]
    v_add_f32 v106, v106, v126
    v_cvt_pk_bf16_f32 v141, v105, v106
    v_mfma_f32_16x16x32_bf16 v[184:187], v[64:67], a[48:51], v[184:187]
    v_add_f32 v107, v107, v127
    s_waitcnt lgkmcnt(1)
    v_add_f32 v108, v108, v128
    v_mfma_f32_16x16x32_bf16 v[184:187], v[68:71], a[68:71], v[184:187]
    buffer_load_dwordx4 v[60:63], v19, s[44:47], s65 offen sc1
    v_mfma_f32_16x16x32_bf16 v[188:191], v[68:71], a[72:75], v[188:191]
    s_add_u32 s65, s77, 81920
    v_cvt_pk_bf16_f32 v142, v107, v108
    v_add_f32 v109, v109, v129
    v_mfma_f32_16x16x32_bf16 v[188:191], v[64:67], a[52:55], v[188:191]
    v_cvt_pk_bf16_f32 v143, v109, v109
    v_bfi_b32 v143, s68, v143, v14
    v_mfma_f32_16x16x32_bf16 v[192:195], v[64:67], a[56:59], v[192:195]
    v_add_f32 v110, v110, v130
    v_add_f32 v111, v111, v131
    v_mfma_f32_16x16x32_bf16 v[192:195], v[68:71], a[76:79], v[192:195]
    s_waitcnt vmcnt(12)
    v_cvt_pk_bf16_f32 v144, v110, v111
    s_waitcnt lgkmcnt(0)
    v_add_f32 v112, v112, v132
    v_mfma_f32_16x16x32_bf16 v[176:179], v[72:75], a[80:83], v[176:179]
    buffer_load_dwordx4 v[64:67], v19, s[44:47], s65 offen sc1
    v_mfma_f32_16x16x32_bf16 v[176:179], v[76:79], a[100:103], v[176:179]
    s_add_u32 s65, s77, 98304
    v_add_f32 v113, v113, v133
    v_cvt_pk_bf16_f32 v145, v112, v113
    v_mfma_f32_16x16x32_bf16 v[180:183], v[76:79], a[104:107], v[180:183]
    v_add_f32 v114, v114, v134
    v_add_f32 v115, v115, v135
    v_mfma_f32_16x16x32_bf16 v[180:183], v[72:75], a[84:87], v[180:183]
    v_cvt_pk_bf16_f32 v146, v114, v115
    v_mfma_f32_16x16x32_bf16 v[184:187], v[72:75], a[88:91], v[184:187]
    buffer_store_dwordx4 v[136:139], v15, s[44:47], s62 offen offset:0 sc1
    v_mfma_f32_16x16x32_bf16 v[184:187], v[76:79], a[108:111], v[184:187]
    buffer_store_dwordx4 v[140:143], v15, s[44:47], s62 offen offset:1024 sc1
    v_mfma_f32_16x16x32_bf16 v[188:191], v[76:79], a[112:115], v[188:191]
    buffer_store_dwordx4 v[144:147], v15, s[44:47], s62 offen offset:2048 sc1
    v_mfma_f32_16x16x32_bf16 v[188:191], v[72:75], a[92:95], v[188:191]
    buffer_load_dwordx4 v[68:71], v19, s[44:47], s65 offen sc1
    v_mfma_f32_16x16x32_bf16 v[192:195], v[72:75], a[96:99], v[192:195]
    s_add_u32 s65, s77, 114688
    v_mfma_f32_16x16x32_bf16 v[192:195], v[76:79], a[116:119], v[192:195]
    s_waitcnt vmcnt(15)
    v_mfma_f32_16x16x32_bf16 v[176:179], v[80:83], a[120:123], v[176:179]
    buffer_load_dwordx4 v[72:75], v19, s[44:47], s65 offen sc1
    v_mfma_f32_16x16x32_bf16 v[176:179], v[84:87], a[140:143], v[176:179]
    s_add_u32 s65, s77, 131072
    v_mfma_f32_16x16x32_bf16 v[180:183], v[84:87], a[144:147], v[180:183]
    v_mfma_f32_16x16x32_bf16 v[180:183], v[80:83], a[124:127], v[180:183]
    v_mfma_f32_16x16x32_bf16 v[184:187], v[80:83], a[128:131], v[184:187]
    v_mfma_f32_16x16x32_bf16 v[184:187], v[84:87], a[148:151], v[184:187]
    buffer_load_dwordx4 v[76:79], v19, s[44:47], s65 offen sc1
    v_mfma_f32_16x16x32_bf16 v[188:191], v[84:87], a[152:155], v[188:191]
    s_add_u32 s65, s77, 147456
L_FB_pad5:
    s_cbranch_execz L_FB_ret
    v_mfma_f32_16x16x32_bf16 v[188:191], v[80:83], a[132:135], v[188:191]
    v_mfma_f32_16x16x32_bf16 v[192:195], v[80:83], a[136:139], v[192:195]
    v_mfma_f32_16x16x32_bf16 v[192:195], v[84:87], a[156:159], v[192:195]
    s_waitcnt vmcnt(15)
    v_mfma_f32_16x16x32_bf16 v[176:179], v[88:91], a[160:163], v[176:179]
    buffer_load_dwordx4 v[80:83], v19, s[44:47], s65 offen sc1
    v_mfma_f32_16x16x32_bf16 v[176:179], v[92:95], a[180:183], v[176:179]
    s_add_u32 s65, s77, 163840
    v_mfma_f32_16x16x32_bf16 v[180:183], v[92:95], a[184:187], v[180:183]
    v_mfma_f32_16x16x32_bf16 v[180:183], v[88:91], a[164:167], v[180:183]
    v_mfma_f32_16x16x32_bf16 v[184:187], v[88:91], a[168:171], v[184:187]
    v_mfma_f32_16x16x32_bf16 v[184:187], v[92:95], a[188:191], v[184:187]
    buffer_load_dwordx4 v[84:87], v19, s[44:47], s65 offen sc1
    v_mfma_f32_16x16x32_bf16 v[188:191], v[92:95], a[192:195], v[188:191]
    s_add_u32 s65, s77, 180224
    v_mfma_f32_16x16x32_bf16 v[188:191], v[88:91], a[172:175], v[188:191]
    v_mfma_f32_16x16x32_bf16 v[192:195], v[88:91], a[176:179], v[192:195]
    v_mfma_f32_16x16x32_bf16 v[192:195], v[92:95], a[196:199], v[192:195]
    s_waitcnt vmcnt(15)
    v_mfma_f32_16x16x32_bf16 v[176:179], v[32:35], a[200:203], v[176:179]
    buffer_load_dwordx4 v[88:91], v19, s[44:47], s65 offen sc1
    v_mfma_f32_16x16x32_bf16 v[176:179], v[36:39], a[220:223], v[176:179]
    s_add_u32 s65, s77, 196608
    v_mfma_f32_16x16x32_bf16 v[180:183], v[36:39], a[224:227], v[180:183]
    v_mfma_f32_16x16x32_bf16 v[180:183], v[32:35], a[204:207], v[180:183]
    v_mfma_f32_16x16x32_bf16 v[184:187], v[32:35], a[208:211], v[184:187]
    v_mfma_f32_16x16x32_bf16 v[184:187], v[36:39], a[228:231], v[184:187]
    buffer_load_dwordx4 v[92:95], v19, s[44:47], s65 offen sc1
    v_mfma_f32_16x16x32_bf16 v[188:191], v[36:39], a[232:235], v[188:191]
    s_add_u32 s65, s77, 0
    v_mfma_f32_16x16x32_bf16 v[188:191], v[32:35], a[212:215], v[188:191]
    v_mfma_f32_16x16x32_bf16 v[192:195], v[32:35], a[216:219], v[192:195]
    v_mfma_f32_16x16x32_bf16 v[192:195], v[36:39], a[236:239], v[192:195]
    s_waitcnt vmcnt(16)
    v_mfma_f32_16x16x32_bf16 v[176:179], v[40:43], a[240:243], v[176:179]
    buffer_load_dwordx4 v[32:35], v20, s[44:47], s65 offen sc1
    v_mfma_f32_16x16x32_bf16 v[180:183], v[40:43], a[244:247], v[180:183]
    s_add_u32 s65, s77, 16384
    v_mfma_f32_16x16x32_bf16 v[184:187], v[40:43], a[248:251], v[184:187]
    v_mfma_f32_16x16x32_bf16 v[188:191], v[40:43], a[252:255], v[188:191]
    v_mfma_f32_16x16x32_bf16 v[192:195], v[40:43], v[28:31], v[192:195]
    s_waitcnt vmcnt(15)
    v_mfma_f32_16x16x32_bf16 v[116:119], v[44:47], a[0:3], 0
    buffer_load_dwordx4 v[36:39], v20, s[44:47], s65 offen sc1
    v_mfma_f32_16x16x32_bf16 v[116:119], v[48:51], a[20:23], v[116:119]
    s_add_u32 s65, s77, 32768
    v_mfma_f32_16x16x32_bf16 v[120:123], v[44:47], a[4:7], 0
    v_mfma_f32_16x16x32_bf16 v[120:123], v[48:51], a[24:27], v[120:123]
    ds_write_b128 v24, v[176:179] offset:15360
    v_mfma_f32_16x16x32_bf16 v[124:127], v[44:47], a[8:11], 0
    v_mfma_f32_16x16x32_bf16 v[124:127], v[48:51], a[28:31], v[124:127]
    buffer_load_dwordx4 v[40:43], v20, s[44:47], s65 offen sc1
    v_mfma_f32_16x16x32_bf16 v[128:131], v[44:47], a[12:15], 0
    s_add_u32 s65, s77, 49152
    v_mfma_f32_16x16x32_bf16 v[128:131], v[48:51], a[32:35], v[128:131]
    ds_write_b128 v24, v[180:183] offset:16384
    v_mfma_f32_16x16x32_bf16 v[132:135], v[44:47], a[16:19], 0
    v_mfma_f32_16x16x32_bf16 v[132:135], v[48:51], a[36:39], v[132:135]
    s_waitcnt vmcnt(15)
    v_mfma_f32_16x16x32_bf16 v[116:119], v[52:55], a[40:43], v[116:119]
    ds_write_b128 v24, v[184:187] offset:17408
    v_mfma_f32_16x16x32_bf16 v[116:119], v[56:59], a[60:63], v[116:119]
    buffer_load_dwordx4 v[44:47], v20, s[44:47], s65 offen sc1
    v_mfma_f32_16x16x32_bf16 v[120:123], v[56:59], a[64:67], v[120:123]
    s_add_u32 s65, s77, 65536
    v_mfma_f32_16x16x32_bf16 v[120:123], v[52:55], a[44:47], v[120:123]
    v_mfma_f32_16x16x32_bf16 v[124:127], v[52:55], a[48:51], v[124:127]
    ds_write_b128 v24, v[188:191] offset:18432
    v_mfma_f32_16x16x32_bf16 v[124:127], v[56:59], a[68:71], v[124:127]
    buffer_load_dwordx4 v[48:51], v20, s[44:47], s65 offen sc1
    v_mfma_f32_16x16x32_bf16 v[128:131], v[56:59], a[72:75], v[128:131]
    s_add_u32 s65, s77, 81920
    v_mfma_f32_16x16x32_bf16 v[128:131], v[52:55], a[52:55], v[128:131]
    ds_write_b128 v24, v[192:195] offset:19456
    v_mfma_f32_16x16x32_bf16 v[132:135], v[52:55], a[56:59], v[132:135]
    v_mfma_f32_16x16x32_bf16 v[132:135], v[56:59], a[76:79], v[132:135]
    s_waitcnt vmcnt(15)
    v_mfma_f32_16x16x32_bf16 v[116:119], v[60:63], a[80:83], v[116:119]
    buffer_load_dwordx4 v[52:55], v20, s[44:47], s65 offen sc1
    v_mfma_f32_16x16x32_bf16 v[116:119], v[64:67], a[100:103], v[116:119]
    v_mfma_f32_16x16x32_bf16 v[120:123], v[64:67], a[104:107], v[120:123]
    v_mfma_f32_16x16x32_bf16 v[120:123], v[60:63], a[84:87], v[120:123]
    v_mfma_f32_16x16x32_bf16 v[124:127], v[60:63], a[88:91], v[124:127]
    s_waitcnt lgkmcnt(0)
    s_barrier
    v_mfma_f32_16x16x32_bf16 v[124:127], v[64:67], a[108:111], v[124:127]
    ds_read_b128 v[136:139], v21 offset:15360
    s_add_u32 s65, s77, 98304
    v_mfma_f32_16x16x32_bf16 v[128:131], v[64:67], a[112:115], v[128:131]
    buffer_load_dwordx4 v[56:59], v20, s[44:47], s65 offen sc1
    v_mfma_f32_16x16x32_bf16 v[128:131], v[60:63], a[92:95], v[128:131]
    ds_read_b128 v[140:143], v21 offset:16384
    s_add_u32 s65, s77, 114688
    v_mfma_f32_16x16x32_bf16 v[132:135], v[60:63], a[96:99], v[132:135]
    v_mfma_f32_16x16x32_bf16 v[132:135], v[64:67], a[116:119], v[132:135]
    s_waitcnt vmcnt(12)
    v_mfma_f32_16x16x32_bf16 v[116:119], v[68:71], a[120:123], v[116:119]
    ds_read_b128 v[144:147], v21 offset:17408
    v_mfma_f32_16x16x32_bf16 v[116:119], v[72:75], a[140:143], v[116:119]
    ds_read_b128 v[148:151], v21 offset:18432
    v_mfma_f32_16x16x32_bf16 v[120:123], v[72:75], a[144:147], v[120:123]
    buffer_load_dwordx4 v[60:63], v20, s[44:47], s65 offen sc1
    v_mfma_f32_16x16x32_bf16 v[120:123], v[68:71], a[124:127], v[120:123]
    ds_read_b128 v[152:155], v21 offset:19456
    s_add_u32 s65, s77, 131072
    v_mfma_f32_16x16x32_bf16 v[124:127], v[68:71], a[128:131], v[124:127]
    v_mfma_f32_16x16x32_bf16 v[124:127], v[72:75], a[148:151], v[124:127]
    buffer_load_dwordx4 v[64:67], v20, s[44:47], s65 offen sc1
    v_mfma_f32_16x16x32_bf16 v[128:131], v[72:75], a[152:155], v[128:131]
    s_add_u32 s65, s77, 147456
    v_mfma_f32_16x16x32_bf16 v[128:131], v[68:71], a[132:135], v[128:131]
    v_mfma_f32_16x16x32_bf16 v[132:135], v[68:71], a[136:139], v[132:135]
    v_mfma_f32_16x16x32_bf16 v[132:135], v[72:75], a[156:159], v[132:135]
    s_waitcnt vmcnt(12)
    v_mfma_f32_16x16x32_bf16 v[116:119], v[76:79], a[160:163], v[116:119]
    buffer_load_dwordx4 v[68:71], v20, s[44:47], s65 offen sc1
    v_mfma_f32_16x16x32_bf16 v[116:119], v[80:83], a[180:183], v[116:119]
    s_add_u32 s65, s77, 163840
    v_mfma_f32_16x16x32_bf16 v[120:123], v[80:83], a[184:187], v[120:123]
    v_mfma_f32_16x16x32_bf16 v[120:123], v[76:79], a[164:167], v[120:123]
    v_mfma_f32_16x16x32_bf16 v[124:127], v[76:79], a[168:171], v[124:127]
    v_mfma_f32_16x16x32_bf16 v[124:127], v[80:83], a[188:191], v[124:127]
    buffer_load_dwordx4 v[72:75], v20, s[44:47], s65 offen sc1
    v_mfma_f32_16x16x32_bf16 v[128:131], v[80:83], a[192:195], v[128:131]
    s_add_u32 s65, s77, 180224
    v_mfma_f32_16x16x32_bf16 v[128:131], v[76:79], a[172:175], v[128:131]
    v_mfma_f32_16x16x32_bf16 v[132:135], v[76:79], a[176:179], v[132:135]
    v_mfma_f32_16x16x32_bf16 v[132:135], v[80:83], a[196:199], v[132:135]
    s_waitcnt vmcnt(12)
    v_mfma_f32_16x16x32_bf16 v[116:119], v[84:87], a[200:203], v[116:119]
    buffer_load_dwordx4 v[76:79], v20, s[44:47], s65 offen sc1
    v_mfma_f32_16x16x32_bf16 v[116:119], v[88:91], a[220:223], v[116:119]
    s_add_u32 s65, s77, 196608
    v_mfma_f32_16x16x32_bf16 v[120:123], v[88:91], a[224:227], v[120:123]
    v_mfma_f32_16x16x32_bf16 v[120:123], v[84:87], a[204:207], v[120:123]
    v_mfma_f32_16x16x32_bf16 v[124:127], v[84:87], a[208:211], v[124:127]
    v_mfma_f32_16x16x32_bf16 v[124:127], v[88:91], a[228:231], v[124:127]
    buffer_load_dwordx4 v[80:83], v20, s[44:47], s65 offen sc1
    v_mfma_f32_16x16x32_bf16 v[128:131], v[88:91], a[232:235], v[128:131]
    s_add_u32 s65, s64, 212992
    v_mfma_f32_16x16x32_bf16 v[128:131], v[84:87], a[212:215], v[128:131]
L_FB_pad6:
    s_cbranch_execz L_FB_ret
    v_mfma_f32_16x16x32_bf16 v[132:135], v[84:87], a[216:219], v[132:135]
    v_mfma_f32_16x16x32_bf16 v[132:135], v[88:91], a[236:239], v[132:135]
    s_waitcnt vmcnt(13)
    v_mfma_f32_16x16x32_bf16 v[116:119], v[92:95], a[240:243], v[116:119]
    buffer_load_dwordx4 v[84:87], v20, s[44:47], s65 offen sc1
    v_mfma_f32_16x16x32_bf16 v[120:123], v[92:95], a[244:247], v[120:123]
    s_add_u32 s65, s77, 0
    v_mfma_f32_16x16x32_bf16 v[124:127], v[92:95], a[248:251], v[124:127]
    v_mfma_f32_16x16x32_bf16 v[128:131], v[92:95], a[252:255], v[128:131]
    v_mfma_f32_16x16x32_bf16 v[132:135], v[92:95], v[28:31], v[132:135]
    s_waitcnt vmcnt(12)
    s_waitcnt lgkmcnt(4)
    v_mfma_f32_16x16x32_bf16 v[136:139], v[32:35], a[0:3], v[136:139]
    buffer_load_dwordx4 v[88:91], v1, s[44:47], s65 offen sc1
    v_mfma_f32_16x16x32_bf16 v[136:139], v[36:39], a[20:23], v[136:139]
    s_add_u32 s65, s77, 16384
    s_waitcnt lgkmcnt(3)
    v_mfma_f32_16x16x32_bf16 v[140:143], v[32:35], a[4:7], v[140:143]
    v_mfma_f32_16x16x32_bf16 v[140:143], v[36:39], a[24:27], v[140:143]
    ds_write_b128 v24, v[116:119] offset:20480
    s_waitcnt lgkmcnt(3)
    v_mfma_f32_16x16x32_bf16 v[144:147], v[32:35], a[8:11], v[144:147]
    v_mfma_f32_16x16x32_bf16 v[144:147], v[36:39], a[28:31], v[144:147]
    buffer_load_dwordx4 v[92:95], v1, s[44:47], s65 offen sc1
    s_waitcnt lgkmcnt(2)
    v_mfma_f32_16x16x32_bf16 v[148:151], v[32:35], a[12:15], v[148:151]
    s_add_u32 s65, s77, 32768
    v_mfma_f32_16x16x32_bf16 v[148:151], v[36:39], a[32:35], v[148:151]
    ds_write_b128 v24, v[120:123] offset:21504
    s_waitcnt lgkmcnt(2)
    v_mfma_f32_16x16x32_bf16 v[152:155], v[32:35], a[16:19], v[152:155]
    v_mfma_f32_16x16x32_bf16 v[152:155], v[36:39], a[36:39], v[152:155]
    s_waitcnt vmcnt(12)
    v_mfma_f32_16x16x32_bf16 v[136:139], v[40:43], a[40:43], v[136:139]
    ds_write_b128 v24, v[124:127] offset:22528
    v_mfma_f32_16x16x32_bf16 v[136:139], v[44:47], a[60:63], v[136:139]
    buffer_load_dwordx4 v[32:35], v1, s[44:47], s65 offen sc1
    v_mfma_f32_16x16x32_bf16 v[140:143], v[44:47], a[64:67], v[140:143]
    s_add_u32 s65, s77, 49152
    v_mfma_f32_16x16x32_bf16 v[140:143], v[40:43], a[44:47], v[140:143]
    v_mfma_f32_16x16x32_bf16 v[144:147], v[40:43], a[48:51], v[144:147]
    ds_write_b128 v24, v[128:131] offset:23552
    v_mfma_f32_16x16x32_bf16 v[144:147], v[44:47], a[68:71], v[144:147]
    buffer_load_dwordx4 v[36:39], v1, s[44:47], s65 offen sc1
    v_mfma_f32_16x16x32_bf16 v[148:151], v[44:47], a[72:75], v[148:151]
    s_add_u32 s65, s77, 65536
    v_mfma_f32_16x16x32_bf16 v[148:151], v[40:43], a[52:55], v[148:151]
    ds_write_b128 v24, v[132:135] offset:24576
    v_mfma_f32_16x16x32_bf16 v[152:155], v[40:43], a[56:59], v[152:155]
    v_mfma_f32_16x16x32_bf16 v[152:155], v[44:47], a[76:79], v[152:155]
    s_waitcnt vmcnt(12)
    v_mfma_f32_16x16x32_bf16 v[136:139], v[48:51], a[80:83], v[136:139]
    buffer_load_dwordx4 v[40:43], v1, s[44:47], s65 offen sc1
    v_mfma_f32_16x16x32_bf16 v[136:139], v[52:55], a[100:103], v[136:139]
    v_mfma_f32_16x16x32_bf16 v[140:143], v[52:55], a[104:107], v[140:143]
    v_mfma_f32_16x16x32_bf16 v[140:143], v[48:51], a[84:87], v[140:143]
    v_mfma_f32_16x16x32_bf16 v[144:147], v[48:51], a[88:91], v[144:147]
    s_waitcnt lgkmcnt(0)
    s_barrier
    v_mfma_f32_16x16x32_bf16 v[144:147], v[52:55], a[108:111], v[144:147]
    ds_read_b128 v[156:159], v22 offset:15360
    s_add_u32 s65, s77, 81920
    v_mfma_f32_16x16x32_bf16 v[148:151], v[52:55], a[112:115], v[148:151]
    buffer_load_dwordx4 v[44:47], v1, s[44:47], s65 offen sc1
    v_mfma_f32_16x16x32_bf16 v[148:151], v[48:51], a[92:95], v[148:151]
    ds_read_b128 v[160:163], v22 offset:16384
    s_add_u32 s65, s77, 98304
    v_mfma_f32_16x16x32_bf16 v[152:155], v[48:51], a[96:99], v[152:155]
    v_mfma_f32_16x16x32_bf16 v[152:155], v[52:55], a[116:119], v[152:155]
    s_waitcnt vmcnt(12)
    v_mfma_f32_16x16x32_bf16 v[136:139], v[56:59], a[120:123], v[136:139]
    ds_read_b128 v[164:167], v22 offset:17408
    v_mfma_f32_16x16x32_bf16 v[136:139], v[60:63], a[140:143], v[136:139]
    ds_read_b128 v[168:171], v22 offset:18432
    v_mfma_f32_16x16x32_bf16 v[140:143], v[60:63], a[144:147], v[140:143]
    buffer_load_dwordx4 v[48:51], v1, s[44:47], s65 offen sc1
    v_mfma_f32_16x16x32_bf16 v[140:143], v[56:59], a[124:127], v[140:143]
    ds_read_b128 v[172:175], v22 offset:19456
    s_add_u32 s65, s77, 114688
    v_mfma_f32_16x16x32_bf16 v[144:147], v[56:59], a[128:131], v[144:147]
    v_mfma_f32_16x16x32_bf16 v[144:147], v[60:63], a[148:151], v[144:147]
    buffer_load_dwordx4 v[52:55], v1, s[44:47], s65 offen sc1
    v_mfma_f32_16x16x32_bf16 v[148:151], v[60:63], a[152:155], v[148:151]
    s_add_u32 s65, s77, 131072
    v_mfma_f32_16x16x32_bf16 v[148:151], v[56:59], a[132:135], v[148:151]
    v_mfma_f32_16x16x32_bf16 v[152:155], v[56:59], a[136:139], v[152:155]
    v_mfma_f32_16x16x32_bf16 v[152:155], v[60:63], a[156:159], v[152:155]
    s_waitcnt vmcnt(12)
    v_mfma_f32_16x16x32_bf16 v[136:139], v[64:67], a[160:163], v[136:139]
    buffer_load_dwordx4 v[56:59], v1, s[44:47], s65 offen sc1
    v_mfma_f32_16x16x32_bf16 v[136:139], v[68:71], a[180:183], v[136:139]
    s_add_u32 s65, s77, 147456
    v_mfma_f32_16x16x32_bf16 v[140:143], v[68:71], a[184:187], v[140:143]
    v_mfma_f32_16x16x32_bf16 v[140:143], v[64:67], a[164:167], v[140:143]
    v_mfma_f32_16x16x32_bf16 v[144:147], v[64:67], a[168:171], v[144:147]
    v_mfma_f32_16x16x32_bf16 v[144:147], v[68:71], a[188:191], v[144:147]
    buffer_load_dwordx4 v[60:63], v1, s[44:47], s65 offen sc1
    v_mfma_f32_16x16x32_bf16 v[148:151], v[68:71], a[192:195], v[148:151]
    s_add_u32 s65, s77, 163840
    v_mfma_f32_16x16x32_bf16 v[148:151], v[64:67], a[172:175], v[148:151]
    v_mfma_f32_16x16x32_bf16 v[152:155], v[64:67], a[176:179], v[152:155]
    v_mfma_f32_16x16x32_bf16 v[152:155], v[68:71], a[196:199], v[152:155]
    s_waitcnt vmcnt(12)
    v_mfma_f32_16x16x32_bf16 v[136:139], v[72:75], a[200:203], v[136:139]
    buffer_load_dwordx4 v[64:67], v1, s[44:47], s65 offen sc1
    v_mfma_f32_16x16x32_bf16 v[136:139], v[76:79], a[220:223], v[136:139]
    s_add_u32 s65, s77, 180224
    v_mfma_f32_16x16x32_bf16 v[140:143], v[76:79], a[224:227], v[140:143]
    v_mfma_f32_16x16x32_bf16 v[140:143], v[72:75], a[204:207], v[140:143]
    v_mfma_f32_16x16x32_bf16 v[144:147], v[72:75], a[208:211], v[144:147]
    v_mfma_f32_16x16x32_bf16 v[144:147], v[76:79], a[228:231], v[144:147]
    buffer_load_dwordx4 v[68:71], v1, s[44:47], s65 offen sc1
    v_mfma_f32_16x16x32_bf16 v[148:151], v[76:79], a[232:235], v[148:151]
    s_add_u32 s65, s77, 196608
    v_mfma_f32_16x16x32_bf16 v[148:151], v[72:75], a[212:215], v[148:151]
    v_mfma_f32_16x16x32_bf16 v[152:155], v[72:75], a[216:219], v[152:155]
    v_mfma_f32_16x16x32_bf16 v[152:155], v[76:79], a[236:239], v[152:155]
    s_waitcnt vmcnt(12)
    v_mfma_f32_16x16x32_bf16 v[136:139], v[80:83], a[240:243], v[136:139]
    buffer_load_dwordx4 v[72:75], v1, s[44:47], s65 offen sc1
    v_mfma_f32_16x16x32_bf16 v[136:139], v[84:87], v[236:239], v[136:139]
    s_add_u32 s65, s64, 212992
    v_mfma_f32_16x16x32_bf16 v[140:143], v[84:87], v[240:243], v[140:143]
    v_mfma_f32_16x16x32_bf16 v[140:143], v[80:83], a[244:247], v[140:143]
    v_mfma_f32_16x16x32_bf16 v[144:147], v[80:83], a[248:251], v[144:147]
    v_mfma_f32_16x16x32_bf16 v[144:147], v[84:87], v[244:247], v[144:147]
    buffer_load_dwordx4 v[76:79], v1, s[44:47], s65 offen sc1
    v_mfma_f32_16x16x32_bf16 v[148:151], v[84:87], v[248:251], v[148:151]
    v_mfma_f32_16x16x32_bf16 v[148:151], v[80:83], a[252:255], v[148:151]
    v_mfma_f32_16x16x32_bf16 v[152:155], v[80:83], v[28:31], v[152:155]
    v_mfma_f32_16x16x32_bf16 v[152:155], v[84:87], v[252:255], v[152:155]
    s_waitcnt vmcnt(12)
    s_waitcnt lgkmcnt(4)
    v_mfma_f32_16x16x32_bf16 v[156:159], v[88:91], a[0:3], v[156:159]
    v_mfma_f32_16x16x32_bf16 v[156:159], v[92:95], a[20:23], v[156:159]
    s_waitcnt lgkmcnt(3)
    v_mfma_f32_16x16x32_bf16 v[160:163], v[88:91], a[4:7], v[160:163]
    v_mfma_f32_16x16x32_bf16 v[160:163], v[92:95], a[24:27], v[160:163]
    ds_write_b128 v24, v[136:139] offset:25600
    s_waitcnt lgkmcnt(3)
    v_mfma_f32_16x16x32_bf16 v[164:167], v[88:91], a[8:11], v[164:167]
    v_mfma_f32_16x16x32_bf16 v[164:167], v[92:95], a[28:31], v[164:167]
    s_waitcnt lgkmcnt(2)
    v_mfma_f32_16x16x32_bf16 v[168:171], v[88:91], a[12:15], v[168:171]
    v_mfma_f32_16x16x32_bf16 v[168:171], v[92:95], a[32:35], v[168:171]
    ds_write_b128 v24, v[140:143] offset:26624
L_FB_pad7:
    s_cbranch_execz L_FB_ret
    s_waitcnt lgkmcnt(2)
    v_mfma_f32_16x16x32_bf16 v[172:175], v[88:91], a[16:19], v[172:175]
    v_mfma_f32_16x16x32_bf16 v[172:175], v[92:95], a[36:39], v[172:175]
    s_waitcnt vmcnt(10)
    v_mfma_f32_16x16x32_bf16 v[156:159], v[32:35], a[40:43], v[156:159]
    ds_write_b128 v24, v[144:147] offset:27648
    v_mfma_f32_16x16x32_bf16 v[156:159], v[36:39], a[60:63], v[156:159]
    v_mfma_f32_16x16x32_bf16 v[160:163], v[36:39], a[64:67], v[160:163]
    v_mfma_f32_16x16x32_bf16 v[160:163], v[32:35], a[44:47], v[160:163]
    v_mfma_f32_16x16x32_bf16 v[164:167], v[32:35], a[48:51], v[164:167]
    ds_write_b128 v24, v[148:151] offset:28672
    v_mfma_f32_16x16x32_bf16 v[164:167], v[36:39], a[68:71], v[164:167]
    v_mfma_f32_16x16x32_bf16 v[168:171], v[36:39], a[72:75], v[168:171]
    v_mfma_f32_16x16x32_bf16 v[168:171], v[32:35], a[52:55], v[168:171]
    ds_write_b128 v24, v[152:155] offset:29696
    v_mfma_f32_16x16x32_bf16 v[172:175], v[32:35], a[56:59], v[172:175]
    v_mfma_f32_16x16x32_bf16 v[172:175], v[36:39], a[76:79], v[172:175]
    s_waitcnt vmcnt(8)
    v_mfma_f32_16x16x32_bf16 v[156:159], v[40:43], a[80:83], v[156:159]
    v_mfma_f32_16x16x32_bf16 v[156:159], v[44:47], a[100:103], v[156:159]
    v_mfma_f32_16x16x32_bf16 v[160:163], v[44:47], a[104:107], v[160:163]
    v_mfma_f32_16x16x32_bf16 v[160:163], v[40:43], a[84:87], v[160:163]
    v_mfma_f32_16x16x32_bf16 v[164:167], v[40:43], a[88:91], v[164:167]
    s_waitcnt lgkmcnt(0)
    s_barrier
    v_mfma_f32_16x16x32_bf16 v[164:167], v[44:47], a[108:111], v[164:167]
    ds_read_b128 v[116:119], v23 offset:15360
    v_mfma_f32_16x16x32_bf16 v[168:171], v[44:47], a[112:115], v[168:171]
    v_mfma_f32_16x16x32_bf16 v[168:171], v[40:43], a[92:95], v[168:171]
    ds_read_b128 v[120:123], v23 offset:16384
    v_mfma_f32_16x16x32_bf16 v[172:175], v[40:43], a[96:99], v[172:175]
    v_mfma_f32_16x16x32_bf16 v[172:175], v[44:47], a[116:119], v[172:175]
    s_waitcnt vmcnt(6)
    v_mfma_f32_16x16x32_bf16 v[156:159], v[48:51], a[120:123], v[156:159]
    ds_read_b128 v[124:127], v23 offset:17408
    v_mfma_f32_16x16x32_bf16 v[156:159], v[52:55], a[140:143], v[156:159]
    ds_read_b128 v[128:131], v23 offset:18432
    v_mfma_f32_16x16x32_bf16 v[160:163], v[52:55], a[144:147], v[160:163]
    buffer_load_dwordx4 v[176:179], v15, s[44:47], s63 offen offset:0 sc1
    v_mfma_f32_16x16x32_bf16 v[160:163], v[48:51], a[124:127], v[160:163]
    ds_read_b128 v[132:135], v23 offset:19456
    v_mfma_f32_16x16x32_bf16 v[164:167], v[48:51], a[128:131], v[164:167]
    buffer_load_dwordx4 v[180:183], v15, s[44:47], s63 offen offset:1024 sc1
    v_mfma_f32_16x16x32_bf16 v[164:167], v[52:55], a[148:151], v[164:167]
    buffer_load_dwordx4 v[184:187], v15, s[44:47], s63 offen offset:2048 sc1
    v_mfma_f32_16x16x32_bf16 v[168:171], v[52:55], a[152:155], v[168:171]
    v_mfma_f32_16x16x32_bf16 v[168:171], v[48:51], a[132:135], v[168:171]
    v_mfma_f32_16x16x32_bf16 v[172:175], v[48:51], a[136:139], v[172:175]
    v_mfma_f32_16x16x32_bf16 v[172:175], v[52:55], a[156:159], v[172:175]
    s_waitcnt vmcnt(7)
    v_mfma_f32_16x16x32_bf16 v[156:159], v[56:59], a[160:163], v[156:159]
    v_mfma_f32_16x16x32_bf16 v[156:159], v[60:63], a[180:183], v[156:159]
    v_mfma_f32_16x16x32_bf16 v[160:163], v[60:63], a[184:187], v[160:163]
    v_mfma_f32_16x16x32_bf16 v[160:163], v[56:59], a[164:167], v[160:163]
    v_mfma_f32_16x16x32_bf16 v[164:167], v[56:59], a[168:171], v[164:167]
    v_mfma_f32_16x16x32_bf16 v[164:167], v[60:63], a[188:191], v[164:167]
    v_mfma_f32_16x16x32_bf16 v[168:171], v[60:63], a[192:195], v[168:171]
    v_mfma_f32_16x16x32_bf16 v[168:171], v[56:59], a[172:175], v[168:171]
    v_mfma_f32_16x16x32_bf16 v[172:175], v[56:59], a[176:179], v[172:175]
    v_mfma_f32_16x16x32_bf16 v[172:175], v[60:63], a[196:199], v[172:175]
    s_waitcnt vmcnt(5)
    v_mfma_f32_16x16x32_bf16 v[156:159], v[64:67], a[200:203], v[156:159]
    v_mfma_f32_16x16x32_bf16 v[156:159], v[68:71], a[220:223], v[156:159]
    v_mfma_f32_16x16x32_bf16 v[160:163], v[68:71], a[224:227], v[160:163]
    v_mfma_f32_16x16x32_bf16 v[160:163], v[64:67], a[204:207], v[160:163]
    v_mfma_f32_16x16x32_bf16 v[164:167], v[64:67], a[208:211], v[164:167]
    v_mfma_f32_16x16x32_bf16 v[164:167], v[68:71], a[228:231], v[164:167]
    v_mfma_f32_16x16x32_bf16 v[168:171], v[68:71], a[232:235], v[168:171]
    v_mfma_f32_16x16x32_bf16 v[168:171], v[64:67], a[212:215], v[168:171]
    v_mfma_f32_16x16x32_bf16 v[172:175], v[64:67], a[216:219], v[172:175]
    v_mfma_f32_16x16x32_bf16 v[172:175], v[68:71], a[236:239], v[172:175]
    s_waitcnt vmcnt(3)
    v_mfma_f32_16x16x32_bf16 v[156:159], v[72:75], a[240:243], v[156:159]
    v_mfma_f32_16x16x32_bf16 v[156:159], v[76:79], v[236:239], v[156:159]
    v_mfma_f32_16x16x32_bf16 v[160:163], v[76:79], v[240:243], v[160:163]
    v_mfma_f32_16x16x32_bf16 v[160:163], v[72:75], a[244:247], v[160:163]
    v_mfma_f32_16x16x32_bf16 v[164:167], v[72:75], a[248:251], v[164:167]
    v_mfma_f32_16x16x32_bf16 v[164:167], v[76:79], v[244:247], v[164:167]
    v_mfma_f32_16x16x32_bf16 v[168:171], v[76:79], v[248:251], v[168:171]
    v_mfma_f32_16x16x32_bf16 v[168:171], v[72:75], a[252:255], v[168:171]
    v_mfma_f32_16x16x32_bf16 v[172:175], v[72:75], v[28:31], v[172:175]
    v_mfma_f32_16x16x32_bf16 v[172:175], v[76:79], v[252:255], v[172:175]
    v_mov_b32 v8, 0xbfb8aa3b
    s_waitcnt lgkmcnt(4)
    v_pk_add_f32 v[156:157], v[156:157], v[116:117]
    s_waitcnt lgkmcnt(3)
    v_pk_add_f32 v[160:161], v[160:161], v[120:121]
    s_waitcnt lgkmcnt(2)
    v_pk_add_f32 v[164:165], v[164:165], v[124:125]
    s_waitcnt lgkmcnt(1)
    v_pk_add_f32 v[168:169], v[168:169], v[128:129]
    s_waitcnt lgkmcnt(0)
    v_pk_add_f32 v[172:173], v[172:173], v[132:133]
    v_pk_mul_f32 v[32:33], v[156:157], v[8:9] op_sel_hi:[1,0]
    v_pk_mul_f32 v[36:37], v[160:161], v[8:9] op_sel_hi:[1,0]
    v_pk_mul_f32 v[40:41], v[164:165], v[8:9] op_sel_hi:[1,0]
    v_pk_mul_f32 v[44:45], v[168:169], v[8:9] op_sel_hi:[1,0]
    v_pk_mul_f32 v[48:49], v[172:173], v[8:9] op_sel_hi:[1,0]
    v_exp_f32 v32, v32
    v_exp_f32 v33, v33
    v_exp_f32 v36, v36
    v_exp_f32 v37, v37
    v_exp_f32 v40, v40
    v_exp_f32 v41, v41
    v_exp_f32 v44, v44
    v_exp_f32 v45, v45
    v_exp_f32 v48, v48
    v_exp_f32_e64 v49, v49
    v_pk_add_f32 v[32:33], v[32:33], 1.0 op_sel_hi:[1,0]
    v_pk_add_f32 v[36:37], v[36:37], 1.0 op_sel_hi:[1,0]
    v_pk_add_f32 v[40:41], v[40:41], 1.0 op_sel_hi:[1,0]
    v_pk_add_f32 v[44:45], v[44:45], 1.0 op_sel_hi:[1,0]
    v_pk_add_f32 v[48:49], v[48:49], 1.0 op_sel_hi:[1,0]
    v_rcp_f32 v32, v32
    v_rcp_f32 v33, v33
    v_rcp_f32 v36, v36
    v_rcp_f32 v37, v37
L_FB_pad8:
    s_cbranch_execz L_FB_ret
    v_rcp_f32 v40, v40
    v_rcp_f32 v41, v41
    v_rcp_f32 v44, v44
    v_rcp_f32 v45, v45
    v_rcp_f32 v48, v48
    v_rcp_f32 v49, v49
    s_waitcnt vmcnt(2)
    v_xor_b32 v13, v179, v14
    s_waitcnt vmcnt(1)
    v_bitop3_b32 v13, v183, v14, v13 bitop3:0xbe
    s_waitcnt vmcnt(0)
    v_bitop3_b32 v13, v187, v14, v13 bitop3:0xbe
    v_cmp_lt_u32 vcc, s68, v13
    s_cbranch_vccz L_F_xch_ok
    s_mov_b32 s25, 0
L_F_xch_retry:

    buffer_load_dwordx4 v[176:179], v15, s[44:47], s63 offen offset:0 sc1
    buffer_load_dwordx4 v[180:183], v15, s[44:47], s63 offen offset:1024 sc1
    buffer_load_dwordx4 v[184:187], v15, s[44:47], s63 offen offset:2048 sc1
    s_add_u32 s25, s25, 1
    s_waitcnt vmcnt(0)
    v_xor_b32 v13, v179, v14
    v_bitop3_b32 v13, v183, v14, v13 bitop3:0xbe
    v_bitop3_b32 v13, v187, v14, v13 bitop3:0xbe
    v_cmp_lt_u32 vcc, s68, v13
    s_cmp_ge_u32 s25, 100000
    s_cbranch_scc1 L_F_xch_ok
    s_cbranch_vccnz L_F_xch_retry
L_F_xch_ok:
    v_lshlrev_b32 v96, 16, v176
    v_and_b32 v97, 0xffff0000, v176
    v_lshlrev_b32 v100, 16, v178
    v_and_b32 v101, 0xffff0000, v178
    v_and_b32 v104, 0xffff0000, v180
    v_lshlrev_b32 v105, 16, v181
    v_and_b32 v108, 0xffff0000, v182
    v_lshlrev_b32 v109, 16, v183
    v_lshlrev_b32_e64 v112, 16, v185
    v_and_b32 v113, 0xffff0000, v185
    v_pk_add_f32 v[216:217], v[216:217], v[96:97]
    v_pk_add_f32 v[220:221], v[220:221], v[100:101]
    v_pk_add_f32 v[224:225], v[224:225], v[104:105]
    v_pk_add_f32 v[228:229], v[228:229], v[108:109]
    v_pk_add_f32 v[232:233], v[232:233], v[112:113]
    v_pk_mul_f32 v[156:157], v[156:157], v[216:217]
    v_pk_mul_f32 v[160:161], v[160:161], v[220:221]
    v_pk_mul_f32 v[164:165], v[164:165], v[224:225]
    v_pk_mul_f32 v[168:169], v[168:169], v[228:229]
    v_pk_mul_f32 v[172:173], v[172:173], v[232:233]
    v_fma_f32 v136, v156, v32, v196
    v_fma_f32 v137, v160, v36, v200
    v_fma_f32 v138, v164, v40, v204
    v_fma_f32 v139, v168, v44, v208
    v_fma_f32 v152, v172, v48, v212
    buffer_store_dwordx4 v[136:139], v4, s[56:59], s69 offen offset:0 sc1
    buffer_store_dword v152, v5, s[56:59], s69 offen offset:256 sc1
    v_fma_f32 v140, v157, v33, v197
    v_fma_f32 v141, v161, v37, v201
    v_fma_f32 v142, v165, v41, v205
    v_fma_f32 v143, v169, v45, v209
    v_fma_f32 v153, v173, v49, v213
    buffer_store_dwordx4 v[140:143], v4, s[56:59], s69 offen offset:2560 sc1
    buffer_store_dword v153, v5, s[56:59], s69 offen offset:2816 sc1
    v_pk_add_f32 v[158:159], v[158:159], v[118:119]
    v_pk_add_f32 v[162:163], v[162:163], v[122:123]
    v_pk_add_f32 v[166:167], v[166:167], v[126:127]
    v_pk_add_f32 v[170:171], v[170:171], v[130:131]
    v_pk_add_f32 v[174:175], v[174:175], v[134:135]
    v_pk_mul_f32 v[34:35], v[158:159], v[8:9] op_sel_hi:[1,0]
    v_pk_mul_f32 v[38:39], v[162:163], v[8:9] op_sel_hi:[1,0]
    v_pk_mul_f32 v[42:43], v[166:167], v[8:9] op_sel_hi:[1,0]
    v_pk_mul_f32 v[46:47], v[170:171], v[8:9] op_sel_hi:[1,0]
    v_pk_mul_f32 v[50:51], v[174:175], v[8:9] op_sel_hi:[1,0]
    v_exp_f32 v34, v34
    v_exp_f32 v35, v35
    v_exp_f32 v38, v38
    v_exp_f32 v39, v39
    v_exp_f32 v42, v42
    v_exp_f32 v43, v43
    v_exp_f32 v46, v46
    v_exp_f32 v47, v47
    v_exp_f32 v50, v50
    v_exp_f32 v51, v51
    v_pk_add_f32 v[34:35], v[34:35], 1.0 op_sel_hi:[1,0]
    v_pk_add_f32 v[38:39], v[38:39], 1.0 op_sel_hi:[1,0]
    v_pk_add_f32 v[42:43], v[42:43], 1.0 op_sel_hi:[1,0]
    v_pk_add_f32 v[46:47], v[46:47], 1.0 op_sel_hi:[1,0]
    v_pk_add_f32 v[50:51], v[50:51], 1.0 op_sel_hi:[1,0]
    v_rcp_f32 v34, v34
    v_rcp_f32 v35, v35
    v_rcp_f32 v38, v38
    v_rcp_f32 v39, v39
    v_rcp_f32 v42, v42
    v_rcp_f32 v43, v43
    v_rcp_f32 v46, v46
    v_rcp_f32 v47, v47
    v_rcp_f32 v50, v50
    v_rcp_f32 v51, v51
    v_lshlrev_b32 v98, 16, v177
    v_and_b32 v99, 0xffff0000, v177
    v_lshlrev_b32 v102, 16, v179
    v_lshlrev_b32 v103, 16, v180
    v_and_b32 v106, 0xffff0000, v181
    v_lshlrev_b32 v107, 16, v182
    v_lshlrev_b32 v110, 16, v184
    v_and_b32 v111, 0xffff0000, v184
    v_lshlrev_b32 v114, 16, v186
    v_and_b32 v115, 0xffff0000, v186
    v_pk_add_f32 v[218:219], v[218:219], v[98:99]
    v_pk_add_f32 v[222:223], v[222:223], v[102:103]
    v_pk_add_f32 v[226:227], v[226:227], v[106:107]
    v_pk_add_f32 v[230:231], v[230:231], v[110:111]
    v_pk_add_f32 v[234:235], v[234:235], v[114:115]
    v_pk_mul_f32 v[158:159], v[158:159], v[218:219]
    v_pk_mul_f32 v[162:163], v[162:163], v[222:223]
    v_pk_mul_f32 v[166:167], v[166:167], v[226:227]
    v_pk_mul_f32 v[170:171], v[170:171], v[230:231]
    v_pk_mul_f32 v[174:175], v[174:175], v[234:235]
    v_fma_f32 v144, v158, v34, v198
    v_fma_f32 v145, v162, v38, v202
    v_fma_f32 v146, v166, v42, v206
    v_fma_f32 v147, v170, v46, v210
    v_fma_f32 v154, v174, v50, v214
    buffer_store_dwordx4 v[144:147], v6, s[56:59], s69 offen offset:0 sc1
    buffer_store_dword v154, v7, s[56:59], s69 offen offset:256 sc1
    v_fma_f32 v148, v159, v35, v199
    v_fma_f32 v149, v163, v39, v203
    v_fma_f32 v150, v167, v43, v207
    v_fma_f32 v151, v171, v47, v211
    v_fma_f32 v155, v175, v51, v215
    buffer_store_dwordx4 v[148:151], v6, s[56:59], s69 offen offset:2560 sc1
    buffer_store_dword v155, v7, s[56:59], s69 offen offset:2816 sc1
    s_cmp_eq_u32 s2, 0
    s_cselect_b32 s67, 0, 1879048192
    v_min_u32 v26, 1, v0
    v_lshlrev_b32 v26, 25, v26
    buffer_store_dword v16, v26, s[44:47], s67 offen sc1
    s_endpgm
    .p2align 12
L_S_start:
    s_load_dwordx2 s[20:21], s[0:1], 64
    s_load_dwordx2 s[32:33], s[0:1], 112
    s_load_dwordx2 s[34:35], s[0:1], 128
    s_add_u32 m0, m0, s70
    s_add_u32 s5, s5, s69
    buffer_load_dwordx4 v12, s[48:51], s5 offen lds
    v_and_b32 v2, 15, v0
    s_cmp_eq_u32 s60, 0
    s_cselect_b32 s52, s6, s8
    s_cselect_b32 s53, s7, s9
    s_cmp_ge_u32 s60, 2
    s_cselect_b32 s52, s18, s52
    s_cselect_b32 s53, s19, s53
    s_movk_i32 s54, 1280
    s_mov_b32 s55, 0x20000
    s_lshl_b32 s70, s60, 8
    s_add_u32 m0, s70, 156672
    s_lshl_b32 s70, s72, 1
    v_lshlrev_b32 v14, 2, v1
    buffer_load_dword v14, s[52:55], s70 offen lds
    s_waitcnt lgkmcnt(0)
    s_mov_b32 s44, s34
    s_mov_b32 s45, s35
    s_mov_b32 s46, 23068672
    s_mov_b32 s47, 0x20000
    s_and_b32 s79, s2, 1
    s_bfe_u32 s76, s2, 0x20005
    s_lshl2_add_u32 s79, s79, s76
    s_mul_i32 s69, s79, 160
    s_cmp_eq_u32 s74, 0
    s_cselect_b32 s52, s30, s20
    s_cselect_b32 s53, s31, s21
    s_lshl_b32 s70, s74, 8
    s_add_u32 s70, s70, 163328
    s_mov_b32 m0, s70
    v_lshlrev_b32 v14, 2, v1
    buffer_load_dword v14, s[52:55], s69 offen lds
    s_mov_b32 s56, s32
    s_mov_b32 s57, s33
    s_mov_b32 s58, 5242880
    s_mov_b32 s59, 0x20000
    v_lshlrev_b32 v14, 21, v1
    buffer_load_dword a255, v14, s[56:59], 0 offen
    s_lshr_b32 s67, s2, 3
    s_lshl2_add_u32 s67, s67, s60
    s_lshl_b32 s67, s67, 10
    s_add_u32 s67, s67, 29696
    v_lshl_add_u32 v12, v1, 7, s67
    v_lshrrev_b32 v13, 3, v1
    v_cmp_eq_u32 vcc, 2, v13
    s_nop 1
    v_cndmask_b32 v14, v14, v12, vcc
    s_and_b32 s67, s3, 7
    s_lshl1_add_u32 s67, s67, s73
    s_mul_i32 s67, s67, 28
    s_lshl1_add_u32 s68, s22, s74
    s_add_u32 s67, s67, s68
    s_lshl_b32 s67, s67, 9
    s_add_u32 s67, s67, 379904
    v_bfe_u32 v12, v1, 2, 1
    v_mul_u32_u24 v12, 6656, v12
    v_add_u32 v12, s67, v12
    v_cmp_eq_u32 vcc, 3, v13
    v_lshl_add_u32 v12, v1, 7, v12
    s_nop 0
    v_cndmask_b32 v14, v14, v12, vcc
    buffer_load_dword a255, v14, s[44:47], 0 offen offset:1024 sc1
    s_mov_b64 exec, 0
    s_cmp_eq_u32 s60, 0
    s_cbranch_scc1 L_SA_pad0
    s_cmp_eq_u32 s60, 1
    s_cbranch_scc1 L_SA_pad1
    s_cmp_eq_u32 s60, 2
    s_cbranch_scc1 L_SA_pad2
    s_branch L_SA_pad3
L_SA_ret:
    s_mov_b64 exec, -1
    s_load_dword s66, s[34:35], 0
    s_add_u32 m0, s64, 16384
    s_lshl_b32 s62, s61, 7
    buffer_load_dwordx4 v18, s[36:39], s62 offen offset:0 lds
    v_lshlrev_b32 v15, 4, v1
    s_lshl_b32 s67, s73, 13
    v_lshrrev_b32 v12, 1, v2
    v_xor_b32 v12, v3, v12
    v_lshlrev_b32 v13, 7, v2
    v_lshl_add_u32 v13, v12, 4, v13
    v_add_u32 v28, s67, v13
    v_xor_b32_e64 v29, 64, v28
    v_mov_b32 v12, 0x3f803f80
    v_accvgpr_write_b32 a240, v12
    v_accvgpr_write_b32 a241, v12
    v_accvgpr_write_b32 a242, v12
    v_accvgpr_write_b32 a243, v12
    s_mul_i32 s67, s74, 12288
    buffer_load_dwordx4 v19, s[36:39], s62 offen offset:1024 lds
    s_add_u32 s67, s67, 49152
    v_add_u32 v30, s67, v13
    v_xor_b32 v31, 64, v30
    s_waitcnt vmcnt(23)
    v_lshlrev_b32 v172, 16, v160
    v_and_b32 v173, 0xffff0000, v160
    v_lshlrev_b32 v174, 16, v161
    v_and_b32 v175, 0xffff0000, v161
    v_lshlrev_b32 v176, 16, v162
    v_and_b32 v177, 0xffff0000, v162
    v_lshlrev_b32 v178, 16, v163
    v_and_b32 v179, 0xffff0000, v163
    s_waitcnt vmcnt(22)
    v_lshlrev_b32 v180, 16, v164
    v_and_b32 v181, 0xffff0000, v164
    v_lshlrev_b32 v182, 16, v165
    buffer_load_dwordx4 v20, s[36:39], s62 offen offset:2048 lds
    v_and_b32 v183, 0xffff0000, v165
    v_lshlrev_b32 v184, 16, v166
    v_and_b32 v185, 0xffff0000, v166
    v_lshlrev_b32 v186, 16, v167
    v_and_b32 v187, 0xffff0000, v167
    s_waitcnt vmcnt(22)
    v_lshlrev_b32 v188, 16, v168
    v_and_b32 v189, 0xffff0000, v168
    v_lshlrev_b32_e64 v190, 16, v169
    v_and_b32 v191, 0xffff0000, v169
    v_pk_add_f32 v[160:161], v[172:173], v[174:175]
    v_pk_add_f32 v[160:161], v[160:161], v[176:177]
    v_pk_add_f32 v[160:161], v[160:161], v[178:179]
    v_pk_add_f32 v[160:161], v[160:161], v[180:181]
    v_pk_add_f32 v[160:161], v[160:161], v[182:183]
    v_pk_add_f32 v[160:161], v[160:161], v[184:185]
    buffer_load_dwordx4 v21, s[36:39], s62 offen offset:3072 lds
    v_pk_add_f32 v[160:161], v[160:161], v[186:187]
    v_pk_add_f32 v[160:161], v[160:161], v[188:189]
    v_pk_add_f32 v[160:161], v[160:161], v[190:191]
    v_add_f32 v162, v160, v161
    s_nop 1
    v_add_f32_dpp v162, v162, v162 row_ror:8 row_mask:0xf bank_mask:0xf
    s_nop 1
    v_add_f32_dpp v162, v162, v162 row_ror:4 row_mask:0xf bank_mask:0xf
    s_nop 1
    v_add_f32_dpp v162, v162, v162 row_ror:2 row_mask:0xf bank_mask:0xf
    s_nop 1
    v_add_f32_dpp v162, v162, v162 row_ror:1 row_mask:0xf bank_mask:0xf
    v_mov_b32 v163, v162
    s_nop 1
    v_permlane16_swap_b32 v162, v163
    v_add_f32_e64 v162, v162, v163
    v_mul_f32 v162, 0x3acccccd, v162
    v_pk_add_f32 v[172:173], v[172:173], v[162:163] op_sel_hi:[1,0] neg_lo:[0,1] neg_hi:[0,1]
    v_pk_add_f32 v[174:175], v[174:175], v[162:163] op_sel_hi:[1,0] neg_lo:[0,1] neg_hi:[0,1]
    s_add_u32 m0, s65, 24576
    s_mul_i32 s63, s61, s71
    s_nop 0
    buffer_load_dwordx4 v22, s[40:43], s63 offen offset:0 lds
    v_pk_add_f32 v[176:177], v[176:177], v[162:163] op_sel_hi:[1,0] neg_lo:[0,1] neg_hi:[0,1]
    v_pk_add_f32 v[178:179], v[178:179], v[162:163] op_sel_hi:[1,0] neg_lo:[0,1] neg_hi:[0,1]
    v_pk_add_f32 v[180:181], v[180:181], v[162:163] op_sel_hi:[1,0] neg_lo:[0,1] neg_hi:[0,1]
    v_pk_add_f32 v[182:183], v[182:183], v[162:163] op_sel_hi:[1,0] neg_lo:[0,1] neg_hi:[0,1]
    v_pk_add_f32 v[184:185], v[184:185], v[162:163] op_sel_hi:[1,0] neg_lo:[0,1] neg_hi:[0,1]
    v_pk_add_f32 v[186:187], v[186:187], v[162:163] op_sel_hi:[1,0] neg_lo:[0,1] neg_hi:[0,1]
    v_pk_add_f32 v[188:189], v[188:189], v[162:163] op_sel_hi:[1,0] neg_lo:[0,1] neg_hi:[0,1]
    v_pk_add_f32 v[190:191], v[190:191], v[162:163] op_sel_hi:[1,0] neg_lo:[0,1] neg_hi:[0,1]
    v_pk_mul_f32 v[160:161], v[172:173], v[172:173]
    v_pk_fma_f32 v[160:161], v[174:175], v[174:175], v[160:161]
    v_pk_fma_f32 v[160:161], v[176:177], v[176:177], v[160:161]
    v_pk_fma_f32 v[160:161], v[178:179], v[178:179], v[160:161]
    v_pk_fma_f32 v[160:161], v[180:181], v[180:181], v[160:161]
    v_pk_fma_f32 v[160:161], v[182:183], v[182:183], v[160:161]
    v_pk_fma_f32 v[160:161], v[184:185], v[184:185], v[160:161]
    buffer_load_dwordx4 v23, s[40:43], s63 offen offset:1024 lds
    v_pk_fma_f32 v[160:161], v[186:187], v[186:187], v[160:161]
    v_pk_fma_f32 v[160:161], v[188:189], v[188:189], v[160:161]
    v_pk_fma_f32 v[160:161], v[190:191], v[190:191], v[160:161]
    v_add_f32 v164, v160, v161
    s_nop 1
    v_add_f32_dpp v164, v164, v164 row_ror:8 row_mask:0xf bank_mask:0xf
    s_nop 1
    v_add_f32_dpp v164, v164, v164 row_ror:4 row_mask:0xf bank_mask:0xf
    s_nop 1
    v_add_f32_dpp v164, v164, v164 row_ror:2 row_mask:0xf bank_mask:0xf
    s_nop 1
    v_add_f32_dpp v164, v164, v164 row_ror:1 row_mask:0xf bank_mask:0xf
    v_mov_b32 v165, v164
    s_nop 1
    v_permlane16_swap_b32 v164, v165
    v_add_f32 v164, v164, v165
    v_mul_f32 v164, 0x3acccccd, v164
    v_cvt_pk_bf16_f32 v164, v164, v164
    v_lshlrev_b32 v164, 16, v164
    buffer_load_dwordx4 v24, s[40:43], s63 offen offset:2048 lds
    v_cvt_pk_bf16_f32 v162, v162, v162
    v_lshlrev_b32 v162, 16, v162
    v_add_f32 v164, 0x3727c5ac, v164
    v_cvt_pk_bf16_f32 v164, v164, v164
    v_lshlrev_b32 v164, 16, v164
    v_sqrt_f32 v164, v164
    v_lshrrev_b32 v172, 5, v0
    v_cvt_pk_bf16_f32 v164, v164, v164
    v_lshlrev_b32 v164, 16, v164
    v_rcp_f32 v164, v164
    v_lshlrev_b32 v172, 3, v172
    v_mul_f32 v165, v162, v164
    v_add_u32 v172, 162816, v172
    ds_write_b64 v172, v[164:165]
    s_waitcnt vmcnt(16) lgkmcnt(0)
    s_barrier
    ds_read_b128 v[96:99], v30 offset:0
    ds_read_b128 v[80:83], v28 offset:0
    ds_read_b128 v[84:87], v28 offset:2048
    ds_read_b128 v[88:91], v28 offset:4096
    ds_read_b128 v[92:95], v28 offset:6144
    ds_read_b128 v[100:103], v30 offset:6144
    ds_read_b128 v[104:107], v30 offset:2048
    ds_read_b128 v[108:111], v30 offset:8192
    ds_read_b128 v[112:115], v30 offset:4096
    ds_read_b128 v[116:119], v30 offset:10240
    s_waitcnt lgkmcnt(8)
    v_mfma_f32_16x16x32_bf16 v[160:163], v[80:83], v[96:99], 0
    ds_read_b128 v[136:139], v31 offset:0
    s_mul_i32 s66, s66, 1664525
    s_waitcnt lgkmcnt(8)
    v_mfma_f32_16x16x32_bf16 v[184:187], v[84:87], v[96:99], 0
    s_add_u32 m0, s65, 27648
    s_add_u32 s61, s61, 1
    s_add_u32 s66, s66, 1013904223
    s_waitcnt lgkmcnt(7)
    v_mfma_f32_16x16x32_bf16 v[208:211], v[88:91], v[96:99], 0
    buffer_load_dwordx4 v25, s[40:43], s63 offen offset:0 lds
    s_waitcnt lgkmcnt(6)
    v_mfma_f32_16x16x32_bf16 v[232:235], v[92:95], v[96:99], 0
    ds_read_b128 v[120:123], v29 offset:0
    s_mul_i32 s75, s3, 5
    v_mfma_f32_16x16x32_bf16 a[0:3], a[240:243], v[96:99], 0
    ds_read_b128 v[124:127], v29 offset:2048
    s_lshr_b32 s75, s75, 3
    s_waitcnt lgkmcnt(7)
    v_mfma_f32_16x16x32_bf16 v[236:239], v[92:95], v[100:103], 0
    s_lshl4_add_u32 s75, s22, s75
    s_lshl1_add_u32 s75, s75, s74
    s_mul_i32 s75, s75, 384
    v_mfma_f32_16x16x32_bf16 a[4:7], a[240:243], v[100:103], 0
    s_add_u32 s75, s75, 163840
    s_bitcmp1_b32 0xb5b5, s3
    s_cselect_b32 s75, s75, 1879048192
    v_mfma_f32_16x16x32_bf16 v[212:215], v[88:91], v[100:103], 0
    buffer_load_dwordx4 v26, s[40:43], s63 offen offset:1024 lds
    v_mfma_f32_16x16x32_bf16 v[188:191], v[84:87], v[100:103], 0
    ds_read_b128 v[128:131], v29 offset:4096
    v_mov_b32 v12, 0x3f803f80
    v_mfma_f32_16x16x32_bf16 v[164:167], v[80:83], v[100:103], 0
    ds_read_b128 v[132:135], v29 offset:6144
    v_accvgpr_write_b32 a244, v12
    s_waitcnt lgkmcnt(8)
    v_mfma_f32_16x16x32_bf16 v[168:171], v[80:83], v[104:107], 0
    s_cmp_eq_u32 s61, 10
    s_cselect_b32 s61, 0, s61
    v_accvgpr_write_b32 a245, 0
    v_mfma_f32_16x16x32_bf16 v[192:195], v[84:87], v[104:107], 0
    s_cmp_ge_u32 s60, 2
    s_cselect_b32 s75, 1879048192, s75
    v_lshlrev_b32 v48, 26, v3
    v_mfma_f32_16x16x32_bf16 v[216:219], v[88:91], v[104:107], 0
    buffer_load_dwordx4 v27, s[40:43], s63 offen offset:2048 lds
    v_mfma_f32_16x16x32_bf16 v[240:243], v[92:95], v[104:107], 0
    ds_read_b128 v[140:143], v31 offset:6144
    s_add_u32 m0, s64, 32768
    v_mfma_f32_16x16x32_bf16 a[8:11], a[240:243], v[104:107], 0
    s_lshl_b32 s62, s61, 7
    v_lshl_add_u32 v48, v2, 4, v48
    v_lshrrev_b32 v49, 1, v48
    s_waitcnt lgkmcnt(8)
    v_mfma_f32_16x16x32_bf16 v[244:247], v[92:95], v[108:111], 0
    ds_read_b128 v[144:147], v31 offset:2048
    v_accvgpr_write_b32 a246, 0
    v_mfma_f32_16x16x32_bf16 a[12:15], a[240:243], v[108:111], 0
    buffer_load_dwordx4 v18, s[36:39], s62 offen offset:0 lds
    v_mfma_f32_16x16x32_bf16 v[220:223], v[88:91], v[108:111], 0
    ds_read_b128 v[148:151], v31 offset:8192
    v_accvgpr_write_b32 a247, v12
    v_mfma_f32_16x16x32_bf16 v[196:199], v[84:87], v[108:111], 0
    s_lshr_b32 s67, s23, 3
    s_and_b32 s68, s23, 7
    s_lshl2_add_u32 s4, s67, s60
    v_mfma_f32_16x16x32_bf16 v[172:175], v[80:83], v[108:111], 0
    s_mul_i32 s68, s68, 96
    s_add_u32 s4, s4, s68
    s_mul_i32 s4, s4, 5120
    s_waitcnt lgkmcnt(9)
    v_mfma_f32_16x16x32_bf16 v[176:179], v[80:83], v[112:115], 0
    ds_read_b128 v[152:155], v31 offset:4096
    s_add_u32 s67, s67, 4
    v_mfma_f32_16x16x32_bf16 v[200:203], v[84:87], v[112:115], 0
    buffer_load_dwordx4 v19, s[36:39], s62 offen offset:1024 lds
    v_mfma_f32_16x16x32_bf16 v[224:227], v[88:91], v[112:115], 0
    ds_read_b128 v[156:159], v31 offset:10240
    s_lshr_b32 s67, s67, 5
    v_mfma_f32_16x16x32_bf16 v[248:251], v[92:95], v[112:115], 0
    s_mul_i32 s67, s67, 1879048192
    s_add_u32 s4, s4, s67
    s_add_u32 s4, s4, 966656
    v_mfma_f32_16x16x32_bf16 a[16:19], a[240:243], v[112:115], 0
    s_waitcnt lgkmcnt(10)
    v_mfma_f32_16x16x32_bf16 v[252:255], v[92:95], v[116:119], 0
    v_mfma_f32_16x16x32_bf16 a[20:23], a[240:243], v[116:119], 0
    buffer_load_dwordx4 v20, s[36:39], s62 offen offset:2048 lds
    v_mfma_f32_16x16x32_bf16 v[228:231], v[88:91], v[116:119], 0
    v_mfma_f32_16x16x32_bf16 v[204:207], v[84:87], v[116:119], 0
    v_mfma_f32_16x16x32_bf16 v[180:183], v[80:83], v[116:119], 0
    s_waitcnt lgkmcnt(0)
    v_mfma_f32_16x16x32_bf16 v[160:163], v[120:123], v[136:139], v[160:163]
    s_mul_i32 s70, s74, 96
    s_add_u32 s70, s70, 156672
    s_lshl_b32 s68, s60, 5
    v_mfma_f32_16x16x32_bf16 v[184:187], v[124:127], v[136:139], v[184:187]
    s_add_u32 s68, s68, 122880
    v_lshl_add_u32 v4, v2, 1, s70
    v_lshl_add_u32 v12, v3, 3, s68
    v_mfma_f32_16x16x32_bf16 v[208:211], v[128:131], v[136:139], v[208:211]
    buffer_load_dwordx4 v21, s[36:39], s62 offen offset:3072 lds
    v_mfma_f32_16x16x32_bf16 v[232:235], v[132:135], v[136:139], v[232:235]
    s_add_u32 m0, s65, 49152
    s_mul_i32 s63, s61, s71
    v_and_b32 v13, 1, v2
    v_mfma_f32_16x16x32_bf16 a[0:3], a[240:243], v[136:139], a[0:3]
    v_lshlrev_b32 v14, 4, v13
    v_xor_b32 v6, v14, v12
    v_mfma_f32_16x16x32_bf16 v[236:239], v[132:135], v[140:143], v[236:239]
    v_lshl_add_u32 v6, v13, 9, v6
    v_lshrrev_b32 v13, 1, v2
    v_mfma_f32_16x16x32_bf16 a[4:7], a[240:243], v[140:143], a[4:7]
    buffer_load_dwordx4 v22, s[40:43], s63 offen offset:0 lds
    v_mfma_f32_16x16x32_bf16 v[212:215], v[128:131], v[140:143], v[212:215]
    v_mul_u32_u24 v13, 1056, v13
    v_add_u32 v6, v6, v13
    v_mfma_f32_16x16x32_bf16 v[188:191], v[124:127], v[140:143], v[188:191]
    v_lshlrev_b32 v14, 2, v2
    v_and_b32 v14, 16, v14
    v_mfma_f32_16x16x32_bf16 v[164:167], v[120:123], v[140:143], v[164:167]
    v_xor_b32 v5, v14, v12
    v_lshl_add_u32 v5, v2, 7, v5
    v_mfma_f32_16x16x32_bf16 v[168:171], v[120:123], v[144:147], v[168:171]
    buffer_load_dwordx4 v23, s[40:43], s63 offen offset:1024 lds
    v_mfma_f32_16x16x32_bf16 v[192:195], v[124:127], v[144:147], v[192:195]
    v_lshrrev_b32 v13, 3, v2
    v_lshl_add_u32 v5, v13, 5, v5
    v_mfma_f32_16x16x32_bf16 v[216:219], v[128:131], v[144:147], v[216:219]
    s_bfe_u32 s78, s2, 0x20001
    s_bfe_u32 s67, s2, 0x20003
    s_lshl2_add_u32 s78, s78, s67
    v_mfma_f32_16x16x32_bf16 v[240:243], v[132:135], v[144:147], v[240:243]
    s_lshr_b32 s67, s2, 7
    s_mul_i32 s68, s67, 56
    s_add_u32 s68, s68, s60
    v_mfma_f32_16x16x32_bf16 a[8:11], a[240:243], v[144:147], a[8:11]
    buffer_load_dwordx4 v24, s[40:43], s63 offen offset:2048 lds
    v_mfma_f32_16x16x32_bf16 v[244:247], v[132:135], v[148:151], v[244:247]
    s_add_u32 m0, s65, 52224
    s_add_u32 s61, s61, 1
    s_mul_i32 s76, s79, 96
    v_mfma_f32_16x16x32_bf16 a[12:15], a[240:243], v[148:151], a[12:15]
    s_add_u32 s76, s76, s68
    s_mul_i32 s76, s76, 5120
    s_add_u32 s76, s76, 1048576
    v_mfma_f32_16x16x32_bf16 v[220:223], v[128:131], v[148:151], v[220:223]
    s_mul_i32 s77, s78, 192
    s_add_u32 s77, s77, s68
    s_lshl_b32 s77, s77, 12
    v_mfma_f32_16x16x32_bf16 v[196:199], v[124:127], v[148:151], v[196:199]
    buffer_load_dwordx4 v25, s[40:43], s63 offen offset:0 lds
    v_mfma_f32_16x16x32_bf16 v[172:175], v[120:123], v[148:151], v[172:175]
    v_mfma_f32_16x16x32_bf16 v[176:179], v[120:123], v[152:155], v[176:179]
    v_mfma_f32_16x16x32_bf16 v[200:203], v[124:127], v[152:155], v[200:203]
    v_mfma_f32_16x16x32_bf16 v[224:227], v[128:131], v[152:155], v[224:227]
    buffer_load_dwordx4 v26, s[40:43], s63 offen offset:1024 lds
    v_mfma_f32_16x16x32_bf16 v[248:251], v[132:135], v[152:155], v[248:251]
    s_cmp_eq_u32 s61, 10
    s_cselect_b32 s61, 0, s61
    v_mfma_f32_16x16x32_bf16 a[16:19], a[240:243], v[152:155], a[16:19]
    v_mfma_f32_16x16x32_bf16 v[252:255], v[132:135], v[156:159], v[252:255]
    v_mfma_f32_16x16x32_bf16 a[20:23], a[240:243], v[156:159], a[20:23]
    buffer_load_dwordx4 v27, s[40:43], s63 offen offset:2048 lds
    v_mfma_f32_16x16x32_bf16 v[228:231], v[128:131], v[156:159], v[228:231]
    v_mfma_f32_16x16x32_bf16 v[204:207], v[124:127], v[156:159], v[204:207]
    v_mfma_f32_16x16x32_bf16 v[180:183], v[120:123], v[156:159], v[180:183]
    s_waitcnt vmcnt(10)
    s_barrier
    s_nop 0
    ds_read_b128 v[96:99], v30 offset:24576
    ds_read_b128 v[80:83], v28 offset:16384
    ds_read_b128 v[84:87], v28 offset:18432
    ds_read_b128 v[88:91], v28 offset:20480
    ds_read_b128 v[92:95], v28 offset:22528
    ds_read_b128 v[100:103], v30 offset:30720
    ds_read_b128 v[104:107], v30 offset:26624
    ds_read_b128 v[108:111], v30 offset:32768
    ds_read_b128 v[112:115], v30 offset:28672
    ds_read_b128 v[116:119], v30 offset:34816
    s_waitcnt lgkmcnt(8)
    v_mfma_f32_16x16x32_bf16 v[160:163], v[80:83], v[96:99], v[160:163]
    ds_read_b64 a[24:25], v6 offset:0
    s_add_u32 s77, s77, 5242880
    s_waitcnt lgkmcnt(8)
    v_mfma_f32_16x16x32_bf16 v[184:187], v[84:87], v[96:99], v[184:187]
    ds_read_b128 v[136:139], v31 offset:24576
    ds_read_b128 v[120:123], v29 offset:16384
    s_waitcnt lgkmcnt(9)
    v_mfma_f32_16x16x32_bf16 v[208:211], v[88:91], v[96:99], v[208:211]
    s_add_u32 m0, s64, 0
    s_lshl_b32 s62, s61, 7
    s_lshl1_add_u32 s80, s78, s73
    s_waitcnt lgkmcnt(8)
    v_mfma_f32_16x16x32_bf16 v[232:235], v[92:95], v[96:99], v[232:235]
    buffer_load_dwordx4 v18, s[36:39], s62 offen offset:0 lds
    s_waitcnt lgkmcnt(7)
    v_mfma_f32_16x16x32_bf16 v[236:239], v[92:95], v[100:103], v[236:239]
    ds_read_b64 a[26:27], v6 offset:10560
    s_lshl3_add_u32 s80, s80, s67
    v_mfma_f32_16x16x32_bf16 v[212:215], v[88:91], v[100:103], v[212:215]
    buffer_load_dwordx4 v19, s[36:39], s62 offen offset:1024 lds
    v_mfma_f32_16x16x32_bf16 v[188:191], v[84:87], v[100:103], v[188:191]
    ds_read_b64 a[28:29], v6 offset:128
    s_lshl1_add_u32 s80, s80, s74
    v_mfma_f32_16x16x32_bf16 v[164:167], v[80:83], v[100:103], v[164:167]
    ds_read_b64 a[30:31], v6 offset:10688
    s_lshl_b32 s80, s80, 2
    s_waitcnt lgkmcnt(9)
    v_mfma_f32_16x16x32_bf16 v[168:171], v[80:83], v[104:107], v[168:171]
    buffer_load_dwordx4 v20, s[36:39], s62 offen offset:2048 lds
    v_mfma_f32_16x16x32_bf16 v[192:195], v[84:87], v[104:107], v[192:195]
    ds_read_b64 a[32:33], v6 offset:256
    s_lshl_b32 s67, s73, 2
    v_mfma_f32_16x16x32_bf16 v[216:219], v[88:91], v[104:107], v[216:219]
    buffer_load_dwordx4 v21, s[36:39], s62 offen offset:3072 lds
    v_mfma_f32_16x16x32_bf16 v[240:243], v[92:95], v[104:107], v[240:243]
    ds_read_b64 a[34:35], v6 offset:10816
    s_add_u32 m0, s65, 0
    s_waitcnt lgkmcnt(10)
    v_mfma_f32_16x16x32_bf16 v[244:247], v[92:95], v[108:111], v[244:247]
    ds_read_b128 v[124:127], v29 offset:18432
    ds_read_b128 v[128:131], v29 offset:20480
    v_mfma_f32_16x16x32_bf16 v[220:223], v[88:91], v[108:111], v[220:223]
    ds_read_b64 a[36:37], v6 offset:384
    s_mul_i32 s63, s61, s71
    v_mfma_f32_16x16x32_bf16 v[196:199], v[84:87], v[108:111], v[196:199]
    buffer_load_dwordx4 v22, s[40:43], s63 offen offset:0 lds
    v_mfma_f32_16x16x32_bf16 v[172:175], v[80:83], v[108:111], v[172:175]
    buffer_load_dwordx4 v23, s[40:43], s63 offen offset:1024 lds
    s_waitcnt lgkmcnt(12)
    v_mfma_f32_16x16x32_bf16 v[176:179], v[80:83], v[112:115], v[176:179]
    ds_read_b64 a[38:39], v6 offset:10944
    v_accvgpr_read_b32 v76, a0
    v_mfma_f32_16x16x32_bf16 v[200:203], v[84:87], v[112:115], v[200:203]
    ds_read_b128 v[132:135], v29 offset:22528
    ds_read_b128 v[140:143], v31 offset:30720
    v_mfma_f32_16x16x32_bf16 v[224:227], v[88:91], v[112:115], v[224:227]
    ds_read_b128 v[144:147], v31 offset:26624
    ds_read_b128 v[148:151], v31 offset:32768
    v_mfma_f32_16x16x32_bf16 v[248:251], v[92:95], v[112:115], v[248:251]
    ds_read_b128 v[152:155], v31 offset:28672
    ds_read_b128 v[156:159], v31 offset:34816
    s_waitcnt lgkmcnt(15)
    v_mfma_f32_16x16x32_bf16 v[252:255], v[92:95], v[116:119], v[252:255]
    buffer_load_dwordx4 v24, s[40:43], s63 offen offset:2048 lds
    v_mfma_f32_16x16x32_bf16 v[228:231], v[88:91], v[116:119], v[228:231]
    ds_read_b64 a[40:41], v5 offset:8448
    s_add_u32 m0, s65, 3072
    v_mfma_f32_16x16x32_bf16 v[204:207], v[84:87], v[116:119], v[204:207]
    ds_read_b64 a[42:43], v5 offset:19008
    s_add_u32 s61, s61, 1
    v_mfma_f32_16x16x32_bf16 v[180:183], v[80:83], v[116:119], v[180:183]
    buffer_load_dwordx4 v25, s[40:43], s63 offen offset:0 lds
    buffer_load_dwordx4 v26, s[40:43], s63 offen offset:1024 lds
    s_cmp_eq_u32 s61, 10
    s_cselect_b32 s61, 0, s61
    buffer_load_dwordx4 v27, s[40:43], s63 offen offset:2048 lds
    v_accvgpr_read_b32 v77, a4
    v_accvgpr_read_b32 v78, a8
    v_accvgpr_read_b32 v79, a12
    v_accvgpr_read_b32 v46, a16
    v_accvgpr_read_b32 v47, a20
    s_bitcmp1_b32 s75, 30
    s_cbranch_scc1 L_Sopt1
    buffer_store_dwordx4 v[76:79], v48, s[44:47], s75 offen sc1
L_Sopt1:
    s_bitcmp1_b32 s75, 30
    s_cbranch_scc1 L_Sopt2
    buffer_store_dwordx2 v[46:47], v49, s[44:47], s75 offen offset:256 sc1
L_Sopt2:
    v_add_u32 v12, s67, v3
    v_lshlrev_b32 v53, 8, v12
    v_cvt_f32_u32 v53, v53
    v_subrev_u32 v14, 1, v12
    v_lshlrev_b32 v14, 4, v14
    v_add_u32 v7, 1, v12
    v_cmp_gt_u32 s[26:27], 2, v12
    s_mul_i32 s67, s74, 384
    s_waitcnt vmcnt(10) lgkmcnt(0)
    s_barrier
    v_mfma_f32_16x16x32_bf16 v[160:163], v[120:123], v[136:139], v[160:163]
    ds_read_u16 v32, v4 offset:0
    s_add_u32 s67, s67, 143360
    v_mfma_f32_16x16x32_bf16 v[184:187], v[124:127], v[136:139], v[184:187]
    ds_read_b128 v[96:99], v30 offset:49152
    ds_read_b128 v[80:83], v28 offset:32768
    v_mfma_f32_16x16x32_bf16 v[208:211], v[128:131], v[136:139], v[208:211]
    s_add_u32 m0, s64, 16384
    s_lshl_b32 s62, s61, 7
    v_cndmask_b32 v54, v14, v7, s[26:27]
    v_mfma_f32_16x16x32_bf16 v[232:235], v[132:135], v[136:139], v[232:235]
    buffer_load_dwordx4 v18, s[36:39], s62 offen offset:0 lds
    v_mfma_f32_16x16x32_bf16 v[236:239], v[132:135], v[140:143], v[236:239]
    ds_read_u16 v33, v4 offset:32
    v_cvt_f32_u32 v54, v54
    v_mfma_f32_16x16x32_bf16 v[212:215], v[128:131], v[140:143], v[212:215]
    s_bitcmp1_b32 s4, 30
    s_cbranch_scc1 L_Sopt3
    buffer_store_dwordx4 a[24:27], v15, s[44:47], s4 offen offset:0 sc1
L_Sopt3:
    v_mfma_f32_16x16x32_bf16 v[188:191], v[124:127], v[140:143], v[188:191]
    ds_read_u16 v34, v4 offset:64
    v_mul_u32_u24 v50, 768, v12
    v_mfma_f32_16x16x32_bf16 v[164:167], v[120:123], v[140:143], v[164:167]
    buffer_load_dwordx4 v19, s[36:39], s62 offen offset:1024 lds
    v_mfma_f32_16x16x32_bf16 v[168:171], v[120:123], v[144:147], v[168:171]
    ds_read_u16 v35, v4 offset:256
    v_lshl_add_u32 v14, v2, 3, s67
    v_mfma_f32_16x16x32_bf16 v[192:195], v[124:127], v[144:147], v[192:195]
    ds_read_b128 v[84:87], v28 offset:34816
    ds_read_b128 v[88:91], v28 offset:36864
    v_mfma_f32_16x16x32_bf16 v[216:219], v[128:131], v[144:147], v[216:219]
    ds_read_u16 v36, v4 offset:288
    v_add_u32 v50, v50, v14
    v_mfma_f32_16x16x32_bf16 v[240:243], v[132:135], v[144:147], v[240:243]
    s_bitcmp1_b32 s4, 30
    s_cbranch_scc1 L_Sopt4
    buffer_store_dwordx4 a[28:31], v15, s[44:47], s4 offen offset:1024 sc1
L_Sopt4:
    v_mfma_f32_16x16x32_bf16 v[244:247], v[132:135], v[148:151], v[244:247]
    buffer_load_dwordx4 v20, s[36:39], s62 offen offset:2048 lds
    v_mfma_f32_16x16x32_bf16 v[220:223], v[128:131], v[148:151], v[220:223]
    ds_read_u16 v37, v4 offset:320
    v_add_u32 v51, 10752, v14
    v_mfma_f32_16x16x32_bf16 v[196:199], v[124:127], v[148:151], v[196:199]
    ds_read_u16 v38, v4 offset:512
    v_cmp_eq_u32 s[26:27], 0, v12
    v_mfma_f32_16x16x32_bf16 v[172:175], v[120:123], v[148:151], v[172:175]
    ds_read_b128 v[92:95], v28 offset:38912
    ds_read_b128 v[100:103], v30 offset:55296
    v_mfma_f32_16x16x32_bf16 v[176:179], v[120:123], v[152:155], v[176:179]
    buffer_load_dwordx4 v21, s[36:39], s62 offen offset:3072 lds
    v_mfma_f32_16x16x32_bf16 v[200:203], v[124:127], v[152:155], v[200:203]
    s_bitcmp1_b32 s4, 30
    s_cbranch_scc1 L_Sopt5
    buffer_store_dwordx4 a[32:35], v15, s[44:47], s4 offen offset:2048 sc1
L_Sopt5:
    v_mfma_f32_16x16x32_bf16 v[224:227], v[128:131], v[152:155], v[224:227]
    ds_read_b128 v[104:107], v30 offset:51200
    ds_read_b128 v[108:111], v30 offset:57344
    v_mfma_f32_16x16x32_bf16 v[248:251], v[132:135], v[152:155], v[248:251]
    ds_read_b128 v[112:115], v30 offset:53248
    ds_read_b128 v[116:119], v30 offset:59392
    v_mfma_f32_16x16x32_bf16 v[252:255], v[132:135], v[156:159], v[252:255]
    ds_read_u16 v39, v4 offset:544
    s_add_u32 m0, s65, 24576
    v_mfma_f32_16x16x32_bf16 v[228:231], v[128:131], v[156:159], v[228:231]
    ds_read_u16 v40, v4 offset:576
    s_mul_i32 s63, s61, s71
    v_mfma_f32_16x16x32_bf16 v[204:207], v[124:127], v[156:159], v[204:207]
    buffer_load_dwordx4 v22, s[40:43], s63 offen offset:0 lds
    v_mfma_f32_16x16x32_bf16 v[180:183], v[120:123], v[156:159], v[180:183]
    v_add_u32 v7, 13312, v50
    v_add_u32 v52, 6144, v50
    v_cndmask_b32 v51, v7, v51, s[26:27]
    v_cmp_eq_u32 s[26:27], 6, v12
    s_nop 1
    v_cndmask_b32 v52, v52, v7, s[26:27]
    v_cmp_gt_u32 s[26:27], 6, v12
    s_waitcnt lgkmcnt(0)
    v_mfma_f32_16x16x32_bf16 v[160:163], v[80:83], v[96:99], v[160:163]
    ds_read_b128 v[136:139], v31 offset:49152
    v_and_b32 v12, 7, v0
    v_mfma_f32_16x16x32_bf16 v[184:187], v[84:87], v[96:99], v[184:187]
    ds_read_b128 v[120:123], v29 offset:32768
    v_lshlrev_b32 v12, 3, v12
    v_mfma_f32_16x16x32_bf16 v[208:211], v[88:91], v[96:99], v[208:211]
    buffer_load_dwordx4 v23, s[40:43], s63 offen offset:1024 lds
    v_mfma_f32_16x16x32_bf16 v[232:235], v[92:95], v[96:99], v[232:235]
    ds_read_b128 v[124:127], v29 offset:34816
    v_add_u32 v12, 162816, v12
    v_mfma_f32_16x16x32_bf16 v[236:239], v[92:95], v[100:103], v[236:239]
    ds_read_b64 v[8:9], v12
    v_mov_b32 v16, s66
    v_mfma_f32_16x16x32_bf16 v[212:215], v[88:91], v[100:103], v[212:215]
    s_bitcmp1_b32 s4, 30
    s_cbranch_scc1 L_Sopt6
    buffer_store_dwordx4 a[36:39], v15, s[44:47], s4 offen offset:3072 sc1
L_Sopt6:
    v_mfma_f32_16x16x32_bf16 v[188:191], v[84:87], v[100:103], v[188:191]
    ds_read_b128 v[128:131], v29 offset:36864
    s_add_u32 s4, s4, 4096
    v_mfma_f32_16x16x32_bf16 v[164:167], v[80:83], v[100:103], v[164:167]
    buffer_load_dwordx4 v24, s[40:43], s63 offen offset:2048 lds
    v_mfma_f32_16x16x32_bf16 v[168:171], v[80:83], v[104:107], v[168:171]
    ds_read_b128 v[132:135], v29 offset:38912
    s_add_u32 m0, s65, 27648
    v_mfma_f32_16x16x32_bf16 v[192:195], v[84:87], v[104:107], v[192:195]
    ds_read_b128 v[140:143], v31 offset:55296
    s_add_u32 s61, s61, 1
    v_mfma_f32_16x16x32_bf16 v[216:219], v[88:91], v[104:107], v[216:219]
    v_mov_b32 v10, s66
    v_mov_b32 v11, s66
    v_mfma_f32_16x16x32_bf16 v[240:243], v[92:95], v[104:107], v[240:243]
    buffer_load_dwordx4 v25, s[40:43], s63 offen offset:0 lds
    v_mfma_f32_16x16x32_bf16 v[244:247], v[92:95], v[108:111], v[244:247]
    ds_read_b128 v[144:147], v31 offset:51200
    v_lshrrev_b32 v12, 3, v0
    v_mfma_f32_16x16x32_bf16 v[220:223], v[88:91], v[108:111], v[220:223]
    s_bitcmp1_b32 s4, 30
    s_cbranch_scc1 L_Sopt7
    buffer_store_dwordx4 a[40:43], v15, s[44:47], s4 offen offset:0 sc1
L_Sopt7:
    v_mfma_f32_16x16x32_bf16 v[196:199], v[84:87], v[108:111], v[196:199]
    ds_read_b128 v[148:151], v31 offset:57344
    v_lshlrev_b32 v12, 25, v12
    v_mfma_f32_16x16x32_bf16 v[172:175], v[80:83], v[108:111], v[172:175]
    ds_read_b128 v[152:155], v31 offset:53248
    v_lshl_add_u32 v12, v0, 4, v12
    v_mfma_f32_16x16x32_bf16 v[176:179], v[80:83], v[112:115], v[176:179]
    buffer_load_dwordx4 v26, s[40:43], s63 offen offset:1024 lds
    v_mfma_f32_16x16x32_bf16 v[200:203], v[84:87], v[112:115], v[200:203]
    ds_read_b128 v[156:159], v31 offset:59392
    s_lshl4_add_u32 s67, s3, s22
    v_mfma_f32_16x16x32_bf16 v[224:227], v[88:91], v[112:115], v[224:227]
    s_cmp_eq_u32 s61, 10
    s_cselect_b32 s61, 0, s61
    s_lshl_b32 s67, s67, 7
    v_mfma_f32_16x16x32_bf16 v[248:251], v[92:95], v[112:115], v[248:251]
    s_add_u32 s67, s67, 32768
    v_lshlrev_b32 v38, 16, v38
    v_mul_f32 v38, 0x3fb8aa3b, v38
    v_mfma_f32_16x16x32_bf16 v[252:255], v[92:95], v[116:119], v[252:255]
    buffer_load_dwordx4 v27, s[40:43], s63 offen offset:2048 lds
    v_mfma_f32_16x16x32_bf16 v[228:231], v[88:91], v[116:119], v[228:231]
    v_exp_f32 v38, v38
    v_mfma_f32_16x16x32_bf16 v[204:207], v[84:87], v[116:119], v[204:207]
    v_lshlrev_b32 v32, 16, v32
    v_lshlrev_b32 v35, 16, v35
    v_mfma_f32_16x16x32_bf16 v[180:183], v[80:83], v[116:119], v[180:183]
    s_waitcnt vmcnt(10) lgkmcnt(0)
    s_barrier
    v_mfma_f32_16x16x32_bf16 v[160:163], v[120:123], v[136:139], v[160:163]
    s_cmp_lg_u32 s60, 0
    s_cbranch_scc1 L_Sopt8
    buffer_store_dwordx4 v[8:11], v12, s[44:47], s67 offen sc1
L_Sopt8:
    v_mfma_f32_16x16x32_bf16 v[184:187], v[124:127], v[136:139], v[184:187]
    ds_read_b128 v[96:99], v30 offset:0
    s_add_u32 m0, s64, 32768
    v_mfma_f32_16x16x32_bf16 v[208:211], v[128:131], v[136:139], v[208:211]
    ds_read_b128 v[80:83], v28 offset:0
    s_lshl_b32 s62, s61, 7
    v_mfma_f32_16x16x32_bf16 v[232:235], v[132:135], v[136:139], v[232:235]
    buffer_load_dwordx4 v18, s[36:39], s62 offen offset:0 lds
    v_mfma_f32_16x16x32_bf16 v[236:239], v[132:135], v[140:143], v[236:239]
    ds_read_b128 v[84:87], v28 offset:2048
    v_cvt_pk_bf16_f32 v38, v38, v38
    v_mfma_f32_16x16x32_bf16 v[212:215], v[128:131], v[140:143], v[212:215]
    ds_read_b128 v[88:91], v28 offset:4096
    v_lshlrev_b32 v38, 16, v38
    v_mfma_f32_16x16x32_bf16 v[188:191], v[124:127], v[140:143], v[188:191]
    v_mul_f32 v74, v38, v32
    v_mul_f32 v75, v38, v35
    v_mfma_f32_16x16x32_bf16 v[164:167], v[120:123], v[140:143], v[164:167]
    buffer_load_dwordx4 v19, s[36:39], s62 offen offset:1024 lds
    v_mfma_f32_16x16x32_bf16 v[168:171], v[120:123], v[144:147], v[168:171]
    ds_read_b128 v[92:95], v28 offset:6144
    v_mul_f32 v74, 0x3fb8aa3b, v74
    v_mfma_f32_16x16x32_bf16 v[192:195], v[124:127], v[144:147], v[192:195]
    ds_read_b128 v[100:103], v30 offset:6144
    v_mul_f32 v75, 0x3e22f983, v75
    v_mfma_f32_16x16x32_bf16 v[216:219], v[128:131], v[144:147], v[216:219]
    v_mul_f32 v76, v53, v74
    v_mul_f32 v77, v53, v75
    v_mfma_f32_16x16x32_bf16 v[240:243], v[132:135], v[144:147], v[240:243]
    buffer_load_dwordx4 v20, s[36:39], s62 offen offset:2048 lds
    v_mfma_f32_16x16x32_bf16 v[244:247], v[132:135], v[148:151], v[244:247]
    ds_read_b128 v[104:107], v30 offset:2048
    v_mfma_f32_16x16x32_bf16 v[220:223], v[128:131], v[148:151], v[220:223]
    ds_read_b128 v[108:111], v30 offset:8192
    v_mfma_f32_16x16x32_bf16 v[196:199], v[124:127], v[148:151], v[196:199]
    v_exp_f32 v76, v76
    v_mfma_f32_16x16x32_bf16 v[172:175], v[120:123], v[148:151], v[172:175]
    ds_read_b128 v[112:115], v30 offset:4096
    v_fract_f32 v77, v77
    v_mfma_f32_16x16x32_bf16 v[176:179], v[120:123], v[152:155], v[176:179]
    buffer_load_dwordx4 v21, s[36:39], s62 offen offset:3072 lds
    v_mfma_f32_16x16x32_bf16 v[200:203], v[124:127], v[152:155], v[200:203]
    ds_read_b128 v[116:119], v30 offset:10240
    s_add_u32 m0, s65, 49152
    v_mfma_f32_16x16x32_bf16 v[224:227], v[128:131], v[152:155], v[224:227]
    s_mul_i32 s63, s61, s71
    v_cos_f32 v56, v77
    v_mfma_f32_16x16x32_bf16 v[248:251], v[132:135], v[152:155], v[248:251]
    v_sin_f32 v57, v77
    v_mfma_f32_16x16x32_bf16 v[252:255], v[132:135], v[156:159], v[252:255]
    buffer_load_dwordx4 v22, s[40:43], s63 offen offset:0 lds
    v_mfma_f32_16x16x32_bf16 v[228:231], v[128:131], v[156:159], v[228:231]
    v_mul_f32 v56, v56, v76
    v_mul_f32 v57, v57, v76
    v_mfma_f32_16x16x32_bf16 v[204:207], v[124:127], v[156:159], v[204:207]
    v_mul_f32 v76, v54, v74
    v_mul_f32 v77, v54, v75
    v_mfma_f32_16x16x32_bf16 v[180:183], v[120:123], v[156:159], v[180:183]
    s_waitcnt lgkmcnt(0)
    v_mfma_f32_16x16x32_bf16 v[160:163], v[80:83], v[96:99], v[160:163]
    ds_read_b128 v[136:139], v31 offset:0
    v_lshrrev_b32 v14, 5, v0
    v_mfma_f32_16x16x32_bf16 v[184:187], v[84:87], v[96:99], v[184:187]
    ds_read_b128 v[120:123], v29 offset:0
    v_min_u32 v14, 1, v14
    v_mfma_f32_16x16x32_bf16 v[208:211], v[88:91], v[96:99], v[208:211]
    buffer_load_dwordx4 v23, s[40:43], s63 offen offset:1024 lds
    v_mfma_f32_16x16x32_bf16 v[232:235], v[92:95], v[96:99], v[232:235]
    ds_read_b128 v[124:127], v29 offset:2048
    v_lshlrev_b32 v14, 25, v14
    v_mfma_f32_16x16x32_bf16 v[236:239], v[92:95], v[100:103], v[236:239]
    v_lshl_add_u32 v14, v0, 2, v14
    s_lshl_b32 s69, s23, 7
    v_mfma_f32_16x16x32_bf16 v[212:215], v[88:91], v[100:103], v[212:215]
    ds_read_b128 v[128:131], v29 offset:4096
    s_add_u32 s69, s69, 98304
    v_mfma_f32_16x16x32_bf16 v[188:191], v[84:87], v[100:103], v[188:191]
    v_exp_f32 v76, v76
    v_mfma_f32_16x16x32_bf16 v[164:167], v[80:83], v[100:103], v[164:167]
    buffer_load_dwordx4 v24, s[40:43], s63 offen offset:2048 lds
    v_mfma_f32_16x16x32_bf16 v[168:171], v[80:83], v[104:107], v[168:171]
    ds_read_b128 v[132:135], v29 offset:6144
    s_add_u32 m0, s65, 52224
    v_mfma_f32_16x16x32_bf16 v[192:195], v[84:87], v[104:107], v[192:195]
    ds_read_b128 v[140:143], v31 offset:6144
    s_add_u32 s61, s61, 1
    v_mfma_f32_16x16x32_bf16 v[216:219], v[88:91], v[104:107], v[216:219]
    v_fract_f32 v77, v77
    v_mfma_f32_16x16x32_bf16 v[240:243], v[92:95], v[104:107], v[240:243]
    buffer_load_dwordx4 v25, s[40:43], s63 offen offset:0 lds
    v_mfma_f32_16x16x32_bf16 v[244:247], v[92:95], v[108:111], v[244:247]
    ds_read_b128 v[144:147], v31 offset:2048
    v_mfma_f32_16x16x32_bf16 v[220:223], v[88:91], v[108:111], v[220:223]
    ds_read_b128 v[148:151], v31 offset:8192
    v_mfma_f32_16x16x32_bf16 v[196:199], v[84:87], v[108:111], v[196:199]
    v_cos_f32 v58, v77
    v_mfma_f32_16x16x32_bf16 v[172:175], v[80:83], v[108:111], v[172:175]
    ds_read_b128 v[152:155], v31 offset:4096
    v_mfma_f32_16x16x32_bf16 v[176:179], v[80:83], v[112:115], v[176:179]
    buffer_load_dwordx4 v26, s[40:43], s63 offen offset:1024 lds
    v_mfma_f32_16x16x32_bf16 v[200:203], v[84:87], v[112:115], v[200:203]
    ds_read_b128 v[156:159], v31 offset:10240
    v_mfma_f32_16x16x32_bf16 v[224:227], v[88:91], v[112:115], v[224:227]
    s_cmp_eq_u32 s61, 10
    s_cselect_b32 s61, 0, s61
    v_mfma_f32_16x16x32_bf16 v[248:251], v[92:95], v[112:115], v[248:251]
    v_sin_f32 v59, v77
    v_mfma_f32_16x16x32_bf16 v[252:255], v[92:95], v[116:119], v[252:255]
    buffer_load_dwordx4 v27, s[40:43], s63 offen offset:2048 lds
    v_mfma_f32_16x16x32_bf16 v[228:231], v[88:91], v[116:119], v[228:231]
    v_cndmask_b32 v76, 0, v76, s[26:27]
    v_mul_f32 v58, v58, v76
    v_mfma_f32_16x16x32_bf16 v[204:207], v[84:87], v[116:119], v[204:207]
    v_mul_f32 v59, v59, v76
    v_mul_f32 v76, v32, v32
    v_mfma_f32_16x16x32_bf16 v[180:183], v[80:83], v[116:119], v[180:183]
    s_waitcnt vmcnt(10) lgkmcnt(0)
    s_barrier
    v_mfma_f32_16x16x32_bf16 v[160:163], v[120:123], v[136:139], v[160:163]
    buffer_store_dword v16, v14, s[44:47], s69 offen sc1
    v_mfma_f32_16x16x32_bf16 v[184:187], v[124:127], v[136:139], v[184:187]
    ds_read_b128 v[96:99], v30 offset:24576
    s_add_u32 m0, s64, 0
    v_mfma_f32_16x16x32_bf16 v[208:211], v[128:131], v[136:139], v[208:211]
    ds_read_b128 v[80:83], v28 offset:16384
    s_lshl_b32 s62, s61, 7
    v_mfma_f32_16x16x32_bf16 v[232:235], v[132:135], v[136:139], v[232:235]
    buffer_load_dwordx4 v18, s[36:39], s62 offen offset:0 lds
    v_mfma_f32_16x16x32_bf16 v[236:239], v[132:135], v[140:143], v[236:239]
    ds_read_b128 v[84:87], v28 offset:18432
    v_fmac_f32 v76, v35, v35
    v_mfma_f32_16x16x32_bf16 v[212:215], v[128:131], v[140:143], v[212:215]
    ds_read_b128 v[88:91], v28 offset:20480
    v_mfma_f32_16x16x32_bf16 v[188:191], v[124:127], v[140:143], v[188:191]
L_SA_pad0:
    s_cbranch_execz L_SA_pad4
    v_rcp_f32 v76, v76
    v_mfma_f32_16x16x32_bf16 v[164:167], v[120:123], v[140:143], v[164:167]
    buffer_load_dwordx4 v19, s[36:39], s62 offen offset:1024 lds
    v_mfma_f32_16x16x32_bf16 v[168:171], v[120:123], v[144:147], v[168:171]
    ds_read_b128 v[92:95], v28 offset:22528
    v_add_f32 v77, -1.0, v58
    v_mfma_f32_16x16x32_bf16 v[192:195], v[124:127], v[144:147], v[192:195]
    ds_read_b128 v[100:103], v30 offset:30720
    v_mul_f32 v60, v77, v32
    v_mfma_f32_16x16x32_bf16 v[216:219], v[128:131], v[144:147], v[216:219]
    v_mul_f32 v61, v59, v32
    v_fmac_f32 v60, v59, v35
    v_mfma_f32_16x16x32_bf16 v[240:243], v[132:135], v[144:147], v[240:243]
    buffer_load_dwordx4 v20, s[36:39], s62 offen offset:2048 lds
    v_mfma_f32_16x16x32_bf16 v[244:247], v[132:135], v[148:151], v[244:247]
    ds_read_b128 v[104:107], v30 offset:26624
    v_fma_f32 v61, -v77, v35, v61
    v_mfma_f32_16x16x32_bf16 v[220:223], v[128:131], v[148:151], v[220:223]
    ds_read_b128 v[108:111], v30 offset:32768
    v_add_f32 v76, v76, v76
    v_mfma_f32_16x16x32_bf16 v[196:199], v[124:127], v[148:151], v[196:199]
    v_mul_f32 v60, v60, v76
    v_mul_f32 v61, v61, v76
    v_mfma_f32_16x16x32_bf16 v[172:175], v[120:123], v[148:151], v[172:175]
    ds_read_b128 v[112:115], v30 offset:28672
    v_lshlrev_b32 v39, 16, v39
    v_mfma_f32_16x16x32_bf16 v[176:179], v[120:123], v[152:155], v[176:179]
    buffer_load_dwordx4 v21, s[36:39], s62 offen offset:3072 lds
    v_mfma_f32_16x16x32_bf16 v[200:203], v[124:127], v[152:155], v[200:203]
    ds_read_b128 v[116:119], v30 offset:34816
    s_add_u32 m0, s65, 0
    v_mfma_f32_16x16x32_bf16 v[224:227], v[128:131], v[152:155], v[224:227]
    s_mul_i32 s63, s61, s71
    v_mul_f32 v39, 0x3fb8aa3b, v39
    v_mfma_f32_16x16x32_bf16 v[248:251], v[132:135], v[152:155], v[248:251]
    v_exp_f32 v39, v39
    v_mfma_f32_16x16x32_bf16 v[252:255], v[132:135], v[156:159], v[252:255]
    buffer_load_dwordx4 v22, s[40:43], s63 offen offset:0 lds
    v_mfma_f32_16x16x32_bf16 v[228:231], v[128:131], v[156:159], v[228:231]
    v_lshlrev_b32 v33, 16, v33
    v_lshlrev_b32 v36, 16, v36
    v_mfma_f32_16x16x32_bf16 v[204:207], v[124:127], v[156:159], v[204:207]
    v_cvt_pk_bf16_f32 v39, v39, v39
    v_lshlrev_b32 v39, 16, v39
    v_mfma_f32_16x16x32_bf16 v[180:183], v[120:123], v[156:159], v[180:183]
    v_mul_f32 v74, v39, v33
    s_waitcnt lgkmcnt(0)
    v_mfma_f32_16x16x32_bf16 v[160:163], v[80:83], v[96:99], v[160:163]
    ds_read_b128 v[136:139], v31 offset:24576
    v_mul_f32 v75, v39, v36
    v_mfma_f32_16x16x32_bf16 v[184:187], v[84:87], v[96:99], v[184:187]
    ds_read_b128 v[120:123], v29 offset:16384
    v_mul_f32 v74, 0x3fb8aa3b, v74
    v_mfma_f32_16x16x32_bf16 v[208:211], v[88:91], v[96:99], v[208:211]
    buffer_load_dwordx4 v23, s[40:43], s63 offen offset:1024 lds
    v_mfma_f32_16x16x32_bf16 v[232:235], v[92:95], v[96:99], v[232:235]
    ds_read_b128 v[124:127], v29 offset:18432
    v_mul_f32 v75, 0x3e22f983, v75
    v_mfma_f32_16x16x32_bf16 v[236:239], v[92:95], v[100:103], v[236:239]
    v_mul_f32 v76, v53, v74
    v_mul_f32 v77, v53, v75
    v_mfma_f32_16x16x32_bf16 v[212:215], v[88:91], v[100:103], v[212:215]
    ds_read_b128 v[128:131], v29 offset:20480
    v_mfma_f32_16x16x32_bf16 v[188:191], v[84:87], v[100:103], v[188:191]
    v_exp_f32 v76, v76
    v_mfma_f32_16x16x32_bf16 v[164:167], v[80:83], v[100:103], v[164:167]
    buffer_load_dwordx4 v24, s[40:43], s63 offen offset:2048 lds
    v_mfma_f32_16x16x32_bf16 v[168:171], v[80:83], v[104:107], v[168:171]
    ds_read_b128 v[132:135], v29 offset:22528
    s_add_u32 m0, s65, 3072
    v_mfma_f32_16x16x32_bf16 v[192:195], v[84:87], v[104:107], v[192:195]
    ds_read_b128 v[140:143], v31 offset:30720
    s_add_u32 s61, s61, 1
    v_mfma_f32_16x16x32_bf16 v[216:219], v[88:91], v[104:107], v[216:219]
    v_fract_f32 v77, v77
    v_mfma_f32_16x16x32_bf16 v[240:243], v[92:95], v[104:107], v[240:243]
    buffer_load_dwordx4 v25, s[40:43], s63 offen offset:0 lds
    v_mfma_f32_16x16x32_bf16 v[244:247], v[92:95], v[108:111], v[244:247]
    ds_read_b128 v[144:147], v31 offset:26624
    v_mfma_f32_16x16x32_bf16 v[220:223], v[88:91], v[108:111], v[220:223]
    ds_read_b128 v[148:151], v31 offset:32768
    v_mfma_f32_16x16x32_bf16 v[196:199], v[84:87], v[108:111], v[196:199]
    v_cos_f32 v62, v77
    v_mfma_f32_16x16x32_bf16 v[172:175], v[80:83], v[108:111], v[172:175]
    ds_read_b128 v[152:155], v31 offset:28672
    v_mfma_f32_16x16x32_bf16 v[176:179], v[80:83], v[112:115], v[176:179]
    buffer_load_dwordx4 v26, s[40:43], s63 offen offset:1024 lds
    v_mfma_f32_16x16x32_bf16 v[200:203], v[84:87], v[112:115], v[200:203]
    ds_read_b128 v[156:159], v31 offset:34816
    v_mfma_f32_16x16x32_bf16 v[224:227], v[88:91], v[112:115], v[224:227]
    s_cmp_eq_u32 s61, 10
    s_cselect_b32 s61, 0, s61
    v_mfma_f32_16x16x32_bf16 v[248:251], v[92:95], v[112:115], v[248:251]
    v_sin_f32 v63, v77
    v_mfma_f32_16x16x32_bf16 v[252:255], v[92:95], v[116:119], v[252:255]
    buffer_load_dwordx4 v27, s[40:43], s63 offen offset:2048 lds
    v_mfma_f32_16x16x32_bf16 v[228:231], v[88:91], v[116:119], v[228:231]
    v_mul_f32 v62, v62, v76
    v_mul_f32 v63, v63, v76
    v_mfma_f32_16x16x32_bf16 v[204:207], v[84:87], v[116:119], v[204:207]
    v_mul_f32 v76, v54, v74
    v_mul_f32 v77, v54, v75
    v_mfma_f32_16x16x32_bf16 v[180:183], v[80:83], v[116:119], v[180:183]
    s_waitcnt vmcnt(11) lgkmcnt(0)
    s_barrier
    v_mfma_f32_16x16x32_bf16 v[160:163], v[120:123], v[136:139], v[160:163]
    ds_read_b128 v[96:99], v30 offset:49152
    s_lshl_b32 s67, s3, 7
    v_mfma_f32_16x16x32_bf16 v[184:187], v[124:127], v[136:139], v[184:187]
    ds_read_b128 v[80:83], v28 offset:32768
    s_add_u32 m0, s64, 16384
    v_mfma_f32_16x16x32_bf16 v[208:211], v[128:131], v[136:139], v[208:211]
    s_lshl_b32 s62, s61, 7
    v_add_u32 v12, s67, v0
    v_lshlrev_b32 v12, 4, v12
    v_mfma_f32_16x16x32_bf16 v[232:235], v[132:135], v[136:139], v[232:235]
    buffer_load_dwordx4 v18, s[36:39], s62 offen offset:0 lds
    v_mfma_f32_16x16x32_bf16 v[236:239], v[132:135], v[140:143], v[236:239]
    ds_read_b128 v[84:87], v28 offset:34816
    v_lshl_add_u32 v13, v2, 4, s22
    v_mfma_f32_16x16x32_bf16 v[212:215], v[128:131], v[140:143], v[212:215]
    ds_read_b128 v[88:91], v28 offset:36864
    v_lshlrev_b32 v13, 7, v13
    v_mfma_f32_16x16x32_bf16 v[188:191], v[124:127], v[140:143], v[188:191]
    s_cmp_ge_u32 s60, 2
    s_cselect_b64 vcc, -1, 0
    v_mfma_f32_16x16x32_bf16 v[164:167], v[120:123], v[140:143], v[164:167]
    buffer_load_dwordx4 v19, s[36:39], s62 offen offset:1024 lds
    v_mfma_f32_16x16x32_bf16 v[168:171], v[120:123], v[144:147], v[168:171]
    ds_read_b128 v[92:95], v28 offset:38912
    v_mfma_f32_16x16x32_bf16 v[192:195], v[124:127], v[144:147], v[192:195]
    ds_read_b128 v[100:103], v30 offset:55296
    v_mfma_f32_16x16x32_bf16 v[216:219], v[128:131], v[144:147], v[216:219]
    v_exp_f32 v76, v76
    v_mfma_f32_16x16x32_bf16 v[240:243], v[132:135], v[144:147], v[240:243]
    buffer_load_dwordx4 v20, s[36:39], s62 offen offset:2048 lds
    v_mfma_f32_16x16x32_bf16 v[244:247], v[132:135], v[148:151], v[244:247]
    ds_read_b128 v[104:107], v30 offset:51200
    v_fract_f32 v77, v77
    v_mfma_f32_16x16x32_bf16 v[220:223], v[128:131], v[148:151], v[220:223]
    ds_read_b128 v[108:111], v30 offset:57344
    v_mfma_f32_16x16x32_bf16 v[196:199], v[124:127], v[148:151], v[196:199]
    v_cos_f32 v64, v77
    v_mfma_f32_16x16x32_bf16 v[172:175], v[120:123], v[148:151], v[172:175]
    ds_read_b128 v[112:115], v30 offset:53248
    v_mfma_f32_16x16x32_bf16 v[176:179], v[120:123], v[152:155], v[176:179]
    buffer_load_dwordx4 v21, s[36:39], s62 offen offset:3072 lds
    v_mfma_f32_16x16x32_bf16 v[200:203], v[124:127], v[152:155], v[200:203]
    ds_read_b128 v[116:119], v30 offset:59392
    s_add_u32 m0, s65, 24576
    v_mfma_f32_16x16x32_bf16 v[224:227], v[128:131], v[152:155], v[224:227]
    s_mul_i32 s63, s61, s71
    v_sin_f32 v65, v77
    v_mfma_f32_16x16x32_bf16 v[248:251], v[132:135], v[152:155], v[248:251]
    v_cndmask_b32 v76, 0, v76, s[26:27]
    v_mul_f32 v64, v64, v76
    v_mfma_f32_16x16x32_bf16 v[252:255], v[132:135], v[156:159], v[252:255]
    buffer_load_dwordx4 v22, s[40:43], s63 offen offset:0 lds
    v_mfma_f32_16x16x32_bf16 v[228:231], v[128:131], v[156:159], v[228:231]
L_SA_pad1:
    s_cbranch_execz L_SA_pad5
    v_mul_f32 v65, v65, v76
    v_mul_f32 v76, v33, v33
    v_mfma_f32_16x16x32_bf16 v[204:207], v[124:127], v[156:159], v[204:207]
    v_fmac_f32 v76, v36, v36
    v_mfma_f32_16x16x32_bf16 v[180:183], v[120:123], v[156:159], v[180:183]
    s_waitcnt lgkmcnt(0)
    v_mfma_f32_16x16x32_bf16 v[160:163], v[80:83], v[96:99], v[160:163]
    ds_read_b128 v[136:139], v31 offset:49152
    v_cndmask_b32 v12, v12, v13, vcc
    v_mfma_f32_16x16x32_bf16 v[184:187], v[84:87], v[96:99], v[184:187]
    ds_read_b128 v[120:123], v29 offset:32768
    v_add_u32 v12, 32768, v12
    v_mfma_f32_16x16x32_bf16 v[208:211], v[88:91], v[96:99], v[208:211]
    buffer_load_dwordx4 v23, s[40:43], s63 offen offset:1024 lds
    v_mfma_f32_16x16x32_bf16 v[232:235], v[92:95], v[96:99], v[232:235]
    ds_read_b128 v[124:127], v29 offset:34816
    v_lshlrev_b32 v13, 2, v0
    v_mfma_f32_16x16x32_bf16 v[236:239], v[92:95], v[100:103], v[236:239]
    s_mul_i32 s67, s73, 1024
    s_add_u32 s67, s67, 155648
    v_add_u32 v13, s67, v13
    v_mfma_f32_16x16x32_bf16 v[212:215], v[88:91], v[100:103], v[212:215]
    ds_read_b128 v[128:131], v29 offset:36864
    v_mfma_f32_16x16x32_bf16 v[188:191], v[84:87], v[100:103], v[188:191]
    v_rcp_f32 v76, v76
    v_mfma_f32_16x16x32_bf16 v[164:167], v[80:83], v[100:103], v[164:167]
    buffer_load_dwordx4 v24, s[40:43], s63 offen offset:2048 lds
    v_mfma_f32_16x16x32_bf16 v[168:171], v[80:83], v[104:107], v[168:171]
    ds_read_b128 v[132:135], v29 offset:38912
    s_add_u32 m0, s65, 27648
    v_mfma_f32_16x16x32_bf16 v[192:195], v[84:87], v[104:107], v[192:195]
    ds_read_b128 v[140:143], v31 offset:55296
    s_add_u32 s61, s61, 1
    v_mfma_f32_16x16x32_bf16 v[216:219], v[88:91], v[104:107], v[216:219]
    v_add_f32 v77, -1.0, v64
    v_mul_f32 v66, v77, v33
    v_mfma_f32_16x16x32_bf16 v[240:243], v[92:95], v[104:107], v[240:243]
    buffer_load_dwordx4 v25, s[40:43], s63 offen offset:0 lds
    v_mfma_f32_16x16x32_bf16 v[244:247], v[92:95], v[108:111], v[244:247]
    ds_read_b128 v[144:147], v31 offset:51200
    v_mul_f32 v67, v65, v33
    v_mfma_f32_16x16x32_bf16 v[220:223], v[88:91], v[108:111], v[220:223]
    ds_read_b128 v[148:151], v31 offset:57344
    v_fmac_f32 v66, v65, v36
    v_mfma_f32_16x16x32_bf16 v[196:199], v[84:87], v[108:111], v[196:199]
    v_fma_f32 v67, -v77, v36, v67
    v_add_f32 v76, v76, v76
    v_mfma_f32_16x16x32_bf16 v[172:175], v[80:83], v[108:111], v[172:175]
    ds_read_b128 v[152:155], v31 offset:53248
    v_mul_f32 v66, v66, v76
    v_mfma_f32_16x16x32_bf16 v[176:179], v[80:83], v[112:115], v[176:179]
    buffer_load_dwordx4 v26, s[40:43], s63 offen offset:1024 lds
    v_mfma_f32_16x16x32_bf16 v[200:203], v[84:87], v[112:115], v[200:203]
    ds_read_b128 v[156:159], v31 offset:59392
    v_mul_f32 v67, v67, v76
    v_mfma_f32_16x16x32_bf16 v[224:227], v[88:91], v[112:115], v[224:227]
    s_cmp_eq_u32 s61, 10
    s_cselect_b32 s61, 0, s61
    v_lshlrev_b32 v40, 16, v40
    v_mfma_f32_16x16x32_bf16 v[248:251], v[92:95], v[112:115], v[248:251]
    v_mul_f32 v40, 0x3fb8aa3b, v40
    v_mfma_f32_16x16x32_bf16 v[252:255], v[92:95], v[116:119], v[252:255]
    buffer_load_dwordx4 v27, s[40:43], s63 offen offset:2048 lds
    v_mfma_f32_16x16x32_bf16 v[228:231], v[88:91], v[116:119], v[228:231]
    v_exp_f32 v40, v40
    v_mfma_f32_16x16x32_bf16 v[204:207], v[84:87], v[116:119], v[204:207]
    v_lshlrev_b32 v34, 16, v34
    v_lshlrev_b32 v37, 16, v37
    v_mfma_f32_16x16x32_bf16 v[180:183], v[80:83], v[116:119], v[180:183]
    s_waitcnt vmcnt(10) lgkmcnt(0)
    s_barrier
    v_mfma_f32_16x16x32_bf16 v[160:163], v[120:123], v[136:139], v[160:163]
    buffer_load_dwordx3 v[8:10], v12, s[44:47], 0 offen sc1
    v_mfma_f32_16x16x32_bf16 v[184:187], v[124:127], v[136:139], v[184:187]
    ds_read_b128 v[96:99], v30 offset:0
    s_add_u32 m0, s64, 32768
    v_mfma_f32_16x16x32_bf16 v[208:211], v[128:131], v[136:139], v[208:211]
    ds_read_b128 v[80:83], v28 offset:0
    s_lshl_b32 s62, s61, 7
    v_mfma_f32_16x16x32_bf16 v[232:235], v[132:135], v[136:139], v[232:235]
    buffer_load_dwordx4 v18, s[36:39], s62 offen offset:0 lds
    v_mfma_f32_16x16x32_bf16 v[236:239], v[132:135], v[140:143], v[236:239]
    ds_read_b128 v[84:87], v28 offset:2048
    v_cvt_pk_bf16_f32 v40, v40, v40
    v_mfma_f32_16x16x32_bf16 v[212:215], v[128:131], v[140:143], v[212:215]
    ds_read_b128 v[88:91], v28 offset:4096
    v_lshlrev_b32 v40, 16, v40
    v_mfma_f32_16x16x32_bf16 v[188:191], v[124:127], v[140:143], v[188:191]
    v_mul_f32 v74, v40, v34
    v_mul_f32 v75, v40, v37
    v_mfma_f32_16x16x32_bf16 v[164:167], v[120:123], v[140:143], v[164:167]
    buffer_load_dwordx4 v19, s[36:39], s62 offen offset:1024 lds
    v_mfma_f32_16x16x32_bf16 v[168:171], v[120:123], v[144:147], v[168:171]
    ds_read_b128 v[92:95], v28 offset:6144
    v_mul_f32 v74, 0x3fb8aa3b, v74
    v_mfma_f32_16x16x32_bf16 v[192:195], v[124:127], v[144:147], v[192:195]
    ds_read_b128 v[100:103], v30 offset:6144
    v_mul_f32 v75, 0x3e22f983, v75
    v_mfma_f32_16x16x32_bf16 v[216:219], v[128:131], v[144:147], v[216:219]
    v_mul_f32 v76, v53, v74
    v_mul_f32 v77, v53, v75
    v_mfma_f32_16x16x32_bf16 v[240:243], v[132:135], v[144:147], v[240:243]
    buffer_load_dwordx4 v20, s[36:39], s62 offen offset:2048 lds
    v_mfma_f32_16x16x32_bf16 v[244:247], v[132:135], v[148:151], v[244:247]
    ds_read_b128 v[104:107], v30 offset:2048
    v_mfma_f32_16x16x32_bf16 v[220:223], v[128:131], v[148:151], v[220:223]
    ds_read_b128 v[108:111], v30 offset:8192
    v_mfma_f32_16x16x32_bf16 v[196:199], v[124:127], v[148:151], v[196:199]
    v_exp_f32 v76, v76
    v_mfma_f32_16x16x32_bf16 v[172:175], v[120:123], v[148:151], v[172:175]
    ds_read_b128 v[112:115], v30 offset:4096
    v_fract_f32 v77, v77
    v_mfma_f32_16x16x32_bf16 v[176:179], v[120:123], v[152:155], v[176:179]
    buffer_load_dwordx4 v21, s[36:39], s62 offen offset:3072 lds
    v_mfma_f32_16x16x32_bf16 v[200:203], v[124:127], v[152:155], v[200:203]
    ds_read_b128 v[116:119], v30 offset:10240
    s_add_u32 m0, s65, 49152
    v_mfma_f32_16x16x32_bf16 v[224:227], v[128:131], v[152:155], v[224:227]
    s_mul_i32 s63, s61, s71
    v_cos_f32 v68, v77
    v_mfma_f32_16x16x32_bf16 v[248:251], v[132:135], v[152:155], v[248:251]
    v_sin_f32 v69, v77
    v_mfma_f32_16x16x32_bf16 v[252:255], v[132:135], v[156:159], v[252:255]
    buffer_load_dwordx4 v22, s[40:43], s63 offen offset:0 lds
    v_mfma_f32_16x16x32_bf16 v[228:231], v[128:131], v[156:159], v[228:231]
    v_mul_f32 v68, v68, v76
    v_mul_f32 v69, v69, v76
    v_mfma_f32_16x16x32_bf16 v[204:207], v[124:127], v[156:159], v[204:207]
    v_mul_f32 v76, v54, v74
    v_mul_f32 v77, v54, v75
    v_mfma_f32_16x16x32_bf16 v[180:183], v[120:123], v[156:159], v[180:183]
    s_waitcnt lgkmcnt(0)
    v_mfma_f32_16x16x32_bf16 v[160:163], v[80:83], v[96:99], v[160:163]
    ds_read_b128 v[136:139], v31 offset:0
    v_and_b32 v14, 7, v0
    v_mfma_f32_16x16x32_bf16 v[184:187], v[84:87], v[96:99], v[184:187]
    ds_read_b128 v[120:123], v29 offset:0
    v_lshlrev_b32 v14, 10, v14
    v_mfma_f32_16x16x32_bf16 v[208:211], v[88:91], v[96:99], v[208:211]
    buffer_load_dwordx4 v23, s[40:43], s63 offen offset:1024 lds
    v_mfma_f32_16x16x32_bf16 v[232:235], v[92:95], v[96:99], v[232:235]
    ds_read_b128 v[124:127], v29 offset:2048
    s_lshl_b32 s69, s60, 6
    v_mfma_f32_16x16x32_bf16 v[236:239], v[92:95], v[100:103], v[236:239]
    s_add_u32 s69, s69, s79
    s_lshl_b32 s69, s69, 7
    s_add_u32 s69, s69, 98304
    v_mfma_f32_16x16x32_bf16 v[212:215], v[88:91], v[100:103], v[212:215]
    ds_read_b128 v[128:131], v29 offset:4096
    s_mul_i32 s75, s22, 12288
    v_mfma_f32_16x16x32_bf16 v[188:191], v[84:87], v[100:103], v[188:191]
    s_add_u32 s75, s75, 163840
    s_lshl_b32 s68, s60, 11
    v_add_u32 v4, s68, v15
    v_mfma_f32_16x16x32_bf16 v[164:167], v[80:83], v[100:103], v[164:167]
    buffer_load_dwordx4 v24, s[40:43], s63 offen offset:2048 lds
    v_mfma_f32_16x16x32_bf16 v[168:171], v[80:83], v[104:107], v[168:171]
    ds_read_b128 v[132:135], v29 offset:6144
    s_add_u32 m0, s65, 52224
L_SA_pad2:
    s_cbranch_execz L_SA_pad6
    v_mfma_f32_16x16x32_bf16 v[192:195], v[84:87], v[104:107], v[192:195]
    ds_read_b128 v[140:143], v31 offset:6144
    s_add_u32 s61, s61, 1
    v_mfma_f32_16x16x32_bf16 v[216:219], v[88:91], v[104:107], v[216:219]
    s_add_u32 s68, s68, 122880
    v_add_u32 v5, 1536, v4
    v_lshrrev_b32 v5, 13, v5
    v_mfma_f32_16x16x32_bf16 v[240:243], v[92:95], v[104:107], v[240:243]
    buffer_load_dwordx4 v25, s[40:43], s63 offen offset:0 lds
    v_mfma_f32_16x16x32_bf16 v[244:247], v[92:95], v[108:111], v[244:247]
    ds_read_b128 v[144:147], v31 offset:2048
    v_lshl_add_u32 v5, v5, 26, v4
    v_mfma_f32_16x16x32_bf16 v[220:223], v[88:91], v[108:111], v[220:223]
    ds_read_b128 v[148:151], v31 offset:8192
    v_mfma_f32_16x16x32_bf16 v[196:199], v[84:87], v[108:111], v[196:199]
    v_exp_f32 v76, v76
    v_mfma_f32_16x16x32_bf16 v[172:175], v[80:83], v[108:111], v[172:175]
    ds_read_b128 v[152:155], v31 offset:4096
    v_fract_f32 v77, v77
    v_mfma_f32_16x16x32_bf16 v[176:179], v[80:83], v[112:115], v[176:179]
    buffer_load_dwordx4 v26, s[40:43], s63 offen offset:1024 lds
    v_mfma_f32_16x16x32_bf16 v[200:203], v[84:87], v[112:115], v[200:203]
    ds_read_b128 v[156:159], v31 offset:10240
    v_mfma_f32_16x16x32_bf16 v[224:227], v[88:91], v[112:115], v[224:227]
    s_cmp_eq_u32 s61, 10
    s_cselect_b32 s61, 0, s61
    v_mfma_f32_16x16x32_bf16 v[248:251], v[92:95], v[112:115], v[248:251]
    v_cos_f32 v70, v77
    v_mfma_f32_16x16x32_bf16 v[252:255], v[92:95], v[116:119], v[252:255]
    buffer_load_dwordx4 v27, s[40:43], s63 offen offset:2048 lds
    v_mfma_f32_16x16x32_bf16 v[228:231], v[88:91], v[116:119], v[228:231]
    v_sin_f32 v71, v77
    v_mfma_f32_16x16x32_bf16 v[204:207], v[84:87], v[116:119], v[204:207]
    v_cndmask_b32 v76, 0, v76, s[26:27]
    v_mul_f32 v70, v70, v76
    v_mfma_f32_16x16x32_bf16 v[180:183], v[80:83], v[116:119], v[180:183]
    s_waitcnt vmcnt(10)
    v_cmp_ne_u32 vcc, s66, v10
    s_cbranch_vccz L_S_f0_ok
    s_mov_b32 s25, 0
L_S_f0_retry:

    buffer_load_dwordx3 v[8:10], v12, s[44:47], 0 offen sc1
    s_add_u32 s25, s25, 1
    s_waitcnt vmcnt(0)
    v_cmp_ne_u32 vcc, s66, v10
    s_cmp_ge_u32 s25, 100000
    s_cbranch_scc1 L_S_f0_ok
    s_cbranch_vccnz L_S_f0_retry
L_S_f0_ok:
    s_waitcnt lgkmcnt(0)
    s_barrier
    v_mfma_f32_16x16x32_bf16 v[160:163], v[120:123], v[136:139], v[160:163]
    buffer_load_dword v11, v14, s[44:47], s69 offen sc1
    v_mfma_f32_16x16x32_bf16 v[184:187], v[124:127], v[136:139], v[184:187]
    ds_read_b128 v[96:99], v30 offset:24576
    s_mov_b32 m0, s68
    v_mfma_f32_16x16x32_bf16 v[208:211], v[128:131], v[136:139], v[208:211]
    buffer_load_dwordx4 v4, s[44:47], s75 offen offset:0 sc1 lds
    v_mfma_f32_16x16x32_bf16 v[232:235], v[132:135], v[136:139], v[232:235]
    ds_read_b128 v[80:83], v28 offset:16384
    s_add_u32 m0, s64, 0
    v_mfma_f32_16x16x32_bf16 v[236:239], v[132:135], v[140:143], v[236:239]
    ds_read_b128 v[84:87], v28 offset:18432
    s_lshl_b32 s62, s61, 7
    v_mfma_f32_16x16x32_bf16 v[212:215], v[128:131], v[140:143], v[212:215]
    ds_read_b128 v[88:91], v28 offset:20480
    v_mul_f32 v71, v71, v76
    v_mfma_f32_16x16x32_bf16 v[188:191], v[124:127], v[140:143], v[188:191]
    buffer_load_dwordx4 v18, s[36:39], s62 offen offset:0 lds
    v_mfma_f32_16x16x32_bf16 v[164:167], v[120:123], v[140:143], v[164:167]
    ds_read_b128 v[92:95], v28 offset:22528
    v_mul_f32 v76, v34, v34
    v_mfma_f32_16x16x32_bf16 v[168:171], v[120:123], v[144:147], v[168:171]
    v_fmac_f32 v76, v37, v37
    v_mfma_f32_16x16x32_bf16 v[192:195], v[124:127], v[144:147], v[192:195]
    buffer_load_dwordx4 v19, s[36:39], s62 offen offset:1024 lds
    v_mfma_f32_16x16x32_bf16 v[216:219], v[128:131], v[144:147], v[216:219]
    ds_read_b128 v[100:103], v30 offset:30720
    v_mfma_f32_16x16x32_bf16 v[240:243], v[132:135], v[144:147], v[240:243]
    ds_read_b128 v[104:107], v30 offset:26624
    v_mfma_f32_16x16x32_bf16 v[244:247], v[132:135], v[148:151], v[244:247]
    buffer_load_dwordx4 v20, s[36:39], s62 offen offset:2048 lds
    v_mfma_f32_16x16x32_bf16 v[220:223], v[128:131], v[148:151], v[220:223]
    ds_read_b128 v[108:111], v30 offset:32768
    v_mfma_f32_16x16x32_bf16 v[196:199], v[124:127], v[148:151], v[196:199]
    v_rcp_f32 v76, v76
    v_mfma_f32_16x16x32_bf16 v[172:175], v[120:123], v[148:151], v[172:175]
    buffer_load_dwordx4 v21, s[36:39], s62 offen offset:3072 lds
    v_mfma_f32_16x16x32_bf16 v[176:179], v[120:123], v[152:155], v[176:179]
    ds_read_b128 v[112:115], v30 offset:28672
    s_mov_b32 m0, s68
    v_mfma_f32_16x16x32_bf16 v[200:203], v[124:127], v[152:155], v[200:203]
    ds_read_b128 v[116:119], v30 offset:34816
    v_add_f32 v77, -1.0, v70
    v_mfma_f32_16x16x32_bf16 v[224:227], v[128:131], v[152:155], v[224:227]
    buffer_load_dwordx4 v5, s[44:47], s75 offen offset:1024 sc1 lds
    v_mfma_f32_16x16x32_bf16 v[248:251], v[132:135], v[152:155], v[248:251]
    s_add_u32 m0, s65, 0
    s_mul_i32 s63, s61, s71
    v_mul_f32 v72, v77, v34
    v_mfma_f32_16x16x32_bf16 v[252:255], v[132:135], v[156:159], v[252:255]
    v_mul_f32 v73, v71, v34
    v_fmac_f32 v72, v71, v37
    v_mfma_f32_16x16x32_bf16 v[228:231], v[128:131], v[156:159], v[228:231]
    buffer_load_dwordx4 v22, s[40:43], s63 offen offset:0 lds
    v_mfma_f32_16x16x32_bf16 v[204:207], v[124:127], v[156:159], v[204:207]
    v_fma_f32 v73, -v77, v37, v73
    v_add_f32 v76, v76, v76
    v_mfma_f32_16x16x32_bf16 v[180:183], v[120:123], v[156:159], v[180:183]
    v_mul_f32 v72, v72, v76
    s_waitcnt lgkmcnt(0)
    v_mfma_f32_16x16x32_bf16 v[160:163], v[80:83], v[96:99], v[160:163]
    ds_read_b128 v[136:139], v31 offset:24576
    v_mul_f32 v73, v73, v76
    v_mfma_f32_16x16x32_bf16 v[184:187], v[84:87], v[96:99], v[184:187]
    ds_read_b128 v[120:123], v29 offset:16384
    v_mfma_f32_16x16x32_bf16 v[208:211], v[88:91], v[96:99], v[208:211]
    buffer_load_dwordx4 v23, s[40:43], s63 offen offset:1024 lds
    v_mfma_f32_16x16x32_bf16 v[232:235], v[92:95], v[96:99], v[232:235]
    ds_read_b128 v[124:127], v29 offset:18432
    s_mul_i32 s5, s80, 1280
    v_mfma_f32_16x16x32_bf16 v[236:239], v[92:95], v[100:103], v[236:239]
    s_mul_i32 s24, s79, 160
    s_add_u32 s5, s5, s24
    s_mul_i32 s24, s60, 3072
L_SA_pad3:
    s_cbranch_execz L_SA_pad7
    v_mfma_f32_16x16x32_bf16 v[212:215], v[88:91], v[100:103], v[212:215]
    ds_read_b128 v[128:131], v29 offset:20480
    s_add_u32 s24, s24, 131072
    v_mfma_f32_16x16x32_bf16 v[188:191], v[84:87], v[100:103], v[188:191]
    v_add_u32 v21, 0, v1
    v_min_u32 v21, 159, v21
    v_mfma_f32_16x16x32_bf16 v[164:167], v[80:83], v[100:103], v[164:167]
    buffer_load_dwordx4 v24, s[40:43], s63 offen offset:2048 lds
    v_mfma_f32_16x16x32_bf16 v[168:171], v[80:83], v[104:107], v[168:171]
    ds_read_b128 v[132:135], v29 offset:22528
    s_add_u32 m0, s65, 3072
    v_mfma_f32_16x16x32_bf16 v[192:195], v[84:87], v[104:107], v[192:195]
    ds_read_b128 v[140:143], v31 offset:30720
    s_add_u32 s61, s61, 1
    v_mfma_f32_16x16x32_bf16 v[216:219], v[88:91], v[104:107], v[216:219]
    v_mul_u32_u24 v21, 6554, v21
    v_lshrrev_b32 v21, 16, v21
    v_mfma_f32_16x16x32_bf16 v[240:243], v[92:95], v[104:107], v[240:243]
    buffer_load_dwordx4 v25, s[40:43], s63 offen offset:0 lds
    v_mfma_f32_16x16x32_bf16 v[244:247], v[92:95], v[108:111], v[244:247]
    ds_read_b128 v[144:147], v31 offset:26624
    v_mfma_f32_16x16x32_bf16 v[220:223], v[88:91], v[108:111], v[220:223]
    ds_read_b128 v[148:151], v31 offset:32768
    v_mfma_f32_16x16x32_bf16 v[196:199], v[84:87], v[108:111], v[196:199]
    v_mfma_f32_16x16x32_bf16 v[172:175], v[80:83], v[108:111], v[172:175]
    ds_read_b128 v[152:155], v31 offset:28672
    v_mfma_f32_16x16x32_bf16 v[176:179], v[80:83], v[112:115], v[176:179]
    buffer_load_dwordx4 v26, s[40:43], s63 offen offset:1024 lds
    v_mfma_f32_16x16x32_bf16 v[200:203], v[84:87], v[112:115], v[200:203]
    ds_read_b128 v[156:159], v31 offset:34816
    v_mfma_f32_16x16x32_bf16 v[224:227], v[88:91], v[112:115], v[224:227]
    v_mfma_f32_16x16x32_bf16 v[248:251], v[92:95], v[112:115], v[248:251]
    v_mfma_f32_16x16x32_bf16 v[252:255], v[92:95], v[116:119], v[252:255]
    buffer_load_dwordx4 v27, s[40:43], s63 offen offset:2048 lds
    v_mfma_f32_16x16x32_bf16 v[228:231], v[88:91], v[116:119], v[228:231]
    v_mfma_f32_16x16x32_bf16 v[204:207], v[84:87], v[116:119], v[204:207]
    v_mfma_f32_16x16x32_bf16 v[180:183], v[80:83], v[116:119], v[180:183]
    s_waitcnt vmcnt(12)
    v_cmp_ne_u32 vcc, s66, v11
    s_cbranch_vccz L_S_fw_ok
    s_mov_b32 s25, 0
L_S_fw_retry:

    buffer_load_dword v11, v14, s[44:47], s69 offen sc1
    s_add_u32 s25, s25, 1
    s_waitcnt vmcnt(0)
    v_cmp_ne_u32 vcc, s66, v11
    s_cmp_ge_u32 s25, 100000
    s_cbranch_scc1 L_S_fw_ok
    s_cbranch_vccnz L_S_fw_retry
L_S_fw_ok:
    s_waitcnt lgkmcnt(0)
    s_barrier
    v_mfma_f32_16x16x32_bf16 v[160:163], v[120:123], v[136:139], v[160:163]
    ds_read_b128 v[96:99], v30 offset:49152
    v_mfma_f32_16x16x32_bf16 v[184:187], v[124:127], v[136:139], v[184:187]
    ds_read_b128 v[80:83], v28 offset:32768
    s_add_u32 s81, s76, 0
    v_mfma_f32_16x16x32_bf16 v[208:211], v[128:131], v[136:139], v[208:211]
    buffer_load_dwordx4 a[0:3], v15, s[44:47], s81 offen offset:0 sc1
    v_mfma_f32_16x16x32_bf16 v[232:235], v[132:135], v[136:139], v[232:235]
    ds_read_b128 v[84:87], v28 offset:34816
    v_mul_u32_u24 v18, 1120, v21
    v_mfma_f32_16x16x32_bf16 v[236:239], v[132:135], v[140:143], v[236:239]
    v_lshrrev_b32 v21, 2, v21
    v_mul_u32_u24 v21, 15360, v21
    v_mfma_f32_16x16x32_bf16 v[212:215], v[128:131], v[140:143], v[212:215]
    ds_read_b128 v[88:91], v28 offset:36864
    v_add3_u32 v18, v18, v21, v15
    v_mfma_f32_16x16x32_bf16 v[188:191], v[124:127], v[140:143], v[188:191]
    buffer_load_dwordx4 a[4:7], v15, s[44:47], s81 offen offset:1024 sc1
    v_mfma_f32_16x16x32_bf16 v[164:167], v[120:123], v[140:143], v[164:167]
    ds_read_b128 v[92:95], v28 offset:38912
    v_add_u32 v21, 64, v1
    v_mfma_f32_16x16x32_bf16 v[168:171], v[120:123], v[144:147], v[168:171]
    v_min_u32 v21, 159, v21
    v_mul_u32_u24 v21, 6554, v21
    v_mfma_f32_16x16x32_bf16 v[192:195], v[124:127], v[144:147], v[192:195]
    buffer_load_dwordx4 a[8:11], v15, s[44:47], s81 offen offset:2048 sc1
    v_mfma_f32_16x16x32_bf16 v[216:219], v[128:131], v[144:147], v[216:219]
    ds_read_b128 v[100:103], v30 offset:55296
    v_lshrrev_b32 v21, 16, v21
    v_mfma_f32_16x16x32_bf16 v[240:243], v[132:135], v[144:147], v[240:243]
    ds_read_b128 v[104:107], v30 offset:51200
    v_mul_u32_u24 v19, 1120, v21
    v_mfma_f32_16x16x32_bf16 v[244:247], v[132:135], v[148:151], v[244:247]
    buffer_load_dwordx4 a[12:15], v15, s[44:47], s81 offen offset:3072 sc1
    v_mfma_f32_16x16x32_bf16 v[220:223], v[128:131], v[148:151], v[220:223]
    ds_read_b128 v[108:111], v30 offset:57344
    s_add_u32 s81, s81, 4096
    v_mfma_f32_16x16x32_bf16 v[196:199], v[124:127], v[148:151], v[196:199]
    v_lshrrev_b32 v21, 2, v21
    v_mfma_f32_16x16x32_bf16 v[172:175], v[120:123], v[148:151], v[172:175]
    buffer_load_dwordx4 a[16:19], v15, s[44:47], s81 offen offset:0 sc1
    v_mfma_f32_16x16x32_bf16 v[176:179], v[120:123], v[152:155], v[176:179]
    ds_read_b128 v[112:115], v30 offset:53248
    s_add_u32 s81, s76, 20480
    v_mfma_f32_16x16x32_bf16 v[200:203], v[124:127], v[152:155], v[200:203]
    ds_read_b128 v[116:119], v30 offset:59392
    v_mfma_f32_16x16x32_bf16 v[224:227], v[128:131], v[152:155], v[224:227]
    buffer_load_dwordx4 a[20:23], v15, s[44:47], s81 offen offset:0 sc1
    v_mfma_f32_16x16x32_bf16 v[248:251], v[132:135], v[152:155], v[248:251]
    v_mfma_f32_16x16x32_bf16 v[252:255], v[132:135], v[156:159], v[252:255]
    v_mfma_f32_16x16x32_bf16 v[228:231], v[128:131], v[156:159], v[228:231]
    buffer_load_dwordx4 a[24:27], v15, s[44:47], s81 offen offset:1024 sc1
    v_mfma_f32_16x16x32_bf16 v[204:207], v[124:127], v[156:159], v[204:207]
    v_mfma_f32_16x16x32_bf16 v[180:183], v[120:123], v[156:159], v[180:183]
    s_waitcnt lgkmcnt(0)
    v_mfma_f32_16x16x32_bf16 v[160:163], v[80:83], v[96:99], v[160:163]
    ds_read_b128 v[136:139], v31 offset:49152
    s_mul_i32 s68, s74, 384
    v_mfma_f32_16x16x32_bf16 v[184:187], v[84:87], v[96:99], v[184:187]
    ds_read_b128 v[120:123], v29 offset:32768
    s_add_u32 s68, s68, 122880
    v_mfma_f32_16x16x32_bf16 v[208:211], v[88:91], v[96:99], v[208:211]
    buffer_load_dwordx4 a[28:31], v15, s[44:47], s81 offen offset:2048 sc1
    v_mfma_f32_16x16x32_bf16 v[232:235], v[92:95], v[96:99], v[232:235]
    ds_read_b128 v[124:127], v29 offset:34816
    v_mul_u32_u24 v5, 768, v3
    v_mfma_f32_16x16x32_bf16 v[236:239], v[92:95], v[100:103], v[236:239]
    v_add_u32 v5, s68, v5
    v_add_u32 v7, 6144, v5
    v_mfma_f32_16x16x32_bf16 v[212:215], v[88:91], v[100:103], v[212:215]
    ds_read_b128 v[128:131], v29 offset:36864
    v_min_u32 v7, 130560, v7
    v_mfma_f32_16x16x32_bf16 v[188:191], v[84:87], v[100:103], v[188:191]
    buffer_load_dwordx4 a[32:35], v15, s[44:47], s81 offen offset:3072 sc1
    v_mfma_f32_16x16x32_bf16 v[164:167], v[80:83], v[100:103], v[164:167]
    ds_read_b128 v[132:135], v29 offset:38912
    s_add_u32 s81, s81, 4096
    v_mfma_f32_16x16x32_bf16 v[168:171], v[80:83], v[104:107], v[168:171]
    v_lshl_add_u32 v4, v2, 4, v5
    v_lshl_add_u32 v5, v2, 3, v5
    v_mfma_f32_16x16x32_bf16 v[192:195], v[84:87], v[104:107], v[192:195]
    buffer_load_dwordx4 a[36:39], v15, s[44:47], s81 offen offset:0 sc1
    v_mfma_f32_16x16x32_bf16 v[216:219], v[88:91], v[104:107], v[216:219]
    ds_read_b128 v[140:143], v31 offset:55296
    s_add_u32 s81, s76, 40960
    v_mfma_f32_16x16x32_bf16 v[240:243], v[92:95], v[104:107], v[240:243]
    ds_read_b128 v[144:147], v31 offset:51200
    v_lshl_add_u32 v6, v2, 4, v7
    v_mfma_f32_16x16x32_bf16 v[244:247], v[92:95], v[108:111], v[244:247]
    buffer_load_dwordx4 a[40:43], v15, s[44:47], s81 offen offset:0 sc1
    v_mfma_f32_16x16x32_bf16 v[220:223], v[88:91], v[108:111], v[220:223]
    ds_read_b128 v[148:151], v31 offset:57344
    v_lshl_add_u32 v7, v2, 3, v7
    v_mfma_f32_16x16x32_bf16 v[196:199], v[84:87], v[108:111], v[196:199]
    s_mul_i32 s61, s60, 30720
    v_mul_u32_u24 v21, 15360, v21
L_SA_pad4:
    s_cbranch_execz L_SA_pad8
    v_add3_u32 v19, v19, v21, v15
    v_mfma_f32_16x16x32_bf16 v[172:175], v[80:83], v[108:111], v[172:175]
    buffer_load_dwordx4 a[44:47], v15, s[44:47], s81 offen offset:1024 sc1
    v_mfma_f32_16x16x32_bf16 v[176:179], v[80:83], v[112:115], v[176:179]
    ds_read_b128 v[152:155], v31 offset:53248
    v_add_u32 v21, 128, v1
    v_mfma_f32_16x16x32_bf16 v[200:203], v[84:87], v[112:115], v[200:203]
    ds_read_b128 v[156:159], v31 offset:59392
    v_min_u32 v21, 159, v21
    v_mfma_f32_16x16x32_bf16 v[224:227], v[88:91], v[112:115], v[224:227]
    buffer_load_dwordx4 a[48:51], v15, s[44:47], s81 offen offset:2048 sc1
    v_mfma_f32_16x16x32_bf16 v[248:251], v[92:95], v[112:115], v[248:251]
    v_mul_u32_u24 v21, 6554, v21
    v_lshrrev_b32 v21, 16, v21
    v_mfma_f32_16x16x32_bf16 v[252:255], v[92:95], v[116:119], v[252:255]
    v_mul_u32_u24 v20, 1120, v21
    v_lshrrev_b32 v21, 2, v21
    v_mfma_f32_16x16x32_bf16 v[228:231], v[88:91], v[116:119], v[228:231]
    buffer_load_dwordx4 a[52:55], v15, s[44:47], s81 offen offset:3072 sc1
    v_mfma_f32_16x16x32_bf16 v[204:207], v[84:87], v[116:119], v[204:207]
    v_mul_u32_u24 v21, 15360, v21
    v_add3_u32 v20, v20, v21, v15
    v_mfma_f32_16x16x32_bf16 v[180:183], v[80:83], v[116:119], v[180:183]
    s_waitcnt vmcnt(14) lgkmcnt(0)
    s_barrier
    v_mfma_f32_16x16x32_bf16 v[160:163], v[120:123], v[136:139], v[160:163]
    ds_read_b128 v[32:35], v4 offset:0
    v_mfma_f32_16x16x32_bf16 v[184:187], v[124:127], v[136:139], v[184:187]
    ds_read_b128 v[96:99], v30 offset:0
    ds_read_b128 v[80:83], v28 offset:0
    v_mfma_f32_16x16x32_bf16 v[208:211], v[128:131], v[136:139], v[208:211]
    s_add_u32 s81, s81, 4096
    v_mfma_f32_16x16x32_bf16 v[232:235], v[132:135], v[136:139], v[232:235]
    buffer_load_dwordx4 a[56:59], v15, s[44:47], s81 offen offset:0 sc1
    v_mfma_f32_16x16x32_bf16 v[236:239], v[132:135], v[140:143], v[236:239]
    ds_read_b64 v[36:37], v5 offset:256
    s_add_u32 s81, s76, 61440
    v_mfma_f32_16x16x32_bf16 v[212:215], v[128:131], v[140:143], v[212:215]
    ds_write_b64 v50, v[56:57] offset:0
    v_mfma_f32_16x16x32_bf16 v[188:191], v[124:127], v[140:143], v[188:191]
    buffer_load_dwordx4 a[60:63], v15, s[44:47], s81 offen offset:0 sc1
    v_mfma_f32_16x16x32_bf16 v[164:167], v[120:123], v[140:143], v[164:167]
    ds_read_b128 v[38:41], v4 offset:3072
    v_mfma_f32_16x16x32_bf16 v[168:171], v[120:123], v[144:147], v[168:171]
    ds_read_b128 v[84:87], v28 offset:2048
    ds_read_b128 v[88:91], v28 offset:4096
    v_mfma_f32_16x16x32_bf16 v[192:195], v[124:127], v[144:147], v[192:195]
    ds_write_b64 v52, v[58:59] offset:0
    v_mfma_f32_16x16x32_bf16 v[216:219], v[128:131], v[144:147], v[216:219]
    buffer_load_dwordx4 a[64:67], v15, s[44:47], s81 offen offset:1024 sc1
    v_mfma_f32_16x16x32_bf16 v[240:243], v[132:135], v[144:147], v[240:243]
    ds_read_b64 v[42:43], v5 offset:3328
    v_mfma_f32_16x16x32_bf16 v[244:247], v[132:135], v[148:151], v[244:247]
    buffer_load_dwordx4 a[68:71], v15, s[44:47], s81 offen offset:2048 sc1
    v_mfma_f32_16x16x32_bf16 v[220:223], v[128:131], v[148:151], v[220:223]
    ds_write_b64 v51, v[60:61] offset:0
    v_mfma_f32_16x16x32_bf16 v[196:199], v[124:127], v[148:151], v[196:199]
    ds_read_b128 v[44:47], v6 offset:0
    v_mfma_f32_16x16x32_bf16 v[172:175], v[120:123], v[148:151], v[172:175]
    buffer_load_dwordx4 a[72:75], v15, s[44:47], s81 offen offset:3072 sc1
    v_mfma_f32_16x16x32_bf16 v[176:179], v[120:123], v[152:155], v[176:179]
    ds_read_b128 v[92:95], v28 offset:6144
    ds_read_b128 v[100:103], v30 offset:6144
    v_mfma_f32_16x16x32_bf16 v[200:203], v[124:127], v[152:155], v[200:203]
    ds_write_b64 v50, v[62:63] offset:128
    v_mfma_f32_16x16x32_bf16 v[224:227], v[128:131], v[152:155], v[224:227]
    ds_read_b128 v[104:107], v30 offset:2048
    ds_read_b128 v[108:111], v30 offset:8192
    v_mfma_f32_16x16x32_bf16 v[248:251], v[132:135], v[152:155], v[248:251]
    ds_read_b128 v[112:115], v30 offset:4096
    ds_read_b128 v[116:119], v30 offset:10240
    v_mfma_f32_16x16x32_bf16 v[252:255], v[132:135], v[156:159], v[252:255]
    ds_read_b64 v[48:49], v7 offset:256
    s_add_u32 s81, s81, 4096
    v_mfma_f32_16x16x32_bf16 v[228:231], v[128:131], v[156:159], v[228:231]
    buffer_load_dwordx4 a[76:79], v15, s[44:47], s81 offen offset:0 sc1
    v_mfma_f32_16x16x32_bf16 v[204:207], v[124:127], v[156:159], v[204:207]
    s_add_u32 s81, s76, 81920
    s_lshl_b32 s67, s73, 8
    s_add_u32 s67, s67, 155648
    v_mfma_f32_16x16x32_bf16 v[180:183], v[120:123], v[156:159], v[180:183]
    v_lshl_add_u32 v6, v3, 6, s67
    buffer_load_dwordx4 a[80:83], v15, s[44:47], s81 offen offset:0 sc1
    s_mul_i32 s68, s74, 384
    s_add_u32 s68, s68, 143360
    v_lshl_add_u32 v7, v2, 3, s68
    v_sub_u32 v5, 12, v3
    v_cmp_eq_u32 vcc, 3, v3
    v_mul_u32_u24 v5, 768, v5
    s_nop 0
    v_cndmask_b32 v5, v5, 0, vcc
    v_add_u32 v5, v5, v7
    s_waitcnt lgkmcnt(0)
    v_mfma_f32_16x16x32_bf16 v[160:163], v[80:83], v[96:99], v[160:163]
    ds_read_b128 v[136:139], v31 offset:0
    ds_read_b128 v[120:123], v29 offset:0
    v_mfma_f32_16x16x32_bf16 v[184:187], v[84:87], v[96:99], v[184:187]
    v_add_f32 v32, v32, v38
    v_add_f32 v33, v33, v39
    v_mfma_f32_16x16x32_bf16 v[208:211], v[88:91], v[96:99], v[208:211]
    buffer_load_dwordx4 a[84:87], v15, s[44:47], s81 offen offset:1024 sc1
    v_mfma_f32_16x16x32_bf16 v[232:235], v[92:95], v[96:99], v[232:235]
    ds_read_b128 v[124:127], v29 offset:2048
    ds_read_b128 v[128:131], v29 offset:4096
    v_mfma_f32_16x16x32_bf16 v[236:239], v[92:95], v[100:103], v[236:239]
    ds_write_b64 v52, v[64:65] offset:128
    v_mfma_f32_16x16x32_bf16 v[212:215], v[88:91], v[100:103], v[212:215]
    v_add_f32 v34, v34, v40
    v_add_f32 v35, v35, v41
    v_mfma_f32_16x16x32_bf16 v[188:191], v[84:87], v[100:103], v[188:191]
    buffer_load_dwordx4 a[88:91], v15, s[44:47], s81 offen offset:2048 sc1
    v_mfma_f32_16x16x32_bf16 v[164:167], v[80:83], v[100:103], v[164:167]
    ds_write_b64 v51, v[66:67] offset:128
    v_mfma_f32_16x16x32_bf16 v[168:171], v[80:83], v[104:107], v[168:171]
    ds_read_b128 v[132:135], v29 offset:6144
    ds_read_b128 v[140:143], v31 offset:6144
    v_mfma_f32_16x16x32_bf16 v[192:195], v[84:87], v[104:107], v[192:195]
    buffer_load_dwordx4 a[92:95], v15, s[44:47], s81 offen offset:3072 sc1
    v_mfma_f32_16x16x32_bf16 v[216:219], v[88:91], v[104:107], v[216:219]
    ds_write_b64 v50, v[68:69] offset:256
    v_mfma_f32_16x16x32_bf16 v[240:243], v[92:95], v[104:107], v[240:243]
    ds_read_b128 v[144:147], v31 offset:2048
    ds_read_b128 v[148:151], v31 offset:8192
    v_mfma_f32_16x16x32_bf16 v[244:247], v[92:95], v[108:111], v[244:247]
    s_add_u32 s81, s81, 4096
    v_add_f32 v36, v36, v42
    v_add_f32 v37, v37, v43
    v_mfma_f32_16x16x32_bf16 v[220:223], v[88:91], v[108:111], v[220:223]
    buffer_load_dwordx4 a[96:99], v15, s[44:47], s81 offen offset:0 sc1
    v_mfma_f32_16x16x32_bf16 v[196:199], v[84:87], v[108:111], v[196:199]
    ds_write_b64 v52, v[70:71] offset:256
    v_mfma_f32_16x16x32_bf16 v[172:175], v[80:83], v[108:111], v[172:175]
    ds_read_b128 v[152:155], v31 offset:4096
    ds_read_b128 v[156:159], v31 offset:10240
    v_mfma_f32_16x16x32_bf16 v[176:179], v[80:83], v[112:115], v[176:179]
    ds_write_b64 v51, v[72:73] offset:256
    v_mfma_f32_16x16x32_bf16 v[200:203], v[84:87], v[112:115], v[200:203]
    s_add_u32 s81, s76, 102400
    v_add_f32 v32, v32, v44
    v_add_f32 v33, v33, v45
    v_mfma_f32_16x16x32_bf16 v[224:227], v[88:91], v[112:115], v[224:227]
    buffer_load_dwordx4 a[100:103], v15, s[44:47], s81 offen offset:0 sc1
    v_mfma_f32_16x16x32_bf16 v[248:251], v[92:95], v[112:115], v[248:251]
    buffer_load_dwordx4 a[104:107], v15, s[44:47], s81 offen offset:1024 sc1
    v_mfma_f32_16x16x32_bf16 v[252:255], v[92:95], v[116:119], v[252:255]
L_SA_pad5:
    s_cbranch_execz L_SA_pad9
    ds_write2_b32 v13, v8, v9 offset0:0 offset1:128
    v_mfma_f32_16x16x32_bf16 v[228:231], v[88:91], v[116:119], v[228:231]
    buffer_load_dwordx4 a[108:111], v15, s[44:47], s81 offen offset:2048 sc1
    v_mfma_f32_16x16x32_bf16 v[204:207], v[84:87], v[116:119], v[204:207]
    v_add_f32 v34, v34, v46
    v_add_f32 v35, v35, v47
    v_mfma_f32_16x16x32_bf16 v[180:183], v[80:83], v[116:119], v[180:183]
    v_add_f32 v36, v36, v48
    v_add_f32 v37, v37, v49
    v_and_b32 v12, 0xffff0000, v32
    v_sub_f32 v32, v32, v12
    v_cvt_pk_bf16_f32 v32, v12, v32
    v_and_b32 v12, 0xffff0000, v33
    v_sub_f32 v33, v33, v12
    v_cvt_pk_bf16_f32 v33, v12, v33
    v_and_b32 v12, 0xffff0000, v34
    v_sub_f32 v34, v34, v12
    v_cvt_pk_bf16_f32 v34, v12, v34
    v_and_b32 v12, 0xffff0000, v35
    v_sub_f32 v35, v35, v12
    v_cvt_pk_bf16_f32 v35, v12, v35
    v_and_b32 v12, 0xffff0000, v36
    v_sub_f32 v36, v36, v12
    v_cvt_pk_bf16_f32 v36, v12, v36
    v_and_b32 v12, 0xffff0000, v37
    v_sub_f32 v37, v37, v12
    v_cvt_pk_bf16_f32 v37, v12, v37
    s_waitcnt lgkmcnt(0)
    s_barrier
    v_mfma_f32_16x16x32_bf16 v[160:163], v[120:123], v[136:139], v[160:163]
    ds_read_b128 v[96:99], v6 offset:512
    v_mfma_f32_16x16x32_bf16 v[184:187], v[124:127], v[136:139], v[184:187]
    ds_read_b128 v[80:83], v6 offset:0
    s_mov_b32 m0, s24
    v_mfma_f32_16x16x16_bf16 v[56:59], a[244:245], v[32:33], 0
    buffer_load_dwordx4 v18, s[36:39], s5 offen offset:0 lds
    v_mfma_f32_16x16x32_bf16 v[208:211], v[128:131], v[136:139], v[208:211]
    ds_read_b128 v[100:103], v6 offset:528
    v_mfma_f32_16x16x32_bf16 v[232:235], v[132:135], v[136:139], v[232:235]
    buffer_load_dwordx4 a[112:115], v15, s[44:47], s81 offen offset:3072 sc1
    v_mfma_f32_16x16x16_bf16 v[60:63], a[246:247], v[32:33], 0
    ds_read_b128 v[84:87], v6 offset:16
    s_add_u32 s81, s81, 4096
    v_mfma_f32_16x16x32_bf16 v[236:239], v[132:135], v[140:143], v[236:239]
    ds_read_b128 v[104:107], v6 offset:544
    v_mfma_f32_16x16x32_bf16 v[212:215], v[128:131], v[140:143], v[212:215]
    ds_read_b128 v[88:91], v6 offset:32
    v_mfma_f32_16x16x16_bf16 v[64:67], a[244:245], v[34:35], 0
    ds_read_b128 v[108:111], v6 offset:560
    v_mfma_f32_16x16x32_bf16 v[188:191], v[124:127], v[140:143], v[188:191]
    v_mfma_f32_16x16x32_bf16 v[164:167], v[120:123], v[140:143], v[164:167]
    ds_read_b128 v[92:95], v6 offset:48
    v_mfma_f32_16x16x16_bf16 v[68:71], a[246:247], v[34:35], 0
    buffer_load_dwordx4 a[116:119], v15, s[44:47], s81 offen offset:0 sc1
    v_mfma_f32_16x16x32_bf16 v[168:171], v[120:123], v[144:147], v[168:171]
    buffer_load_dwordx4 v19, s[36:39], s5 offen offset:1024 lds
    v_mfma_f32_16x16x32_bf16 v[192:195], v[124:127], v[144:147], v[192:195]
    ds_read_b64 v[112:113], v7 offset:6912
    s_add_u32 s81, s76, 122880
    v_mfma_f32_16x16x16_bf16 v[72:75], a[244:245], v[36:37], 0
    ds_read_b64 v[38:39], v7 offset:6144
    v_mfma_f32_16x16x32_bf16 v[216:219], v[128:131], v[144:147], v[216:219]
    ds_read_b64 v[44:45], v5 offset:0
    v_mfma_f32_16x16x32_bf16 v[240:243], v[132:135], v[144:147], v[240:243]
    ds_read_b64 v[114:115], v7 offset:7040
    v_mfma_f32_16x16x16_bf16 v[76:79], a[246:247], v[36:37], 0
    buffer_load_dwordx4 a[120:123], v15, s[44:47], s81 offen offset:0 sc1
    v_mfma_f32_16x16x32_bf16 v[244:247], v[132:135], v[148:151], v[244:247]
    ds_read_b64 v[40:41], v7 offset:6272
    v_mfma_f32_16x16x32_bf16 v[220:223], v[128:131], v[148:151], v[220:223]
    ds_read_b64 v[46:47], v5 offset:128
    v_mfma_f32_16x16x32_bf16 v[196:199], v[124:127], v[148:151], v[196:199]
    ds_read_b64 v[116:117], v7 offset:7168
    v_mfma_f32_16x16x32_bf16 v[172:175], v[120:123], v[148:151], v[172:175]
    buffer_load_dwordx4 v20, s[36:39], s5 offen offset:2048 lds
    v_mfma_f32_16x16x32_bf16 v[176:179], v[120:123], v[152:155], v[176:179]
    ds_read_b64 v[42:43], v7 offset:6400
    v_mfma_f32_16x16x32_bf16 v[200:203], v[124:127], v[152:155], v[200:203]
    ds_read_b64 v[48:49], v5 offset:256
    v_mfma_f32_16x16x32_bf16 v[224:227], v[128:131], v[152:155], v[224:227]
    buffer_load_dwordx4 a[124:127], v15, s[44:47], s81 offen offset:1024 sc1
    v_mfma_f32_16x16x32_bf16 v[248:251], v[132:135], v[152:155], v[248:251]
    v_mfma_f32_16x16x32_bf16 v[252:255], v[132:135], v[156:159], v[252:255]
    v_mfma_f32_16x16x32_bf16 v[228:231], v[128:131], v[156:159], v[228:231]
    v_mfma_f32_16x16x32_bf16 v[204:207], v[124:127], v[156:159], v[204:207]
    v_mfma_f32_16x16x32_bf16 v[180:183], v[120:123], v[156:159], v[180:183]
    v_mov_b32 v131, s66
    v_and_b32 v5, 1, v3
    v_lshlrev_b32 v5, 26, v5
    v_lshl_add_u32 v5, v2, 4, v5
    v_lshl_add_u32 v5, v3, 7, v5
    s_sub_u32 s67, s22, 9
    s_lshl1_add_u32 s67, s67, s74
    s_lshl_b32 s67, s67, 9
    s_add_u32 s67, s67, 393216
    s_lshl_b32 s68, s3, 1
    s_waitcnt lgkmcnt(15)
    s_nop 0
    v_pk_mul_f32 v[18:19], v[96:97], v[56:57]
    v_pk_fma_f32 v[160:161], v[80:81], v[160:161], v[18:19] neg_lo:[0,0,1] neg_hi:[0,0,1]
    v_pk_mul_f32 v[18:19], v[96:97], v[60:61]
    v_pk_fma_f32 v[164:165], v[80:81], v[164:165], v[18:19] neg_lo:[0,0,1] neg_hi:[0,0,1]
    v_pk_mul_f32 v[18:19], v[98:99], v[56:57]
    v_pk_fma_f32 v[162:163], v[82:83], v[162:163], v[18:19] neg_lo:[0,0,1] neg_hi:[0,0,1]
    v_pk_mul_f32 v[18:19], v[98:99], v[60:61]
    v_pk_fma_f32 v[166:167], v[82:83], v[166:167], v[18:19] neg_lo:[0,0,1] neg_hi:[0,0,1]
    s_waitcnt lgkmcnt(8)
    s_nop 0
    v_pk_fma_f32 v[28:29], v[112:113], v[164:165], v[162:163] op_sel:[1,0,0] op_sel_hi:[1,1,1] neg_lo:[1,0,0] neg_hi:[1,0,0]
    v_pk_fma_f32 v[30:31], v[112:113], v[160:161], v[166:167] op_sel:[1,0,0] op_sel_hi:[1,1,1]
    v_pk_fma_f32 v[20:21], v[112:113], v[160:161], v[28:29] op_sel:[0,0,0] op_sel_hi:[0,1,1]
    v_pk_fma_f32 v[22:23], v[112:113], v[164:165], v[30:31] op_sel:[0,0,0] op_sel_hi:[0,1,1]
    v_pk_mul_f32 v[18:19], v[100:101], v[56:57]
    v_pk_fma_f32 v[184:185], v[84:85], v[184:185], v[18:19] neg_lo:[0,0,1] neg_hi:[0,0,1]
    v_pk_mul_f32 v[18:19], v[100:101], v[60:61]
    v_pk_fma_f32 v[188:189], v[84:85], v[188:189], v[18:19] neg_lo:[0,0,1] neg_hi:[0,0,1]
    v_pk_fma_f32 v[28:29], v[112:113], v[22:23], v[184:185] op_sel:[1,0,0] op_sel_hi:[1,1,1] neg_lo:[1,0,0] neg_hi:[1,0,0]
    v_pk_fma_f32 v[30:31], v[112:113], v[20:21], v[188:189] op_sel:[1,0,0] op_sel_hi:[1,1,1]
    v_pk_fma_f32 v[20:21], v[112:113], v[20:21], v[28:29] op_sel:[0,0,0] op_sel_hi:[0,1,1]
    v_pk_fma_f32 v[22:23], v[112:113], v[22:23], v[30:31] op_sel:[0,0,0] op_sel_hi:[0,1,1]
    v_pk_mul_f32 v[18:19], v[102:103], v[56:57]
    v_pk_fma_f32 v[186:187], v[86:87], v[186:187], v[18:19] neg_lo:[0,0,1] neg_hi:[0,0,1]
    v_pk_mul_f32 v[18:19], v[102:103], v[60:61]
    v_pk_fma_f32 v[190:191], v[86:87], v[190:191], v[18:19] neg_lo:[0,0,1] neg_hi:[0,0,1]
    v_pk_fma_f32 v[28:29], v[112:113], v[22:23], v[186:187] op_sel:[1,0,0] op_sel_hi:[1,1,1] neg_lo:[1,0,0] neg_hi:[1,0,0]
    v_pk_fma_f32 v[30:31], v[112:113], v[20:21], v[190:191] op_sel:[1,0,0] op_sel_hi:[1,1,1]
    v_pk_fma_f32 v[20:21], v[112:113], v[20:21], v[28:29] op_sel:[0,0,0] op_sel_hi:[0,1,1]
    v_pk_fma_f32 v[22:23], v[112:113], v[22:23], v[30:31] op_sel:[0,0,0] op_sel_hi:[0,1,1]
    v_pk_mul_f32 v[18:19], v[104:105], v[56:57]
    v_pk_fma_f32 v[208:209], v[88:89], v[208:209], v[18:19] neg_lo:[0,0,1] neg_hi:[0,0,1]
    v_pk_mul_f32 v[18:19], v[104:105], v[60:61]
    v_pk_fma_f32 v[212:213], v[88:89], v[212:213], v[18:19] neg_lo:[0,0,1] neg_hi:[0,0,1]
    v_pk_fma_f32 v[28:29], v[112:113], v[22:23], v[208:209] op_sel:[1,0,0] op_sel_hi:[1,1,1] neg_lo:[1,0,0] neg_hi:[1,0,0]
    v_pk_fma_f32 v[30:31], v[112:113], v[20:21], v[212:213] op_sel:[1,0,0] op_sel_hi:[1,1,1]
    v_pk_fma_f32 v[20:21], v[112:113], v[20:21], v[28:29] op_sel:[0,0,0] op_sel_hi:[0,1,1]
    v_pk_fma_f32 v[22:23], v[112:113], v[22:23], v[30:31] op_sel:[0,0,0] op_sel_hi:[0,1,1]
    v_pk_mul_f32 v[18:19], v[106:107], v[56:57]
    v_pk_fma_f32 v[210:211], v[90:91], v[210:211], v[18:19] neg_lo:[0,0,1] neg_hi:[0,0,1]
    v_pk_mul_f32 v[18:19], v[106:107], v[60:61]
    v_pk_fma_f32 v[214:215], v[90:91], v[214:215], v[18:19] neg_lo:[0,0,1] neg_hi:[0,0,1]
    v_pk_fma_f32 v[28:29], v[112:113], v[22:23], v[210:211] op_sel:[1,0,0] op_sel_hi:[1,1,1] neg_lo:[1,0,0] neg_hi:[1,0,0]
    v_pk_fma_f32 v[30:31], v[112:113], v[20:21], v[214:215] op_sel:[1,0,0] op_sel_hi:[1,1,1]
    v_pk_fma_f32 v[20:21], v[112:113], v[20:21], v[28:29] op_sel:[0,0,0] op_sel_hi:[0,1,1]
    v_pk_fma_f32 v[22:23], v[112:113], v[22:23], v[30:31] op_sel:[0,0,0] op_sel_hi:[0,1,1]
    v_pk_mul_f32 v[18:19], v[108:109], v[56:57]
    v_pk_fma_f32 v[232:233], v[92:93], v[232:233], v[18:19] neg_lo:[0,0,1] neg_hi:[0,0,1]
    v_pk_mul_f32 v[18:19], v[108:109], v[60:61]
    s_nop 0
L_SA_pad6:
    s_cbranch_execz L_SA_pad10
    v_pk_fma_f32 v[236:237], v[92:93], v[236:237], v[18:19] neg_lo:[0,0,1] neg_hi:[0,0,1]
    v_pk_fma_f32 v[28:29], v[112:113], v[22:23], v[232:233] op_sel:[1,0,0] op_sel_hi:[1,1,1] neg_lo:[1,0,0] neg_hi:[1,0,0]
    v_pk_fma_f32 v[30:31], v[112:113], v[20:21], v[236:237] op_sel:[1,0,0] op_sel_hi:[1,1,1]
    v_pk_fma_f32 v[20:21], v[112:113], v[20:21], v[28:29] op_sel:[0,0,0] op_sel_hi:[0,1,1]
    v_pk_fma_f32 v[22:23], v[112:113], v[22:23], v[30:31] op_sel:[0,0,0] op_sel_hi:[0,1,1]
    v_pk_mul_f32 v[18:19], v[110:111], v[56:57]
    v_pk_fma_f32 v[234:235], v[94:95], v[234:235], v[18:19] neg_lo:[0,0,1] neg_hi:[0,0,1]
    v_pk_mul_f32 v[18:19], v[110:111], v[60:61]
    v_pk_fma_f32 v[238:239], v[94:95], v[238:239], v[18:19] neg_lo:[0,0,1] neg_hi:[0,0,1]
    v_pk_fma_f32 v[28:29], v[112:113], v[22:23], v[234:235] op_sel:[1,0,0] op_sel_hi:[1,1,1] neg_lo:[1,0,0] neg_hi:[1,0,0]
    v_pk_fma_f32 v[30:31], v[112:113], v[20:21], v[238:239] op_sel:[1,0,0] op_sel_hi:[1,1,1]
    v_pk_fma_f32 v[20:21], v[112:113], v[20:21], v[28:29] op_sel:[0,0,0] op_sel_hi:[0,1,1]
    v_pk_fma_f32 v[22:23], v[112:113], v[22:23], v[30:31] op_sel:[0,0,0] op_sel_hi:[0,1,1]
    s_waitcnt lgkmcnt(7)
    v_fma_f32 v32, v38, v20, v21
    v_fma_f32 v33, v38, v22, v23
    v_fma_f32 v32, -v39, v22, v32
    v_fma_f32 v33, v39, v20, v33
    s_waitcnt lgkmcnt(6)
    v_pk_mul_f32 v[18:19], v[44:45], v[32:33] op_sel:[0,0] op_sel_hi:[0,1]
    v_pk_fma_f32 v[120:121], v[44:45], v[32:33], v[18:19] op_sel:[1,1,0] op_sel_hi:[1,0,1] neg_lo:[1,0,0]
    v_pk_mul_f32 v[18:19], v[96:97], v[64:65]
    v_pk_fma_f32 v[168:169], v[80:81], v[168:169], v[18:19] neg_lo:[0,0,1] neg_hi:[0,0,1]
    v_pk_mul_f32 v[18:19], v[96:97], v[68:69]
    v_pk_fma_f32 v[172:173], v[80:81], v[172:173], v[18:19] neg_lo:[0,0,1] neg_hi:[0,0,1]
    v_pk_mul_f32 v[18:19], v[98:99], v[64:65]
    v_pk_fma_f32 v[170:171], v[82:83], v[170:171], v[18:19] neg_lo:[0,0,1] neg_hi:[0,0,1]
    v_pk_mul_f32 v[18:19], v[98:99], v[68:69]
    v_pk_fma_f32 v[174:175], v[82:83], v[174:175], v[18:19] neg_lo:[0,0,1] neg_hi:[0,0,1]
    s_waitcnt lgkmcnt(5)
    s_nop 0
    v_pk_fma_f32 v[28:29], v[114:115], v[172:173], v[170:171] op_sel:[1,0,0] op_sel_hi:[1,1,1] neg_lo:[1,0,0] neg_hi:[1,0,0]
    v_pk_fma_f32 v[30:31], v[114:115], v[168:169], v[174:175] op_sel:[1,0,0] op_sel_hi:[1,1,1]
    v_pk_fma_f32 v[20:21], v[114:115], v[168:169], v[28:29] op_sel:[0,0,0] op_sel_hi:[0,1,1]
    v_pk_fma_f32 v[22:23], v[114:115], v[172:173], v[30:31] op_sel:[0,0,0] op_sel_hi:[0,1,1]
    v_pk_mul_f32 v[18:19], v[100:101], v[64:65]
    v_pk_fma_f32 v[192:193], v[84:85], v[192:193], v[18:19] neg_lo:[0,0,1] neg_hi:[0,0,1]
    v_pk_mul_f32 v[18:19], v[100:101], v[68:69]
    v_pk_fma_f32 v[196:197], v[84:85], v[196:197], v[18:19] neg_lo:[0,0,1] neg_hi:[0,0,1]
    v_pk_fma_f32 v[28:29], v[114:115], v[22:23], v[192:193] op_sel:[1,0,0] op_sel_hi:[1,1,1] neg_lo:[1,0,0] neg_hi:[1,0,0]
    v_pk_fma_f32 v[30:31], v[114:115], v[20:21], v[196:197] op_sel:[1,0,0] op_sel_hi:[1,1,1]
    v_pk_fma_f32 v[20:21], v[114:115], v[20:21], v[28:29] op_sel:[0,0,0] op_sel_hi:[0,1,1]
    v_pk_fma_f32 v[22:23], v[114:115], v[22:23], v[30:31] op_sel:[0,0,0] op_sel_hi:[0,1,1]
    v_pk_mul_f32 v[18:19], v[102:103], v[64:65]
    v_pk_fma_f32 v[194:195], v[86:87], v[194:195], v[18:19] neg_lo:[0,0,1] neg_hi:[0,0,1]
    v_pk_mul_f32 v[18:19], v[102:103], v[68:69]
    v_pk_fma_f32 v[198:199], v[86:87], v[198:199], v[18:19] neg_lo:[0,0,1] neg_hi:[0,0,1]
    v_pk_fma_f32 v[28:29], v[114:115], v[22:23], v[194:195] op_sel:[1,0,0] op_sel_hi:[1,1,1] neg_lo:[1,0,0] neg_hi:[1,0,0]
    v_pk_fma_f32 v[30:31], v[114:115], v[20:21], v[198:199] op_sel:[1,0,0] op_sel_hi:[1,1,1]
    v_pk_fma_f32 v[20:21], v[114:115], v[20:21], v[28:29] op_sel:[0,0,0] op_sel_hi:[0,1,1]
    v_pk_fma_f32 v[22:23], v[114:115], v[22:23], v[30:31] op_sel:[0,0,0] op_sel_hi:[0,1,1]
    v_pk_mul_f32 v[18:19], v[104:105], v[64:65]
    v_pk_fma_f32 v[216:217], v[88:89], v[216:217], v[18:19] neg_lo:[0,0,1] neg_hi:[0,0,1]
    v_pk_mul_f32 v[18:19], v[104:105], v[68:69]
    v_pk_fma_f32 v[220:221], v[88:89], v[220:221], v[18:19] neg_lo:[0,0,1] neg_hi:[0,0,1]
    v_pk_fma_f32 v[28:29], v[114:115], v[22:23], v[216:217] op_sel:[1,0,0] op_sel_hi:[1,1,1] neg_lo:[1,0,0] neg_hi:[1,0,0]
    v_pk_fma_f32 v[30:31], v[114:115], v[20:21], v[220:221] op_sel:[1,0,0] op_sel_hi:[1,1,1]
    v_pk_fma_f32 v[20:21], v[114:115], v[20:21], v[28:29] op_sel:[0,0,0] op_sel_hi:[0,1,1]
    v_pk_fma_f32 v[22:23], v[114:115], v[22:23], v[30:31] op_sel:[0,0,0] op_sel_hi:[0,1,1]
    v_pk_mul_f32 v[18:19], v[106:107], v[64:65]
    v_pk_fma_f32 v[218:219], v[90:91], v[218:219], v[18:19] neg_lo:[0,0,1] neg_hi:[0,0,1]
    v_pk_mul_f32 v[18:19], v[106:107], v[68:69]
    v_pk_fma_f32 v[222:223], v[90:91], v[222:223], v[18:19] neg_lo:[0,0,1] neg_hi:[0,0,1]
    v_pk_fma_f32 v[28:29], v[114:115], v[22:23], v[218:219] op_sel:[1,0,0] op_sel_hi:[1,1,1] neg_lo:[1,0,0] neg_hi:[1,0,0]
    v_pk_fma_f32 v[30:31], v[114:115], v[20:21], v[222:223] op_sel:[1,0,0] op_sel_hi:[1,1,1]
    v_pk_fma_f32 v[20:21], v[114:115], v[20:21], v[28:29] op_sel:[0,0,0] op_sel_hi:[0,1,1]
    v_pk_fma_f32 v[22:23], v[114:115], v[22:23], v[30:31] op_sel:[0,0,0] op_sel_hi:[0,1,1]
    v_pk_mul_f32 v[18:19], v[108:109], v[64:65]
    v_pk_fma_f32 v[240:241], v[92:93], v[240:241], v[18:19] neg_lo:[0,0,1] neg_hi:[0,0,1]
    v_pk_mul_f32 v[18:19], v[108:109], v[68:69]
    v_pk_fma_f32 v[244:245], v[92:93], v[244:245], v[18:19] neg_lo:[0,0,1] neg_hi:[0,0,1]
    v_pk_fma_f32 v[28:29], v[114:115], v[22:23], v[240:241] op_sel:[1,0,0] op_sel_hi:[1,1,1] neg_lo:[1,0,0] neg_hi:[1,0,0]
    v_pk_fma_f32 v[30:31], v[114:115], v[20:21], v[244:245] op_sel:[1,0,0] op_sel_hi:[1,1,1]
    v_pk_fma_f32 v[20:21], v[114:115], v[20:21], v[28:29] op_sel:[0,0,0] op_sel_hi:[0,1,1]
    v_pk_fma_f32 v[22:23], v[114:115], v[22:23], v[30:31] op_sel:[0,0,0] op_sel_hi:[0,1,1]
    v_pk_mul_f32 v[18:19], v[110:111], v[64:65]
    v_pk_fma_f32 v[242:243], v[94:95], v[242:243], v[18:19] neg_lo:[0,0,1] neg_hi:[0,0,1]
    v_pk_mul_f32 v[18:19], v[110:111], v[68:69]
    v_pk_fma_f32 v[246:247], v[94:95], v[246:247], v[18:19] neg_lo:[0,0,1] neg_hi:[0,0,1]
    v_pk_fma_f32 v[28:29], v[114:115], v[22:23], v[242:243] op_sel:[1,0,0] op_sel_hi:[1,1,1] neg_lo:[1,0,0] neg_hi:[1,0,0]
    v_pk_fma_f32 v[30:31], v[114:115], v[20:21], v[246:247] op_sel:[1,0,0] op_sel_hi:[1,1,1]
    v_pk_fma_f32 v[20:21], v[114:115], v[20:21], v[28:29] op_sel:[0,0,0] op_sel_hi:[0,1,1]
    v_pk_fma_f32 v[22:23], v[114:115], v[22:23], v[30:31] op_sel:[0,0,0] op_sel_hi:[0,1,1]
    s_waitcnt lgkmcnt(4)
    v_fma_f32 v34, v40, v20, v21
    v_fma_f32 v35, v40, v22, v23
    v_fma_f32 v34, -v41, v22, v34
    v_fma_f32 v35, v41, v20, v35
    s_waitcnt lgkmcnt(3)
    v_pk_mul_f32 v[18:19], v[46:47], v[34:35] op_sel:[0,0] op_sel_hi:[0,1]
    v_pk_fma_f32 v[122:123], v[46:47], v[34:35], v[18:19] op_sel:[1,1,0] op_sel_hi:[1,0,1] neg_lo:[1,0,0]
    v_pk_mul_f32 v[18:19], v[96:97], v[72:73]
    v_pk_fma_f32 v[176:177], v[80:81], v[176:177], v[18:19] neg_lo:[0,0,1] neg_hi:[0,0,1]
    v_pk_mul_f32 v[18:19], v[96:97], v[76:77]
    v_pk_fma_f32 v[180:181], v[80:81], v[180:181], v[18:19] neg_lo:[0,0,1] neg_hi:[0,0,1]
    v_pk_mul_f32 v[18:19], v[98:99], v[72:73]
    v_pk_fma_f32 v[178:179], v[82:83], v[178:179], v[18:19] neg_lo:[0,0,1] neg_hi:[0,0,1]
    v_pk_mul_f32 v[18:19], v[98:99], v[76:77]
    v_pk_fma_f32 v[182:183], v[82:83], v[182:183], v[18:19] neg_lo:[0,0,1] neg_hi:[0,0,1]
    s_waitcnt lgkmcnt(2)
    s_nop 0
    v_pk_fma_f32 v[28:29], v[116:117], v[180:181], v[178:179] op_sel:[1,0,0] op_sel_hi:[1,1,1] neg_lo:[1,0,0] neg_hi:[1,0,0]
    v_pk_fma_f32 v[30:31], v[116:117], v[176:177], v[182:183] op_sel:[1,0,0] op_sel_hi:[1,1,1]
    v_pk_fma_f32 v[20:21], v[116:117], v[176:177], v[28:29] op_sel:[0,0,0] op_sel_hi:[0,1,1]
    v_pk_fma_f32 v[22:23], v[116:117], v[180:181], v[30:31] op_sel:[0,0,0] op_sel_hi:[0,1,1]
    v_pk_mul_f32 v[18:19], v[100:101], v[72:73]
    v_pk_fma_f32 v[200:201], v[84:85], v[200:201], v[18:19] neg_lo:[0,0,1] neg_hi:[0,0,1]
    s_nop 0
L_SA_pad7:
    s_cbranch_execz L_SA_pad11
    v_pk_mul_f32 v[18:19], v[100:101], v[76:77]
    v_pk_fma_f32 v[204:205], v[84:85], v[204:205], v[18:19] neg_lo:[0,0,1] neg_hi:[0,0,1]
    v_pk_fma_f32 v[28:29], v[116:117], v[22:23], v[200:201] op_sel:[1,0,0] op_sel_hi:[1,1,1] neg_lo:[1,0,0] neg_hi:[1,0,0]
    v_pk_fma_f32 v[30:31], v[116:117], v[20:21], v[204:205] op_sel:[1,0,0] op_sel_hi:[1,1,1]
    v_pk_fma_f32 v[20:21], v[116:117], v[20:21], v[28:29] op_sel:[0,0,0] op_sel_hi:[0,1,1]
    v_pk_fma_f32 v[22:23], v[116:117], v[22:23], v[30:31] op_sel:[0,0,0] op_sel_hi:[0,1,1]
    v_pk_mul_f32 v[18:19], v[102:103], v[72:73]
    v_pk_fma_f32 v[202:203], v[86:87], v[202:203], v[18:19] neg_lo:[0,0,1] neg_hi:[0,0,1]
    v_pk_mul_f32 v[18:19], v[102:103], v[76:77]
    v_pk_fma_f32 v[206:207], v[86:87], v[206:207], v[18:19] neg_lo:[0,0,1] neg_hi:[0,0,1]
    v_pk_fma_f32 v[28:29], v[116:117], v[22:23], v[202:203] op_sel:[1,0,0] op_sel_hi:[1,1,1] neg_lo:[1,0,0] neg_hi:[1,0,0]
    v_pk_fma_f32 v[30:31], v[116:117], v[20:21], v[206:207] op_sel:[1,0,0] op_sel_hi:[1,1,1]
    v_pk_fma_f32 v[20:21], v[116:117], v[20:21], v[28:29] op_sel:[0,0,0] op_sel_hi:[0,1,1]
    v_pk_fma_f32 v[22:23], v[116:117], v[22:23], v[30:31] op_sel:[0,0,0] op_sel_hi:[0,1,1]
    v_pk_mul_f32 v[18:19], v[104:105], v[72:73]
    v_pk_fma_f32 v[224:225], v[88:89], v[224:225], v[18:19] neg_lo:[0,0,1] neg_hi:[0,0,1]
    v_pk_mul_f32 v[18:19], v[104:105], v[76:77]
    v_pk_fma_f32 v[228:229], v[88:89], v[228:229], v[18:19] neg_lo:[0,0,1] neg_hi:[0,0,1]
    v_pk_fma_f32 v[28:29], v[116:117], v[22:23], v[224:225] op_sel:[1,0,0] op_sel_hi:[1,1,1] neg_lo:[1,0,0] neg_hi:[1,0,0]
    v_pk_fma_f32 v[30:31], v[116:117], v[20:21], v[228:229] op_sel:[1,0,0] op_sel_hi:[1,1,1]
    v_pk_fma_f32 v[20:21], v[116:117], v[20:21], v[28:29] op_sel:[0,0,0] op_sel_hi:[0,1,1]
    v_pk_fma_f32 v[22:23], v[116:117], v[22:23], v[30:31] op_sel:[0,0,0] op_sel_hi:[0,1,1]
    v_pk_mul_f32 v[18:19], v[106:107], v[72:73]
    v_pk_fma_f32 v[226:227], v[90:91], v[226:227], v[18:19] neg_lo:[0,0,1] neg_hi:[0,0,1]
    v_pk_mul_f32 v[18:19], v[106:107], v[76:77]
    v_pk_fma_f32 v[230:231], v[90:91], v[230:231], v[18:19] neg_lo:[0,0,1] neg_hi:[0,0,1]
    v_pk_fma_f32 v[28:29], v[116:117], v[22:23], v[226:227] op_sel:[1,0,0] op_sel_hi:[1,1,1] neg_lo:[1,0,0] neg_hi:[1,0,0]
    v_pk_fma_f32 v[30:31], v[116:117], v[20:21], v[230:231] op_sel:[1,0,0] op_sel_hi:[1,1,1]
    v_pk_fma_f32 v[20:21], v[116:117], v[20:21], v[28:29] op_sel:[0,0,0] op_sel_hi:[0,1,1]
    v_pk_fma_f32 v[22:23], v[116:117], v[22:23], v[30:31] op_sel:[0,0,0] op_sel_hi:[0,1,1]
    v_pk_mul_f32 v[18:19], v[108:109], v[72:73]
    v_pk_fma_f32 v[248:249], v[92:93], v[248:249], v[18:19] neg_lo:[0,0,1] neg_hi:[0,0,1]
    v_pk_mul_f32 v[18:19], v[108:109], v[76:77]
    v_pk_fma_f32 v[252:253], v[92:93], v[252:253], v[18:19] neg_lo:[0,0,1] neg_hi:[0,0,1]
    v_pk_fma_f32 v[28:29], v[116:117], v[22:23], v[248:249] op_sel:[1,0,0] op_sel_hi:[1,1,1] neg_lo:[1,0,0] neg_hi:[1,0,0]
    v_pk_fma_f32 v[30:31], v[116:117], v[20:21], v[252:253] op_sel:[1,0,0] op_sel_hi:[1,1,1]
    v_pk_fma_f32 v[20:21], v[116:117], v[20:21], v[28:29] op_sel:[0,0,0] op_sel_hi:[0,1,1]
    v_pk_fma_f32 v[22:23], v[116:117], v[22:23], v[30:31] op_sel:[0,0,0] op_sel_hi:[0,1,1]
    v_pk_mul_f32 v[18:19], v[110:111], v[72:73]
    v_pk_fma_f32 v[250:251], v[94:95], v[250:251], v[18:19] neg_lo:[0,0,1] neg_hi:[0,0,1]
    v_pk_mul_f32 v[18:19], v[110:111], v[76:77]
    v_pk_fma_f32 v[254:255], v[94:95], v[254:255], v[18:19] neg_lo:[0,0,1] neg_hi:[0,0,1]
    v_pk_fma_f32 v[28:29], v[116:117], v[22:23], v[250:251] op_sel:[1,0,0] op_sel_hi:[1,1,1] neg_lo:[1,0,0] neg_hi:[1,0,0]
    v_pk_fma_f32 v[30:31], v[116:117], v[20:21], v[254:255] op_sel:[1,0,0] op_sel_hi:[1,1,1]
    v_pk_fma_f32 v[20:21], v[116:117], v[20:21], v[28:29] op_sel:[0,0,0] op_sel_hi:[0,1,1]
    v_pk_fma_f32 v[22:23], v[116:117], v[22:23], v[30:31] op_sel:[0,0,0] op_sel_hi:[0,1,1]
    s_waitcnt lgkmcnt(1)
    v_fma_f32 v36, v42, v20, v21
    v_fma_f32 v37, v42, v22, v23
    v_fma_f32 v36, -v43, v22, v36
    v_fma_f32 v37, v43, v20, v37
    s_waitcnt lgkmcnt(0)
    v_pk_mul_f32 v[18:19], v[48:49], v[36:37] op_sel:[0,0] op_sel_hi:[0,1]
    v_pk_fma_f32 v[124:125], v[48:49], v[36:37], v[18:19] op_sel:[1,1,0] op_sel_hi:[1,0,1] neg_lo:[1,0,0]
    s_add_u32 s69, s68, s73
    s_mul_i32 s69, s69, 7168
    v_permlane32_swap_b32 v120, v124
    v_permlane32_swap_b32 v121, v125
    v_permlane32_swap_b32 v122, v123
    v_pk_add_f32 v[120:121], v[120:121], v[124:125]
    v_add_f32 v122, v122, v123
    v_mov_b32 v126, v120
    v_mov_b32 v127, v121
    v_mov_b32 v123, v122
    s_add_u32 s69, s69, s67
    v_permlane16_swap_b32 v120, v126
    v_permlane16_swap_b32 v121, v127
    v_permlane16_swap_b32 v122, v123
    v_pk_add_f32 v[128:129], v[120:121], v[126:127]
    v_add_f32 v130, v122, v123
    buffer_store_dwordx4 v[128:131], v5, s[44:47], s69 offen sc1
    s_lshl_b32 s69, s73, 2
    buffer_load_dwordx4 a[128:131], v15, s[44:47], s81 offen offset:2048 sc1
    v_add_u32 v14, s69, v3
    v_mul_u32_u24 v13, 768, v14
    v_add_u32 v13, v13, v7
    v_add_u32 v12, 13312, v13
    v_add_u32 v4, 11520, v7
    v_cmp_le_u32 vcc, 1, v3
    v_subrev_u32 v132, 768, v12
    v_add_u32 v135, 7680, v7
    v_cndmask_b32 v132, v4, v132, vcc
    v_cmp_le_u32 vcc, 2, v3
    v_subrev_u32 v133, 1536, v12
    v_add_u32 v136, 9984, v7
    buffer_load_dwordx4 a[132:135], v15, s[44:47], s81 offen offset:3072 sc1
    v_cndmask_b32 v133, v4, v133, vcc
    v_cmp_le_u32 vcc, 3, v3
    v_subrev_u32 v134, 2304, v12
    v_add_u32 v137, 10752, v7
    v_cndmask_b32 v134, v4, v134, vcc
    v_add_u32 v5, 9, v3
    v_cmp_eq_u32 vcc, 0, v3
    v_mul_u32_u24 v5, 768, v5
    s_nop 0
    v_cndmask_b32 v5, v5, 0, vcc
    v_add_u32 v5, v5, v7
    ds_write2_b64 v12, v[32:33], v[34:35] offset0:0 offset1:16
    ds_write_b64 v12, v[36:37] offset:256
    ds_read2_b64 v[50:53], v135 offset0:0 offset1:16
    s_add_u32 s81, s81, 4096
    buffer_load_dwordx4 a[136:139], v15, s[44:47], s81 offen offset:0 sc1
    ds_read_b64 v[54:55], v135 offset:256
    ds_read2_b64 v[80:83], v132 offset0:0 offset1:16
    ds_read_b64 v[84:85], v132 offset:256
    ds_read2_b64 v[86:89], v133 offset0:0 offset1:16
    ds_read_b64 v[90:91], v133 offset:256
    ds_read2_b64 v[92:95], v134 offset0:0 offset1:16
    ds_read_b64 v[96:97], v134 offset:256
    ds_read2_b64 v[20:23], v137 offset0:0 offset1:16
    ds_read_b64 v[24:25], v137 offset:256
    ds_read2_b64 v[110:113], v5 offset0:0 offset1:16
    ds_read_b64 v[114:115], v5 offset:256
    ds_read2_b64 v[98:101], v136 offset0:0 offset1:16
    s_add_u32 s81, s76, 143360
    buffer_load_dwordx4 a[140:143], v15, s[44:47], s81 offen offset:0 sc1
    ds_read_b64 v[102:103], v136 offset:256
    ds_read2_b64 v[104:107], v13 offset0:0 offset1:16
    ds_read_b64 v[108:109], v13 offset:256
    v_lshlrev_b32 v4, 4, v2
    v_lshlrev_b32 v5, 2, v14
    v_sub_u32 v5, s68, v5
    v_mov_b32 v6, 1879048192
    v_subrev_u32 v13, 1, v5
    v_cmp_le_i32 vcc, 0, v13
    v_mul_u32_u24 v13, 7168, v13
    v_add_u32 v13, v13, v4
    v_cndmask_b32 v30, v6, v13, vcc
    v_cndmask_b32 v118, 0, v16, vcc
    buffer_load_dwordx4 a[144:147], v15, s[44:47], s81 offen offset:1024 sc1
    v_subrev_u32 v13, 2, v5
    v_cmp_le_i32 vcc, 0, v13
    v_mul_u32_u24 v13, 7168, v13
    v_add_u32 v13, v13, v4
    v_cndmask_b32 v31, v6, v13, vcc
    v_cndmask_b32 v119, 0, v16, vcc
    v_subrev_u32 v13, 3, v5
    v_cmp_le_i32 vcc, 0, v13
    v_mul_u32_u24 v13, 7168, v13
    v_add_u32 v13, v13, v4
    v_cndmask_b32 v116, v6, v13, vcc
    v_cndmask_b32 v138, 0, v16, vcc
    buffer_load_dwordx4 a[148:151], v15, s[44:47], s81 offen offset:2048 sc1
    v_subrev_u32 v13, 4, v5
    v_cmp_le_i32 vcc, 0, v13
    v_mul_u32_u24 v13, 7168, v13
    v_add_u32 v13, v13, v4
    v_cndmask_b32 v117, v6, v13, vcc
    v_cndmask_b32 v139, 0, v16, vcc
    s_waitcnt lgkmcnt(9)
    v_pk_fma_f32 v[28:29], v[50:51], v[92:93], v[86:87] op_sel:[0,0,0] op_sel_hi:[0,1,1]
    v_pk_fma_f32 v[132:133], v[50:51], v[92:93], v[28:29] op_sel:[1,1,0] op_sel_hi:[1,0,1] neg_lo:[1,0,0]
    v_pk_fma_f32 v[28:29], v[50:51], v[132:133], v[80:81] op_sel:[0,0,0] op_sel_hi:[0,1,1]
    v_pk_fma_f32 v[132:133], v[50:51], v[132:133], v[28:29] op_sel:[1,1,0] op_sel_hi:[1,0,1] neg_lo:[1,0,0]
    v_pk_fma_f32 v[28:29], v[50:51], v[132:133], v[32:33] op_sel:[0,0,0] op_sel_hi:[0,1,1]
    v_pk_fma_f32 v[32:33], v[50:51], v[132:133], v[28:29] op_sel:[1,1,0] op_sel_hi:[1,0,1] neg_lo:[1,0,0]
    v_pk_fma_f32 v[28:29], v[52:53], v[94:95], v[88:89] op_sel:[0,0,0] op_sel_hi:[0,1,1]
    buffer_load_dwordx4 a[152:155], v15, s[44:47], s81 offen offset:3072 sc1
    v_pk_fma_f32 v[134:135], v[52:53], v[94:95], v[28:29] op_sel:[1,1,0] op_sel_hi:[1,0,1] neg_lo:[1,0,0]
    v_pk_fma_f32 v[28:29], v[52:53], v[134:135], v[82:83] op_sel:[0,0,0] op_sel_hi:[0,1,1]
    v_pk_fma_f32 v[134:135], v[52:53], v[134:135], v[28:29] op_sel:[1,1,0] op_sel_hi:[1,0,1] neg_lo:[1,0,0]
    s_nop 0
L_SA_pad8:
    s_cbranch_execz L_SA_pad12
    v_pk_fma_f32 v[28:29], v[52:53], v[134:135], v[34:35] op_sel:[0,0,0] op_sel_hi:[0,1,1]
    v_pk_fma_f32 v[34:35], v[52:53], v[134:135], v[28:29] op_sel:[1,1,0] op_sel_hi:[1,0,1] neg_lo:[1,0,0]
    s_waitcnt lgkmcnt(8)
    s_nop 0
    v_pk_fma_f32 v[28:29], v[54:55], v[96:97], v[90:91] op_sel:[0,0,0] op_sel_hi:[0,1,1]
    v_pk_fma_f32 v[136:137], v[54:55], v[96:97], v[28:29] op_sel:[1,1,0] op_sel_hi:[1,0,1] neg_lo:[1,0,0]
    v_pk_fma_f32 v[28:29], v[54:55], v[136:137], v[84:85] op_sel:[0,0,0] op_sel_hi:[0,1,1]
    v_pk_fma_f32 v[136:137], v[54:55], v[136:137], v[28:29] op_sel:[1,1,0] op_sel_hi:[1,0,1] neg_lo:[1,0,0]
    v_pk_fma_f32 v[28:29], v[54:55], v[136:137], v[36:37] op_sel:[0,0,0] op_sel_hi:[0,1,1]
    v_pk_fma_f32 v[36:37], v[54:55], v[136:137], v[28:29] op_sel:[1,1,0] op_sel_hi:[1,0,1] neg_lo:[1,0,0]
    s_mul_i32 s70, s73, 9984
    s_add_u32 s81, s81, 4096
    buffer_load_dwordx4 a[156:159], v15, s[44:47], s81 offen offset:0 sc1
    v_add_u32 v4, s70, v7
    s_mul_i32 s68, s73, 4096
    s_add_u32 s68, s68, 11520
    v_add_u32 v6, s68, v7
    ds_write2_b64 v12, v[32:33], v[34:35] offset0:0 offset1:16
    ds_write_b64 v12, v[36:37] offset:256
    s_waitcnt lgkmcnt(0)
    s_barrier
    ds_read2_b64 v[80:83], v4 offset0:0 offset1:16
    ds_read_b64 v[84:85], v4 offset:256
    ds_read2_b64 v[86:89], v6 offset0:0 offset1:16
    ds_read_b64 v[90:91], v6 offset:256
    s_waitcnt vmcnt(8)
    s_nop 0
    v_pk_mul_f32 v[18:19], v[20:21], v[160:161] op_sel:[0,0] op_sel_hi:[1,0]
    buffer_load_dwordx4 v[56:59], v30, s[44:47], s67 offen offset:0 sc1
    v_pk_mul_f32 v[160:161], v[20:21], v[160:161] op_sel:[0,1] op_sel_hi:[1,1]
    v_pk_fma_f32 v[18:19], v[20:21], v[164:165], v[18:19] op_sel:[1,0,0] op_sel_hi:[0,0,1] neg_lo:[1,0,0]
    v_pk_fma_f32 v[160:161], v[20:21], v[164:165], v[160:161] op_sel:[1,1,0] op_sel_hi:[0,1,1] neg_lo:[1,0,0]
    v_pk_mul_f32 v[164:165], v[20:21], v[162:163] op_sel:[0,0] op_sel_hi:[1,0]
    v_pk_mul_f32 v[162:163], v[20:21], v[162:163] op_sel:[0,1] op_sel_hi:[1,1]
    v_pk_fma_f32 v[164:165], v[20:21], v[166:167], v[164:165] op_sel:[1,0,0] op_sel_hi:[0,0,1] neg_lo:[1,0,0]
    buffer_load_dwordx4 v[60:63], v30, s[44:47], s67 offen offset:256 sc1
    v_pk_fma_f32 v[162:163], v[20:21], v[166:167], v[162:163] op_sel:[1,1,0] op_sel_hi:[0,1,1] neg_lo:[1,0,0]
    v_pk_mul_f32 v[166:167], v[20:21], v[184:185] op_sel:[0,0] op_sel_hi:[1,0]
    v_pk_mul_f32 v[184:185], v[20:21], v[184:185] op_sel:[0,1] op_sel_hi:[1,1]
    v_pk_fma_f32 v[166:167], v[20:21], v[188:189], v[166:167] op_sel:[1,0,0] op_sel_hi:[0,0,1] neg_lo:[1,0,0]
    v_pk_fma_f32 v[184:185], v[20:21], v[188:189], v[184:185] op_sel:[1,1,0] op_sel_hi:[0,1,1] neg_lo:[1,0,0]
    v_pk_mul_f32 v[188:189], v[20:21], v[186:187] op_sel:[0,0] op_sel_hi:[1,0]
    buffer_load_dwordx4 v[64:67], v31, s[44:47], s67 offen offset:0 sc1
    v_pk_mul_f32 v[186:187], v[20:21], v[186:187] op_sel:[0,1] op_sel_hi:[1,1]
    v_pk_fma_f32 v[188:189], v[20:21], v[190:191], v[188:189] op_sel:[1,0,0] op_sel_hi:[0,0,1] neg_lo:[1,0,0]
    v_pk_fma_f32 v[186:187], v[20:21], v[190:191], v[186:187] op_sel:[1,1,0] op_sel_hi:[0,1,1] neg_lo:[1,0,0]
    v_pk_mul_f32 v[190:191], v[20:21], v[208:209] op_sel:[0,0] op_sel_hi:[1,0]
    v_pk_mul_f32 v[208:209], v[20:21], v[208:209] op_sel:[0,1] op_sel_hi:[1,1]
    v_pk_fma_f32 v[190:191], v[20:21], v[212:213], v[190:191] op_sel:[1,0,0] op_sel_hi:[0,0,1] neg_lo:[1,0,0]
    buffer_load_dwordx4 v[68:71], v31, s[44:47], s67 offen offset:256 sc1
    v_pk_fma_f32 v[208:209], v[20:21], v[212:213], v[208:209] op_sel:[1,1,0] op_sel_hi:[0,1,1] neg_lo:[1,0,0]
    v_pk_mul_f32 v[212:213], v[20:21], v[210:211] op_sel:[0,0] op_sel_hi:[1,0]
    v_pk_mul_f32 v[210:211], v[20:21], v[210:211] op_sel:[0,1] op_sel_hi:[1,1]
    v_pk_fma_f32 v[212:213], v[20:21], v[214:215], v[212:213] op_sel:[1,0,0] op_sel_hi:[0,0,1] neg_lo:[1,0,0]
    v_pk_fma_f32 v[210:211], v[20:21], v[214:215], v[210:211] op_sel:[1,1,0] op_sel_hi:[0,1,1] neg_lo:[1,0,0]
    v_pk_mul_f32 v[214:215], v[20:21], v[232:233] op_sel:[0,0] op_sel_hi:[1,0]
    buffer_load_dwordx4 v[72:75], v116, s[44:47], s67 offen offset:0 sc1
    v_pk_mul_f32 v[232:233], v[20:21], v[232:233] op_sel:[0,1] op_sel_hi:[1,1]
    v_pk_fma_f32 v[214:215], v[20:21], v[236:237], v[214:215] op_sel:[1,0,0] op_sel_hi:[0,0,1] neg_lo:[1,0,0]
    v_pk_fma_f32 v[232:233], v[20:21], v[236:237], v[232:233] op_sel:[1,1,0] op_sel_hi:[0,1,1] neg_lo:[1,0,0]
    v_pk_mul_f32 v[236:237], v[20:21], v[234:235] op_sel:[0,0] op_sel_hi:[1,0]
    v_pk_mul_f32 v[234:235], v[20:21], v[234:235] op_sel:[0,1] op_sel_hi:[1,1]
    v_pk_fma_f32 v[236:237], v[20:21], v[238:239], v[236:237] op_sel:[1,0,0] op_sel_hi:[0,0,1] neg_lo:[1,0,0]
    buffer_load_dwordx4 v[76:79], v116, s[44:47], s67 offen offset:256 sc1
    v_pk_fma_f32 v[234:235], v[20:21], v[238:239], v[234:235] op_sel:[1,1,0] op_sel_hi:[0,1,1] neg_lo:[1,0,0]
    v_pk_mul_f32 v[238:239], v[22:23], v[168:169] op_sel:[0,0] op_sel_hi:[1,0]
    v_pk_mul_f32 v[168:169], v[22:23], v[168:169] op_sel:[0,1] op_sel_hi:[1,1]
    v_pk_fma_f32 v[238:239], v[22:23], v[172:173], v[238:239] op_sel:[1,0,0] op_sel_hi:[0,0,1] neg_lo:[1,0,0]
    v_pk_fma_f32 v[168:169], v[22:23], v[172:173], v[168:169] op_sel:[1,1,0] op_sel_hi:[0,1,1] neg_lo:[1,0,0]
    v_pk_mul_f32 v[172:173], v[22:23], v[170:171] op_sel:[0,0] op_sel_hi:[1,0]
    buffer_load_dwordx4 v[120:123], v117, s[44:47], s67 offen offset:0 sc1
    v_pk_mul_f32 v[170:171], v[22:23], v[170:171] op_sel:[0,1] op_sel_hi:[1,1]
    v_pk_fma_f32 v[172:173], v[22:23], v[174:175], v[172:173] op_sel:[1,0,0] op_sel_hi:[0,0,1] neg_lo:[1,0,0]
    v_pk_fma_f32 v[170:171], v[22:23], v[174:175], v[170:171] op_sel:[1,1,0] op_sel_hi:[0,1,1] neg_lo:[1,0,0]
    v_pk_mul_f32 v[174:175], v[22:23], v[192:193] op_sel:[0,0] op_sel_hi:[1,0]
    v_pk_mul_f32 v[192:193], v[22:23], v[192:193] op_sel:[0,1] op_sel_hi:[1,1]
    v_pk_fma_f32 v[174:175], v[22:23], v[196:197], v[174:175] op_sel:[1,0,0] op_sel_hi:[0,0,1] neg_lo:[1,0,0]
    buffer_load_dwordx4 v[124:127], v117, s[44:47], s67 offen offset:256 sc1
    v_pk_fma_f32 v[192:193], v[22:23], v[196:197], v[192:193] op_sel:[1,1,0] op_sel_hi:[0,1,1] neg_lo:[1,0,0]
    v_pk_mul_f32 v[196:197], v[22:23], v[194:195] op_sel:[0,0] op_sel_hi:[1,0]
    v_pk_mul_f32 v[194:195], v[22:23], v[194:195] op_sel:[0,1] op_sel_hi:[1,1]
    v_pk_fma_f32 v[196:197], v[22:23], v[198:199], v[196:197] op_sel:[1,0,0] op_sel_hi:[0,0,1] neg_lo:[1,0,0]
    v_pk_fma_f32 v[194:195], v[22:23], v[198:199], v[194:195] op_sel:[1,1,0] op_sel_hi:[0,1,1] neg_lo:[1,0,0]
    v_pk_mul_f32 v[198:199], v[22:23], v[216:217] op_sel:[0,0] op_sel_hi:[1,0]
    v_pk_mul_f32 v[216:217], v[22:23], v[216:217] op_sel:[0,1] op_sel_hi:[1,1]
    v_pk_fma_f32 v[198:199], v[22:23], v[220:221], v[198:199] op_sel:[1,0,0] op_sel_hi:[0,0,1] neg_lo:[1,0,0]
    v_pk_fma_f32 v[216:217], v[22:23], v[220:221], v[216:217] op_sel:[1,1,0] op_sel_hi:[0,1,1] neg_lo:[1,0,0]
    v_pk_mul_f32 v[220:221], v[22:23], v[218:219] op_sel:[0,0] op_sel_hi:[1,0]
    v_pk_mul_f32 v[218:219], v[22:23], v[218:219] op_sel:[0,1] op_sel_hi:[1,1]
    v_pk_fma_f32 v[220:221], v[22:23], v[222:223], v[220:221] op_sel:[1,0,0] op_sel_hi:[0,0,1] neg_lo:[1,0,0]
    v_pk_fma_f32 v[218:219], v[22:23], v[222:223], v[218:219] op_sel:[1,1,0] op_sel_hi:[0,1,1] neg_lo:[1,0,0]
    v_pk_mul_f32 v[222:223], v[22:23], v[240:241] op_sel:[0,0] op_sel_hi:[1,0]
    v_pk_mul_f32 v[240:241], v[22:23], v[240:241] op_sel:[0,1] op_sel_hi:[1,1]
    v_pk_fma_f32 v[222:223], v[22:23], v[244:245], v[222:223] op_sel:[1,0,0] op_sel_hi:[0,0,1] neg_lo:[1,0,0]
    v_pk_fma_f32 v[240:241], v[22:23], v[244:245], v[240:241] op_sel:[1,1,0] op_sel_hi:[0,1,1] neg_lo:[1,0,0]
    v_pk_mul_f32 v[244:245], v[22:23], v[242:243] op_sel:[0,0] op_sel_hi:[1,0]
    v_pk_mul_f32 v[242:243], v[22:23], v[242:243] op_sel:[0,1] op_sel_hi:[1,1]
    v_pk_fma_f32 v[244:245], v[22:23], v[246:247], v[244:245] op_sel:[1,0,0] op_sel_hi:[0,0,1] neg_lo:[1,0,0]
    v_pk_fma_f32 v[242:243], v[22:23], v[246:247], v[242:243] op_sel:[1,1,0] op_sel_hi:[0,1,1] neg_lo:[1,0,0]
    v_pk_mul_f32 v[246:247], v[24:25], v[176:177] op_sel:[0,0] op_sel_hi:[1,0]
    v_pk_mul_f32 v[176:177], v[24:25], v[176:177] op_sel:[0,1] op_sel_hi:[1,1]
    v_pk_fma_f32 v[246:247], v[24:25], v[180:181], v[246:247] op_sel:[1,0,0] op_sel_hi:[0,0,1] neg_lo:[1,0,0]
    v_pk_fma_f32 v[176:177], v[24:25], v[180:181], v[176:177] op_sel:[1,1,0] op_sel_hi:[0,1,1] neg_lo:[1,0,0]
    v_pk_mul_f32 v[180:181], v[24:25], v[178:179] op_sel:[0,0] op_sel_hi:[1,0]
    v_pk_mul_f32 v[178:179], v[24:25], v[178:179] op_sel:[0,1] op_sel_hi:[1,1]
    v_pk_fma_f32 v[180:181], v[24:25], v[182:183], v[180:181] op_sel:[1,0,0] op_sel_hi:[0,0,1] neg_lo:[1,0,0]
    v_pk_fma_f32 v[178:179], v[24:25], v[182:183], v[178:179] op_sel:[1,1,0] op_sel_hi:[0,1,1] neg_lo:[1,0,0]
    v_pk_mul_f32 v[182:183], v[24:25], v[200:201] op_sel:[0,0] op_sel_hi:[1,0]
    v_pk_mul_f32 v[200:201], v[24:25], v[200:201] op_sel:[0,1] op_sel_hi:[1,1]
    v_pk_fma_f32 v[182:183], v[24:25], v[204:205], v[182:183] op_sel:[1,0,0] op_sel_hi:[0,0,1] neg_lo:[1,0,0]
    v_pk_fma_f32 v[200:201], v[24:25], v[204:205], v[200:201] op_sel:[1,1,0] op_sel_hi:[0,1,1] neg_lo:[1,0,0]
    v_pk_mul_f32 v[204:205], v[24:25], v[202:203] op_sel:[0,0] op_sel_hi:[1,0]
    v_pk_mul_f32 v[202:203], v[24:25], v[202:203] op_sel:[0,1] op_sel_hi:[1,1]
    v_pk_fma_f32 v[204:205], v[24:25], v[206:207], v[204:205] op_sel:[1,0,0] op_sel_hi:[0,0,1] neg_lo:[1,0,0]
    v_pk_fma_f32 v[202:203], v[24:25], v[206:207], v[202:203] op_sel:[1,1,0] op_sel_hi:[0,1,1] neg_lo:[1,0,0]
    v_pk_mul_f32 v[206:207], v[24:25], v[224:225] op_sel:[0,0] op_sel_hi:[1,0]
    v_pk_mul_f32 v[224:225], v[24:25], v[224:225] op_sel:[0,1] op_sel_hi:[1,1]
    v_pk_fma_f32 v[206:207], v[24:25], v[228:229], v[206:207] op_sel:[1,0,0] op_sel_hi:[0,0,1] neg_lo:[1,0,0]
    v_pk_fma_f32 v[224:225], v[24:25], v[228:229], v[224:225] op_sel:[1,1,0] op_sel_hi:[0,1,1] neg_lo:[1,0,0]
    v_pk_mul_f32 v[228:229], v[24:25], v[226:227] op_sel:[0,0] op_sel_hi:[1,0]
    v_pk_mul_f32 v[226:227], v[24:25], v[226:227] op_sel:[0,1] op_sel_hi:[1,1]
    v_pk_fma_f32 v[228:229], v[24:25], v[230:231], v[228:229] op_sel:[1,0,0] op_sel_hi:[0,0,1] neg_lo:[1,0,0]
    v_pk_fma_f32 v[226:227], v[24:25], v[230:231], v[226:227] op_sel:[1,1,0] op_sel_hi:[0,1,1] neg_lo:[1,0,0]
    v_pk_mul_f32 v[230:231], v[24:25], v[248:249] op_sel:[0,0] op_sel_hi:[1,0]
    v_pk_mul_f32 v[248:249], v[24:25], v[248:249] op_sel:[0,1] op_sel_hi:[1,1]
    v_pk_fma_f32 v[230:231], v[24:25], v[252:253], v[230:231] op_sel:[1,0,0] op_sel_hi:[0,0,1] neg_lo:[1,0,0]
    v_pk_fma_f32 v[248:249], v[24:25], v[252:253], v[248:249] op_sel:[1,1,0] op_sel_hi:[0,1,1] neg_lo:[1,0,0]
    v_pk_mul_f32 v[252:253], v[24:25], v[250:251] op_sel:[0,0] op_sel_hi:[1,0]
    v_pk_mul_f32 v[250:251], v[24:25], v[250:251] op_sel:[0,1] op_sel_hi:[1,1]
    v_pk_fma_f32 v[252:253], v[24:25], v[254:255], v[252:253] op_sel:[1,0,0] op_sel_hi:[0,0,1] neg_lo:[1,0,0]
    v_pk_fma_f32 v[250:251], v[24:25], v[254:255], v[250:251] op_sel:[1,1,0] op_sel_hi:[0,1,1] neg_lo:[1,0,0]
    s_waitcnt lgkmcnt(1)
    s_nop 0
    v_pk_fma_f32 v[28:29], v[110:111], v[86:87], v[132:133] op_sel:[0,0,0] op_sel_hi:[0,1,1]
    v_pk_fma_f32 v[132:133], v[110:111], v[86:87], v[28:29] op_sel:[1,1,0] op_sel_hi:[1,0,1] neg_lo:[1,0,0]
    v_pk_mul_f32 v[28:29], v[80:81], v[110:111] op_sel:[0,0] op_sel_hi:[0,1]
    v_pk_fma_f32 v[110:111], v[80:81], v[110:111], v[28:29] op_sel:[1,1,0] op_sel_hi:[1,0,1] neg_lo:[1,0,0]
    v_pk_mul_f32 v[28:29], v[20:21], v[132:133] op_sel:[0,0] op_sel_hi:[0,1]
    v_pk_fma_f32 v[132:133], v[20:21], v[132:133], v[28:29] op_sel:[1,1,0] op_sel_hi:[1,0,1] neg_lo:[1,0,0]
    v_pk_mul_f32 v[28:29], v[20:21], v[110:111] op_sel:[0,0] op_sel_hi:[0,1]
    s_nop 0
L_SA_pad9:
    s_cbranch_execz L_SA_ret
    v_pk_fma_f32 v[110:111], v[20:21], v[110:111], v[28:29] op_sel:[1,1,0] op_sel_hi:[1,0,1] neg_lo:[1,0,0]
    v_pk_fma_f32 v[28:29], v[112:113], v[88:89], v[134:135] op_sel:[0,0,0] op_sel_hi:[0,1,1]
    v_pk_fma_f32 v[134:135], v[112:113], v[88:89], v[28:29] op_sel:[1,1,0] op_sel_hi:[1,0,1] neg_lo:[1,0,0]
    v_pk_mul_f32 v[28:29], v[82:83], v[112:113] op_sel:[0,0] op_sel_hi:[0,1]
    v_pk_fma_f32 v[112:113], v[82:83], v[112:113], v[28:29] op_sel:[1,1,0] op_sel_hi:[1,0,1] neg_lo:[1,0,0]
    v_pk_mul_f32 v[28:29], v[22:23], v[134:135] op_sel:[0,0] op_sel_hi:[0,1]
    v_pk_fma_f32 v[134:135], v[22:23], v[134:135], v[28:29] op_sel:[1,1,0] op_sel_hi:[1,0,1] neg_lo:[1,0,0]
    v_pk_mul_f32 v[28:29], v[22:23], v[112:113] op_sel:[0,0] op_sel_hi:[0,1]
    v_pk_fma_f32 v[112:113], v[22:23], v[112:113], v[28:29] op_sel:[1,1,0] op_sel_hi:[1,0,1] neg_lo:[1,0,0]
    s_waitcnt lgkmcnt(0)
    s_nop 0
    v_pk_fma_f32 v[28:29], v[114:115], v[90:91], v[136:137] op_sel:[0,0,0] op_sel_hi:[0,1,1]
    v_pk_fma_f32 v[136:137], v[114:115], v[90:91], v[28:29] op_sel:[1,1,0] op_sel_hi:[1,0,1] neg_lo:[1,0,0]
    v_pk_mul_f32 v[28:29], v[84:85], v[114:115] op_sel:[0,0] op_sel_hi:[0,1]
    v_pk_fma_f32 v[114:115], v[84:85], v[114:115], v[28:29] op_sel:[1,1,0] op_sel_hi:[1,0,1] neg_lo:[1,0,0]
    v_pk_mul_f32 v[28:29], v[24:25], v[136:137] op_sel:[0,0] op_sel_hi:[0,1]
    v_pk_fma_f32 v[136:137], v[24:25], v[136:137], v[28:29] op_sel:[1,1,0] op_sel_hi:[1,0,1] neg_lo:[1,0,0]
    v_pk_mul_f32 v[28:29], v[24:25], v[114:115] op_sel:[0,0] op_sel_hi:[0,1]
    v_pk_fma_f32 v[114:115], v[24:25], v[114:115], v[28:29] op_sel:[1,1,0] op_sel_hi:[1,0,1] neg_lo:[1,0,0]
    s_lshl_b32 s68, s60, 10
    s_xor_b32 s69, s68, 2048
    v_lshlrev_b32 v12, 4, v2
    v_add_u32 v12, 122880, v12
    v_add_u32 v5, s69, v12
    v_add_u32 v12, s68, v12
    v_lshl_add_u32 v4, v3, 8, v12
    v_and_b32 v14, 1, v2
    v_lshlrev_b32 v14, 4, v14
    v_mov_b32 v13, 0x3f80
    v_lshlrev_b32 v14, v14, v13
    v_lshrrev_b32 v13, 1, v2
    v_lshlrev_b32 v7, 1, v3
    v_cmp_eq_u32 vcc, v13, v7
    v_add_u32 v7, 1, v7
    s_mul_i32 s69, s3, 192
    v_cndmask_b32 v20, 0, v14, vcc
    v_cmp_eq_u32 vcc, v13, v7
    s_lshr_b32 s68, s72, 4
    s_add_u32 s69, s69, s68
    v_cndmask_b32 v21, 0, v14, vcc
    s_mul_i32 s68, s74, 3
    s_add_u32 s69, s69, s68
    s_lshl1_add_u32 s69, s69, s73
    s_lshl_b32 s69, s69, 11
    s_add_u32 s4, s69, 5472256
    s_lshl1_add_u32 s68, s22, s74
    s_cmp_eq_u32 s68, 30
    s_cselect_b32 s70, 1879048192, s4
    s_lshl4_add_u32 s5, s3, s22
    s_lshl_b32 s5, s5, 7
    s_add_u32 s5, s5, 65536
    v_lshrrev_b32 v26, 5, v0
    v_min_u32 v26, 1, v26
    v_lshlrev_b32 v26, 25, v26
    v_lshl_add_u32 v26, v0, 2, v26
    s_lshl_b32 s68, s78, 11
    s_add_u32 s68, s68, 65536
    v_max_u32 v27, 9, v2
    v_lshl_add_u32 v27, v27, 7, s68
    s_waitcnt vmcnt(7)
    v_xor_b32 v13, v59, v118
    s_waitcnt vmcnt(6)
    v_bitop3_b32 v13, v63, v118, v13 bitop3:0xbe
    s_waitcnt vmcnt(5)
    v_bitop3_b32 v13, v67, v119, v13 bitop3:0xbe
    s_waitcnt vmcnt(4)
    v_bitop3_b32 v13, v71, v119, v13 bitop3:0xbe
    s_waitcnt vmcnt(3)
    v_bitop3_b32 v13, v75, v138, v13 bitop3:0xbe
    s_waitcnt vmcnt(2)
    v_bitop3_b32 v13, v79, v138, v13 bitop3:0xbe
    s_waitcnt vmcnt(1)
    v_bitop3_b32 v13, v123, v139, v13 bitop3:0xbe
    s_waitcnt vmcnt(0)
    v_bitop3_b32 v13, v127, v139, v13 bitop3:0xbe
    v_cmp_ne_u32 vcc, 0, v13
    s_cbranch_vccz L_S_eg_ok
    s_mov_b32 s25, 0
L_S_eg_retry:

    s_nop 0
    buffer_load_dwordx4 v[56:59], v30, s[44:47], s67 offen offset:0 sc1
    buffer_load_dwordx4 v[60:63], v30, s[44:47], s67 offen offset:256 sc1
    buffer_load_dwordx4 v[64:67], v31, s[44:47], s67 offen offset:0 sc1
    buffer_load_dwordx4 v[68:71], v31, s[44:47], s67 offen offset:256 sc1
    buffer_load_dwordx4 v[72:75], v116, s[44:47], s67 offen offset:0 sc1
    buffer_load_dwordx4 v[76:79], v116, s[44:47], s67 offen offset:256 sc1
    buffer_load_dwordx4 v[120:123], v117, s[44:47], s67 offen offset:0 sc1
    buffer_load_dwordx4 v[124:127], v117, s[44:47], s67 offen offset:256 sc1
    s_add_u32 s25, s25, 1
    s_waitcnt vmcnt(0)
    v_xor_b32_e64 v13, v59, v118
    v_bitop3_b32 v13, v63, v118, v13 bitop3:0xbe
    v_bitop3_b32 v13, v67, v119, v13 bitop3:0xbe
    v_bitop3_b32 v13, v71, v119, v13 bitop3:0xbe
    v_bitop3_b32 v13, v75, v138, v13 bitop3:0xbe
    v_bitop3_b32 v13, v79, v138, v13 bitop3:0xbe
    v_bitop3_b32 v13, v123, v139, v13 bitop3:0xbe
    v_bitop3_b32 v13, v127, v139, v13 bitop3:0xbe
    v_cmp_ne_u32 vcc, 0, v13
    s_cmp_ge_u32 s25, 100000
    s_cbranch_scc1 L_S_eg_ok
    s_cbranch_vccnz L_S_eg_retry
L_S_eg_ok:
    v_mov_b32 v59, v62
    v_mov_b32 v67, v70
    v_mov_b32 v75, v78
    v_mov_b32_e64 v123, v126
    v_pk_fma_f32 v[28:29], v[98:99], v[120:121], v[72:73] op_sel:[0,0,0] op_sel_hi:[0,1,1]
    v_pk_fma_f32 v[32:33], v[98:99], v[120:121], v[28:29] op_sel:[1,1,0] op_sel_hi:[1,0,1] neg_lo:[1,0,0]
    v_pk_fma_f32 v[28:29], v[98:99], v[32:33], v[64:65] op_sel:[0,0,0] op_sel_hi:[0,1,1]
    v_pk_fma_f32 v[32:33], v[98:99], v[32:33], v[28:29] op_sel:[1,1,0] op_sel_hi:[1,0,1] neg_lo:[1,0,0]
    v_pk_fma_f32 v[28:29], v[98:99], v[32:33], v[56:57] op_sel:[0,0,0] op_sel_hi:[0,1,1]
    v_pk_fma_f32 v[32:33], v[98:99], v[32:33], v[28:29] op_sel:[1,1,0] op_sel_hi:[1,0,1] neg_lo:[1,0,0]
    v_pk_mul_f32 v[28:29], v[104:105], v[32:33] op_sel:[0,0] op_sel_hi:[0,1]
    v_pk_fma_f32 v[32:33], v[104:105], v[32:33], v[28:29] op_sel:[1,1,0] op_sel_hi:[1,0,1] neg_lo:[1,0,0]
    v_pk_fma_f32 v[28:29], v[100:101], v[122:123], v[74:75] op_sel:[0,0,0] op_sel_hi:[0,1,1]
    v_pk_fma_f32 v[34:35], v[100:101], v[122:123], v[28:29] op_sel:[1,1,0] op_sel_hi:[1,0,1] neg_lo:[1,0,0]
    v_pk_fma_f32 v[28:29], v[100:101], v[34:35], v[66:67] op_sel:[0,0,0] op_sel_hi:[0,1,1]
    v_pk_fma_f32 v[34:35], v[100:101], v[34:35], v[28:29] op_sel:[1,1,0] op_sel_hi:[1,0,1] neg_lo:[1,0,0]
    v_pk_fma_f32 v[28:29], v[100:101], v[34:35], v[58:59] op_sel:[0,0,0] op_sel_hi:[0,1,1]
    v_pk_fma_f32 v[34:35], v[100:101], v[34:35], v[28:29] op_sel:[1,1,0] op_sel_hi:[1,0,1] neg_lo:[1,0,0]
    v_pk_mul_f32 v[28:29], v[106:107], v[34:35] op_sel:[0,0] op_sel_hi:[0,1]
    v_pk_fma_f32 v[34:35], v[106:107], v[34:35], v[28:29] op_sel:[1,1,0] op_sel_hi:[1,0,1] neg_lo:[1,0,0]
    v_pk_fma_f32 v[28:29], v[102:103], v[124:125], v[76:77] op_sel:[0,0,0] op_sel_hi:[0,1,1]
    v_pk_fma_f32 v[36:37], v[102:103], v[124:125], v[28:29] op_sel:[1,1,0] op_sel_hi:[1,0,1] neg_lo:[1,0,0]
    v_pk_fma_f32 v[28:29], v[102:103], v[36:37], v[68:69] op_sel:[0,0,0] op_sel_hi:[0,1,1]
    v_pk_fma_f32 v[36:37], v[102:103], v[36:37], v[28:29] op_sel:[1,1,0] op_sel_hi:[1,0,1] neg_lo:[1,0,0]
    v_pk_fma_f32 v[28:29], v[102:103], v[36:37], v[60:61] op_sel:[0,0,0] op_sel_hi:[0,1,1]
    v_pk_fma_f32 v[36:37], v[102:103], v[36:37], v[28:29] op_sel:[1,1,0] op_sel_hi:[1,0,1] neg_lo:[1,0,0]
    v_pk_mul_f32 v[28:29], v[108:109], v[36:37] op_sel:[0,0] op_sel_hi:[0,1]
    v_pk_fma_f32 v[36:37], v[108:109], v[36:37], v[28:29] op_sel:[1,1,0] op_sel_hi:[1,0,1] neg_lo:[1,0,0]
    s_nop 1
    v_permlane32_swap_b32 v32, v36
    v_permlane32_swap_b32 v33, v37
    v_permlane32_swap_b32 v34, v35
    v_pk_add_f32 v[32:33], v[32:33], v[36:37]
    v_add_f32 v34, v34, v35
    v_mov_b32 v28, v32
    v_mov_b32 v29, v33
    v_mov_b32 v35, v34
    v_permlane16_swap_b32 v32, v28
    v_permlane16_swap_b32 v33, v29
    v_permlane16_swap_b32 v34, v35
    v_pk_add_f32 v[80:81], v[32:33], v[28:29]
    v_add_f32 v82, v34, v35
    ds_write_b96 v4, v[80:82]
    s_waitcnt lgkmcnt(0)
    s_barrier
    ds_read_b96 v[80:82], v12
    ds_read_b96 v[84:86], v5
    ds_read_b96 v[88:90], v12 offset:512
    ds_read_b96 v[92:94], v5 offset:512
    s_waitcnt lgkmcnt(2)
    v_pk_add_f32 v[32:33], v[80:81], v[84:85]
    v_add_f32 v34, v82, v86
    v_pk_fma_f32 v[28:29], v[110:111], v[32:33], v[132:133] op_sel:[0,0,0] op_sel_hi:[0,1,1]
    v_pk_fma_f32 v[32:33], v[110:111], v[32:33], v[28:29] op_sel:[1,1,0] op_sel_hi:[1,0,1] neg_lo:[1,0,0]
    s_waitcnt lgkmcnt(0)
    v_pk_add_f32 v[36:37], v[88:89], v[92:93]
    v_add_f32 v35, v90, v94
    v_pk_fma_f32 v[28:29], v[112:113], v[34:35], v[134:135] op_sel:[0,0,0] op_sel_hi:[0,1,1]
    v_pk_fma_f32 v[34:35], v[112:113], v[34:35], v[28:29] op_sel:[1,1,0] op_sel_hi:[1,0,1] neg_lo:[1,0,0]
    v_pk_fma_f32 v[28:29], v[114:115], v[36:37], v[136:137] op_sel:[0,0,0] op_sel_hi:[0,1,1]
    v_pk_fma_f32 v[36:37], v[114:115], v[36:37], v[28:29] op_sel:[1,1,0] op_sel_hi:[1,0,1] neg_lo:[1,0,0]
    v_pk_fma_f32 v[18:19], v[38:39], v[32:33], v[18:19] op_sel:[0,0,0] op_sel_hi:[0,1,1]
    v_pk_fma_f32 v[18:19], v[38:39], v[32:33], v[18:19] op_sel:[1,1,0] op_sel_hi:[1,0,1] neg_lo:[1,0,0]
    v_pk_fma_f32 v[160:161], v[38:39], v[18:19], v[160:161] op_sel:[0,0,0] op_sel_hi:[0,1,1]
    v_pk_fma_f32 v[160:161], v[38:39], v[18:19], v[160:161] op_sel:[1,1,0] op_sel_hi:[1,0,1] neg_lo:[1,0,0]
    v_pk_fma_f32 v[164:165], v[38:39], v[160:161], v[164:165] op_sel:[0,0,0] op_sel_hi:[0,1,1]
    v_pk_fma_f32 v[164:165], v[38:39], v[160:161], v[164:165] op_sel:[1,1,0] op_sel_hi:[1,0,1] neg_lo:[1,0,0]
    v_pk_fma_f32 v[162:163], v[38:39], v[164:165], v[162:163] op_sel:[0,0,0] op_sel_hi:[0,1,1]
    v_pk_fma_f32 v[162:163], v[38:39], v[164:165], v[162:163] op_sel:[1,1,0] op_sel_hi:[1,0,1] neg_lo:[1,0,0]
    s_nop 0
L_SA_pad10:
    s_cbranch_execz L_SA_ret
    v_pk_fma_f32 v[166:167], v[38:39], v[162:163], v[166:167] op_sel:[0,0,0] op_sel_hi:[0,1,1]
    v_pk_fma_f32 v[166:167], v[38:39], v[162:163], v[166:167] op_sel:[1,1,0] op_sel_hi:[1,0,1] neg_lo:[1,0,0]
    v_pk_fma_f32 v[184:185], v[38:39], v[166:167], v[184:185] op_sel:[0,0,0] op_sel_hi:[0,1,1]
    v_pk_fma_f32 v[184:185], v[38:39], v[166:167], v[184:185] op_sel:[1,1,0] op_sel_hi:[1,0,1] neg_lo:[1,0,0]
    v_pk_fma_f32 v[188:189], v[38:39], v[184:185], v[188:189] op_sel:[0,0,0] op_sel_hi:[0,1,1]
    v_pk_fma_f32 v[188:189], v[38:39], v[184:185], v[188:189] op_sel:[1,1,0] op_sel_hi:[1,0,1] neg_lo:[1,0,0]
    v_pk_fma_f32 v[186:187], v[38:39], v[188:189], v[186:187] op_sel:[0,0,0] op_sel_hi:[0,1,1]
    v_pk_fma_f32 v[186:187], v[38:39], v[188:189], v[186:187] op_sel:[1,1,0] op_sel_hi:[1,0,1] neg_lo:[1,0,0]
    v_cvt_pk_bf16_f32 v80, v18, v160
    v_cvt_pk_bf16_f32 v81, v164, v162
    v_cvt_pk_bf16_f32 v82, -v19, -v161
    v_cvt_pk_bf16_f32 v83, -v165, -v163
    v_mfma_f32_16x16x16_bf16 v[56:59], v[80:81], v[20:21], 0
    v_cvt_pk_bf16_f32 v84, v166, v184
    v_cvt_pk_bf16_f32 v85, v188, v186
    v_mfma_f32_16x16x16_bf16 v[60:63], v[82:83], v[20:21], 0
    v_cvt_pk_bf16_f32 v86, -v167, -v185
    v_cvt_pk_bf16_f32 v87, -v189, -v187
    v_mfma_f32_16x16x16_bf16 v[64:67], v[84:85], v[20:21], 0
    s_nop 0
    v_mfma_f32_16x16x16_bf16 v[68:71], v[86:87], v[20:21], 0
    s_nop 0
    v_pk_fma_f32 v[238:239], v[40:41], v[34:35], v[238:239] op_sel:[0,0,0] op_sel_hi:[0,1,1]
    v_pk_fma_f32 v[238:239], v[40:41], v[34:35], v[238:239] op_sel:[1,1,0] op_sel_hi:[1,0,1] neg_lo:[1,0,0]
    v_pk_fma_f32 v[168:169], v[40:41], v[238:239], v[168:169] op_sel:[0,0,0] op_sel_hi:[0,1,1]
    v_pk_fma_f32 v[168:169], v[40:41], v[238:239], v[168:169] op_sel:[1,1,0] op_sel_hi:[1,0,1] neg_lo:[1,0,0]
    v_pk_fma_f32 v[172:173], v[40:41], v[168:169], v[172:173] op_sel:[0,0,0] op_sel_hi:[0,1,1]
    v_pk_fma_f32 v[172:173], v[40:41], v[168:169], v[172:173] op_sel:[1,1,0] op_sel_hi:[1,0,1] neg_lo:[1,0,0]
    v_cvt_pk_bf16_f32 v98, v56, v57
    v_cvt_pk_bf16_f32 v99, v58, v59
    v_cvt_pk_bf16_f32 v100, v60, v61
    v_cvt_pk_bf16_f32 v101, v62, v63
    v_cvt_pk_bf16_f32 v102, v64, v65
    v_cvt_pk_bf16_f32 v103, v66, v67
    v_cvt_pk_bf16_f32 v104, v68, v69
    v_cvt_pk_bf16_f32 v105, v70, v71
    v_pk_fma_f32 v[170:171], v[40:41], v[172:173], v[170:171] op_sel:[0,0,0] op_sel_hi:[0,1,1]
    v_pk_fma_f32 v[170:171], v[40:41], v[172:173], v[170:171] op_sel:[1,1,0] op_sel_hi:[1,0,1] neg_lo:[1,0,0]
    v_pk_fma_f32 v[174:175], v[40:41], v[170:171], v[174:175] op_sel:[0,0,0] op_sel_hi:[0,1,1]
    v_pk_fma_f32 v[174:175], v[40:41], v[170:171], v[174:175] op_sel:[1,1,0] op_sel_hi:[1,0,1] neg_lo:[1,0,0]
    v_pk_fma_f32 v[192:193], v[40:41], v[174:175], v[192:193] op_sel:[0,0,0] op_sel_hi:[0,1,1]
    v_pk_fma_f32 v[192:193], v[40:41], v[174:175], v[192:193] op_sel:[1,1,0] op_sel_hi:[1,0,1] neg_lo:[1,0,0]
    v_pk_fma_f32 v[196:197], v[40:41], v[192:193], v[196:197] op_sel:[0,0,0] op_sel_hi:[0,1,1]
    v_pk_fma_f32 v[196:197], v[40:41], v[192:193], v[196:197] op_sel:[1,1,0] op_sel_hi:[1,0,1] neg_lo:[1,0,0]
    v_pk_fma_f32 v[194:195], v[40:41], v[196:197], v[194:195] op_sel:[0,0,0] op_sel_hi:[0,1,1]
    v_pk_fma_f32 v[194:195], v[40:41], v[196:197], v[194:195] op_sel:[1,1,0] op_sel_hi:[1,0,1] neg_lo:[1,0,0]
    v_cvt_pk_bf16_f32 v80, v238, v168
    v_cvt_pk_bf16_f32 v81, v172, v170
    v_cvt_pk_bf16_f32 v82, -v239, -v169
    v_cvt_pk_bf16_f32 v83, -v173, -v171
    v_mfma_f32_16x16x16_bf16 v[56:59], v[80:81], v[20:21], 0
    v_cvt_pk_bf16_f32 v84, v174, v192
    v_cvt_pk_bf16_f32 v85, v196, v194
    v_mfma_f32_16x16x16_bf16 v[60:63], v[82:83], v[20:21], 0
    v_cvt_pk_bf16_f32 v86, -v175, -v193
    v_cvt_pk_bf16_f32 v87, -v197, -v195
    s_add_u32 s24, s70, 0
    v_mfma_f32_16x16x16_bf16 v[64:67], v[84:85], v[20:21], 0
    buffer_store_dwordx4 v[98:101], v15, s[44:47], s24 offen offset:0 sc1
    v_mfma_f32_16x16x16_bf16 v[68:71], v[86:87], v[20:21], 0
    s_nop 0
    buffer_store_dwordx4 v[102:105], v15, s[44:47], s24 offen offset:1024 sc1
    v_pk_fma_f32 v[246:247], v[42:43], v[36:37], v[246:247] op_sel:[0,0,0] op_sel_hi:[0,1,1]
    v_pk_fma_f32 v[246:247], v[42:43], v[36:37], v[246:247] op_sel:[1,1,0] op_sel_hi:[1,0,1] neg_lo:[1,0,0]
    v_pk_fma_f32 v[176:177], v[42:43], v[246:247], v[176:177] op_sel:[0,0,0] op_sel_hi:[0,1,1]
    v_pk_fma_f32 v[176:177], v[42:43], v[246:247], v[176:177] op_sel:[1,1,0] op_sel_hi:[1,0,1] neg_lo:[1,0,0]
    v_pk_fma_f32 v[180:181], v[42:43], v[176:177], v[180:181] op_sel:[0,0,0] op_sel_hi:[0,1,1]
    v_pk_fma_f32 v[180:181], v[42:43], v[176:177], v[180:181] op_sel:[1,1,0] op_sel_hi:[1,0,1] neg_lo:[1,0,0]
    v_cvt_pk_bf16_f32 v106, v56, v57
    v_cvt_pk_bf16_f32 v107, v58, v59
    v_cvt_pk_bf16_f32 v108, v60, v61
    v_cvt_pk_bf16_f32 v109, v62, v63
    v_cvt_pk_bf16_f32 v110, v64, v65
    v_cvt_pk_bf16_f32 v111, v66, v67
    v_cvt_pk_bf16_f32 v112, v68, v69
    v_cvt_pk_bf16_f32 v113, v70, v71
    v_pk_fma_f32 v[178:179], v[42:43], v[180:181], v[178:179] op_sel:[0,0,0] op_sel_hi:[0,1,1]
    v_pk_fma_f32 v[178:179], v[42:43], v[180:181], v[178:179] op_sel:[1,1,0] op_sel_hi:[1,0,1] neg_lo:[1,0,0]
    v_pk_fma_f32 v[182:183], v[42:43], v[178:179], v[182:183] op_sel:[0,0,0] op_sel_hi:[0,1,1]
    v_pk_fma_f32 v[182:183], v[42:43], v[178:179], v[182:183] op_sel:[1,1,0] op_sel_hi:[1,0,1] neg_lo:[1,0,0]
    v_pk_fma_f32 v[200:201], v[42:43], v[182:183], v[200:201] op_sel:[0,0,0] op_sel_hi:[0,1,1]
    v_pk_fma_f32 v[200:201], v[42:43], v[182:183], v[200:201] op_sel:[1,1,0] op_sel_hi:[1,0,1] neg_lo:[1,0,0]
    v_pk_fma_f32 v[204:205], v[42:43], v[200:201], v[204:205] op_sel:[0,0,0] op_sel_hi:[0,1,1]
    v_pk_fma_f32 v[204:205], v[42:43], v[200:201], v[204:205] op_sel:[1,1,0] op_sel_hi:[1,0,1] neg_lo:[1,0,0]
    v_pk_fma_f32 v[202:203], v[42:43], v[204:205], v[202:203] op_sel:[0,0,0] op_sel_hi:[0,1,1]
    v_pk_fma_f32 v[202:203], v[42:43], v[204:205], v[202:203] op_sel:[1,1,0] op_sel_hi:[1,0,1] neg_lo:[1,0,0]
    v_cvt_pk_bf16_f32 v80, v246, v176
    v_cvt_pk_bf16_f32 v81, v180, v178
    v_cvt_pk_bf16_f32 v82, -v247, -v177
    v_cvt_pk_bf16_f32 v83, -v181, -v179
    v_mfma_f32_16x16x16_bf16 v[56:59], v[80:81], v[20:21], 0
    v_cvt_pk_bf16_f32 v84, v182, v200
    v_cvt_pk_bf16_f32 v85, v204, v202
    v_mfma_f32_16x16x16_bf16 v[60:63], v[82:83], v[20:21], 0
    v_cvt_pk_bf16_f32 v86, -v183, -v201
    v_cvt_pk_bf16_f32 v87, -v205, -v203
    s_add_u32 s24, s70, 4096
    v_mfma_f32_16x16x16_bf16 v[64:67], v[84:85], v[20:21], 0
    buffer_store_dwordx4 v[106:109], v15, s[44:47], s24 offen offset:0 sc1
    v_mfma_f32_16x16x16_bf16 v[68:71], v[86:87], v[20:21], 0
    buffer_store_dwordx4 v[110:113], v15, s[44:47], s24 offen offset:1024 sc1
    v_cvt_pk_bf16_f32 v98, v56, v57
    v_cvt_pk_bf16_f32 v99, v58, v59
    v_cvt_pk_bf16_f32 v100, v60, v61
    v_cvt_pk_bf16_f32 v101, v62, v63
L_SA_pad11:
    s_cbranch_execz L_SA_ret
    s_nop 0
    v_cvt_pk_bf16_f32 v102, v64, v65
    v_cvt_pk_bf16_f32 v103, v66, v67
    v_cvt_pk_bf16_f32 v104, v68, v69
    v_cvt_pk_bf16_f32 v105, v70, v71
    s_add_u32 s24, s4, 8192
    buffer_store_dwordx4 v[98:101], v15, s[44:47], s24 offen offset:0 sc1
    buffer_store_dwordx4 v[102:105], v15, s[44:47], s24 offen offset:1024 sc1
    v_pk_fma_f32 v[190:191], v[38:39], v[186:187], v[190:191] op_sel:[0,0,0] op_sel_hi:[0,1,1]
    v_pk_fma_f32 v[190:191], v[38:39], v[186:187], v[190:191] op_sel:[1,1,0] op_sel_hi:[1,0,1] neg_lo:[1,0,0]
    v_pk_fma_f32 v[208:209], v[38:39], v[190:191], v[208:209] op_sel:[0,0,0] op_sel_hi:[0,1,1]
    v_pk_fma_f32 v[208:209], v[38:39], v[190:191], v[208:209] op_sel:[1,1,0] op_sel_hi:[1,0,1] neg_lo:[1,0,0]
    v_pk_fma_f32 v[212:213], v[38:39], v[208:209], v[212:213] op_sel:[0,0,0] op_sel_hi:[0,1,1]
    v_pk_fma_f32 v[212:213], v[38:39], v[208:209], v[212:213] op_sel:[1,1,0] op_sel_hi:[1,0,1] neg_lo:[1,0,0]
    v_pk_fma_f32 v[210:211], v[38:39], v[212:213], v[210:211] op_sel:[0,0,0] op_sel_hi:[0,1,1]
    v_pk_fma_f32 v[210:211], v[38:39], v[212:213], v[210:211] op_sel:[1,1,0] op_sel_hi:[1,0,1] neg_lo:[1,0,0]
    v_pk_fma_f32 v[214:215], v[38:39], v[210:211], v[214:215] op_sel:[0,0,0] op_sel_hi:[0,1,1]
    v_pk_fma_f32 v[214:215], v[38:39], v[210:211], v[214:215] op_sel:[1,1,0] op_sel_hi:[1,0,1] neg_lo:[1,0,0]
    v_pk_fma_f32 v[232:233], v[38:39], v[214:215], v[232:233] op_sel:[0,0,0] op_sel_hi:[0,1,1]
    v_pk_fma_f32 v[232:233], v[38:39], v[214:215], v[232:233] op_sel:[1,1,0] op_sel_hi:[1,0,1] neg_lo:[1,0,0]
    v_pk_fma_f32 v[236:237], v[38:39], v[232:233], v[236:237] op_sel:[0,0,0] op_sel_hi:[0,1,1]
    v_pk_fma_f32 v[236:237], v[38:39], v[232:233], v[236:237] op_sel:[1,1,0] op_sel_hi:[1,0,1] neg_lo:[1,0,0]
    v_pk_fma_f32 v[234:235], v[38:39], v[236:237], v[234:235] op_sel:[0,0,0] op_sel_hi:[0,1,1]
    v_pk_fma_f32 v[234:235], v[38:39], v[236:237], v[234:235] op_sel:[1,1,0] op_sel_hi:[1,0,1] neg_lo:[1,0,0]
    v_cvt_pk_bf16_f32 v80, v190, v208
    v_cvt_pk_bf16_f32 v81, v212, v210
    v_cvt_pk_bf16_f32 v82, -v191, -v209
    v_cvt_pk_bf16_f32 v83, -v213, -v211
    v_mfma_f32_16x16x16_bf16 v[56:59], v[80:81], v[20:21], 0
    v_cvt_pk_bf16_f32 v84, v214, v232
    v_cvt_pk_bf16_f32 v85, v236, v234
    v_mfma_f32_16x16x16_bf16 v[60:63], v[82:83], v[20:21], 0
    v_cvt_pk_bf16_f32 v86, -v215, -v233
    v_cvt_pk_bf16_f32 v87, -v237, -v235
    v_mfma_f32_16x16x16_bf16 v[64:67], v[84:85], v[20:21], 0
    s_nop 0
    v_mfma_f32_16x16x16_bf16 v[68:71], v[86:87], v[20:21], 0
    s_nop 0
    v_pk_fma_f32 v[198:199], v[40:41], v[194:195], v[198:199] op_sel:[0,0,0] op_sel_hi:[0,1,1]
    v_pk_fma_f32 v[198:199], v[40:41], v[194:195], v[198:199] op_sel:[1,1,0] op_sel_hi:[1,0,1] neg_lo:[1,0,0]
    v_pk_fma_f32 v[216:217], v[40:41], v[198:199], v[216:217] op_sel:[0,0,0] op_sel_hi:[0,1,1]
    v_pk_fma_f32 v[216:217], v[40:41], v[198:199], v[216:217] op_sel:[1,1,0] op_sel_hi:[1,0,1] neg_lo:[1,0,0]
    v_pk_fma_f32 v[220:221], v[40:41], v[216:217], v[220:221] op_sel:[0,0,0] op_sel_hi:[0,1,1]
    v_pk_fma_f32 v[220:221], v[40:41], v[216:217], v[220:221] op_sel:[1,1,0] op_sel_hi:[1,0,1] neg_lo:[1,0,0]
    v_cvt_pk_bf16_f32 v106, v56, v57
    v_cvt_pk_bf16_f32 v107, v58, v59
    v_cvt_pk_bf16_f32 v108, v60, v61
    v_cvt_pk_bf16_f32 v109, v62, v63
    v_cvt_pk_bf16_f32 v110, v64, v65
    v_cvt_pk_bf16_f32 v111, v66, v67
    v_cvt_pk_bf16_f32 v112, v68, v69
    v_cvt_pk_bf16_f32 v113, v70, v71
    v_pk_fma_f32 v[218:219], v[40:41], v[220:221], v[218:219] op_sel:[0,0,0] op_sel_hi:[0,1,1]
    v_pk_fma_f32 v[218:219], v[40:41], v[220:221], v[218:219] op_sel:[1,1,0] op_sel_hi:[1,0,1] neg_lo:[1,0,0]
    v_pk_fma_f32 v[222:223], v[40:41], v[218:219], v[222:223] op_sel:[0,0,0] op_sel_hi:[0,1,1]
    v_pk_fma_f32 v[222:223], v[40:41], v[218:219], v[222:223] op_sel:[1,1,0] op_sel_hi:[1,0,1] neg_lo:[1,0,0]
    v_pk_fma_f32 v[240:241], v[40:41], v[222:223], v[240:241] op_sel:[0,0,0] op_sel_hi:[0,1,1]
    v_pk_fma_f32 v[240:241], v[40:41], v[222:223], v[240:241] op_sel:[1,1,0] op_sel_hi:[1,0,1] neg_lo:[1,0,0]
    v_pk_fma_f32 v[244:245], v[40:41], v[240:241], v[244:245] op_sel:[0,0,0] op_sel_hi:[0,1,1]
    v_pk_fma_f32 v[244:245], v[40:41], v[240:241], v[244:245] op_sel:[1,1,0] op_sel_hi:[1,0,1] neg_lo:[1,0,0]
    v_pk_fma_f32 v[242:243], v[40:41], v[244:245], v[242:243] op_sel:[0,0,0] op_sel_hi:[0,1,1]
    v_pk_fma_f32 v[242:243], v[40:41], v[244:245], v[242:243] op_sel:[1,1,0] op_sel_hi:[1,0,1] neg_lo:[1,0,0]
    v_cvt_pk_bf16_f32 v80, v198, v216
    v_cvt_pk_bf16_f32 v81, v220, v218
    v_cvt_pk_bf16_f32 v82, -v199, -v217
    v_cvt_pk_bf16_f32 v83, -v221, -v219
    v_mfma_f32_16x16x16_bf16 v[56:59], v[80:81], v[20:21], 0
    v_cvt_pk_bf16_f32 v84, v222, v240
    v_cvt_pk_bf16_f32 v85, v244, v242
    v_mfma_f32_16x16x16_bf16 v[60:63], v[82:83], v[20:21], 0
    v_cvt_pk_bf16_f32 v86, -v223, -v241
    v_cvt_pk_bf16_f32 v87, -v245, -v243
    s_add_u32 s24, s70, 393216
    v_mfma_f32_16x16x16_bf16 v[64:67], v[84:85], v[20:21], 0
    buffer_store_dwordx4 v[106:109], v15, s[44:47], s24 offen offset:0 sc1
    v_mfma_f32_16x16x16_bf16 v[68:71], v[86:87], v[20:21], 0
    buffer_store_dwordx4 v[110:113], v15, s[44:47], s24 offen offset:1024 sc1
    v_pk_fma_f32 v[206:207], v[42:43], v[202:203], v[206:207] op_sel:[0,0,0] op_sel_hi:[0,1,1]
    v_pk_fma_f32 v[206:207], v[42:43], v[202:203], v[206:207] op_sel:[1,1,0] op_sel_hi:[1,0,1] neg_lo:[1,0,0]
    v_pk_fma_f32 v[224:225], v[42:43], v[206:207], v[224:225] op_sel:[0,0,0] op_sel_hi:[0,1,1]
    v_pk_fma_f32 v[224:225], v[42:43], v[206:207], v[224:225] op_sel:[1,1,0] op_sel_hi:[1,0,1] neg_lo:[1,0,0]
    v_pk_fma_f32 v[228:229], v[42:43], v[224:225], v[228:229] op_sel:[0,0,0] op_sel_hi:[0,1,1]
    v_pk_fma_f32 v[228:229], v[42:43], v[224:225], v[228:229] op_sel:[1,1,0] op_sel_hi:[1,0,1] neg_lo:[1,0,0]
    v_cvt_pk_bf16_f32 v98, v56, v57
    v_cvt_pk_bf16_f32 v99, v58, v59
    v_cvt_pk_bf16_f32 v100, v60, v61
    v_cvt_pk_bf16_f32 v101, v62, v63
    v_cvt_pk_bf16_f32 v102, v64, v65
    v_cvt_pk_bf16_f32 v103, v66, v67
    v_cvt_pk_bf16_f32 v104, v68, v69
    v_cvt_pk_bf16_f32 v105, v70, v71
    s_waitcnt vmcnt(2)
    s_barrier
    buffer_store_dword v16, v26, s[44:47], s5 offen sc1
    v_pk_fma_f32 v[226:227], v[42:43], v[228:229], v[226:227] op_sel:[0,0,0] op_sel_hi:[0,1,1]
    v_pk_fma_f32 v[226:227], v[42:43], v[228:229], v[226:227] op_sel:[1,1,0] op_sel_hi:[1,0,1] neg_lo:[1,0,0]
    v_pk_fma_f32 v[230:231], v[42:43], v[226:227], v[230:231] op_sel:[0,0,0] op_sel_hi:[0,1,1]
    v_pk_fma_f32 v[230:231], v[42:43], v[226:227], v[230:231] op_sel:[1,1,0] op_sel_hi:[1,0,1] neg_lo:[1,0,0]
    v_pk_fma_f32 v[248:249], v[42:43], v[230:231], v[248:249] op_sel:[0,0,0] op_sel_hi:[0,1,1]
    v_pk_fma_f32 v[248:249], v[42:43], v[230:231], v[248:249] op_sel:[1,1,0] op_sel_hi:[1,0,1] neg_lo:[1,0,0]
    v_pk_fma_f32 v[252:253], v[42:43], v[248:249], v[252:253] op_sel:[0,0,0] op_sel_hi:[0,1,1]
    v_pk_fma_f32 v[252:253], v[42:43], v[248:249], v[252:253] op_sel:[1,1,0] op_sel_hi:[1,0,1] neg_lo:[1,0,0]
    v_pk_fma_f32 v[250:251], v[42:43], v[252:253], v[250:251] op_sel:[0,0,0] op_sel_hi:[0,1,1]
    v_pk_fma_f32 v[250:251], v[42:43], v[252:253], v[250:251] op_sel:[1,1,0] op_sel_hi:[1,0,1] neg_lo:[1,0,0]
    v_cvt_pk_bf16_f32 v80, v206, v224
    v_cvt_pk_bf16_f32 v81, v228, v226
    v_cvt_pk_bf16_f32 v82, -v207, -v225
    v_cvt_pk_bf16_f32 v83, -v229, -v227
    v_mfma_f32_16x16x16_bf16 v[56:59], v[80:81], v[20:21], 0
    v_cvt_pk_bf16_f32 v84, v230, v248
    v_cvt_pk_bf16_f32 v85, v252, v250
    v_mfma_f32_16x16x16_bf16 v[60:63], v[82:83], v[20:21], 0
    v_cvt_pk_bf16_f32 v86, -v231, -v249
    v_cvt_pk_bf16_f32 v87, -v253, -v251
    s_add_u32 s24, s70, 397312
    v_mfma_f32_16x16x16_bf16 v[64:67], v[84:85], v[20:21], 0
    buffer_store_dwordx4 v[98:101], v15, s[44:47], s24 offen offset:0 sc1
    v_mfma_f32_16x16x16_bf16 v[68:71], v[86:87], v[20:21], 0
    buffer_store_dwordx4 v[102:105], v15, s[44:47], s24 offen offset:1024 sc1
    v_cvt_pk_bf16_f32 v106, v56, v57
    v_cvt_pk_bf16_f32 v107, v58, v59
    v_cvt_pk_bf16_f32 v108, v60, v61
    v_cvt_pk_bf16_f32 v109, v62, v63
    s_nop 0
    s_nop 0
    v_cvt_pk_bf16_f32 v110, v64, v65
    v_cvt_pk_bf16_f32 v111, v66, v67
    v_cvt_pk_bf16_f32 v112, v68, v69
    v_cvt_pk_bf16_f32 v113, v70, v71
    s_add_u32 s24, s4, 401408
    buffer_store_dwordx4 v[106:109], v15, s[44:47], s24 offen offset:0 sc1
    buffer_store_dwordx4 v[110:113], v15, s[44:47], s24 offen offset:1024 sc1
    s_add_u32 s81, s76, 163840
    buffer_load_dwordx4 a[160:163], v15, s[44:47], s81 offen offset:0 sc1
    buffer_load_dwordx4 a[164:167], v15, s[44:47], s81 offen offset:1024 sc1
    buffer_load_dwordx4 a[168:171], v15, s[44:47], s81 offen offset:2048 sc1
    buffer_load_dwordx4 a[172:175], v15, s[44:47], s81 offen offset:3072 sc1
    s_add_u32 s81, s81, 4096
    buffer_load_dwordx4 a[176:179], v15, s[44:47], s81 offen offset:0 sc1
L_Y_join:
L_SA_pad12:
    s_cbranch_execz L_SA_ret
    s_add_u32 s67, s60, 0
    s_add_u32 s81, s76, 184320
    buffer_load_dwordx4 a[180:183], v15, s[44:47], s81 offen offset:0 sc1
    s_and_b32 s67, s67, 3
    s_lshl_b32 s68, s67, 10
    v_add_u32 v1, s68, v15
    s_add_u32 s67, s60, 1
    s_and_b32 s67, s67, 3
    s_lshl_b32 s68, s67, 10
    v_add_u32 v18, s68, v15
    s_add_u32 s67, s60, 2
    s_and_b32 s67, s67, 3
    s_mul_i32 s68, s67, 30720
    s_add_u32 s68, s68, 0
    buffer_load_dwordx4 a[184:187], v15, s[44:47], s81 offen offset:1024 sc1
    v_add_u32 v21, s68, v15
    s_add_u32 s67, s60, 2
    s_and_b32 s67, s67, 3
    s_lshl_b32 s68, s67, 10
    v_add_u32 v19, s68, v15
    s_add_u32 s67, s60, 2
    s_and_b32 s67, s67, 3
    s_mul_i32 s68, s67, 30720
    s_add_u32 s68, s68, 5120
    v_add_u32 v22, s68, v15
    s_add_u32 s67, s60, 3
    buffer_load_dwordx4 a[188:191], v15, s[44:47], s81 offen offset:2048 sc1
    s_and_b32 s67, s67, 3
    s_lshl_b32 s68, s67, 10
    v_add_u32 v20, s68, v15
    s_add_u32 s67, s60, 1
    s_and_b32 s67, s67, 3
    s_mul_i32 s68, s67, 30720
    s_add_u32 s68, s68, 10240
    v_add_u32 v23, s68, v15
    v_add_u32 v24, s61, v15
    s_lshl_b32 s64, s73, 13
    s_sub_u32 s64, s77, s64
    buffer_load_dwordx4 a[192:195], v15, s[44:47], s81 offen offset:3072 sc1
    v_lshl_add_u32 v12, v3, 4, s80
    v_bfe_u32 v13, v0, 3, 2
    v_bfe_u32 v14, v0, 1, 2
    v_lshl_add_u32 v13, v13, 4, v14
    v_and_b32 v14, 1, v0
    v_lshlrev_b32 v14, 2, v14
    v_lshl_add_u32 v13, v13, 4, v14
    s_lshl_b32 s70, s80, 4
    s_add_u32 s70, s70, 32768
    s_lshl_b32 s67, s60, 8
    s_add_u32 m0, s67, 126976
    s_add_u32 s81, s81, 4096
    buffer_load_dwordx4 a[196:199], v15, s[44:47], s81 offen offset:0 sc1
    v_lshl_add_u32 v14, v3, 5, m0
    v_mov_b32 v7, 163328
    v_lshl_add_u32 v6, v2, 3, v7
    v_lshl_add_u32 v7, v2, 1, v7
    s_mul_i32 s69, s60, 3072
    s_add_u32 s69, s69, 131072
    v_mul_u32_u24 v5, 640, v3
    v_add_u32 v5, s69, v5
    v_lshl_add_u32 v4, v2, 3, v5
    v_lshl_add_u32 v5, v2, 1, v5
    s_mov_b64 exec, 0
    s_cmp_eq_u32 s60, 0
    s_cbranch_scc1 L_SB_pad0
    s_cmp_eq_u32 s60, 1
    s_cbranch_scc1 L_SB_pad1
    s_cmp_eq_u32 s60, 2
    s_cbranch_scc1 L_SB_pad2
    s_branch L_SB_pad3
L_SB_ret:
    s_mov_b64 exec, -1
    buffer_load_dword v8, v27, s[44:47], 0 offen sc1
    s_waitcnt vmcnt(0)
    v_cmp_ne_u32 vcc, s66, v8
    s_cbranch_vccz L_S_f1a_ok
    s_mov_b32 s25, 0
L_S_f1a_retry:

    buffer_load_dword v8, v27, s[44:47], 0 offen sc1
    s_add_u32 s25, s25, 1
    s_waitcnt vmcnt(0)
    v_cmp_ne_u32 vcc, s66, v8
    s_cmp_ge_u32 s25, 100000
    s_cbranch_scc1 L_S_f1a_ok
    s_cbranch_vccnz L_S_f1a_retry
L_S_f1a_ok:
    s_add_u32 s65, s77, 0
    buffer_load_dwordx4 v[32:35], v18, s[44:47], s65 offen sc1
    s_add_u32 s65, s77, 16384
    buffer_load_dwordx4 v[36:39], v18, s[44:47], s65 offen sc1
    s_add_u32 s65, s77, 32768
    buffer_load_dwordx4 v[40:43], v18, s[44:47], s65 offen sc1
    s_add_u32 s65, s77, 49152
    buffer_load_dwordx4 v[44:47], v18, s[44:47], s65 offen sc1
    s_add_u32 s65, s77, 65536
    buffer_load_dwordx4 v[48:51], v18, s[44:47], s65 offen sc1
    s_add_u32 s65, s77, 81920
    buffer_load_dwordx4 v[52:55], v18, s[44:47], s65 offen sc1
    s_add_u32 s5, s5, 65536
    s_barrier
    buffer_store_dword v16, v26, s[44:47], s5 offen sc1
    s_add_u32 s65, s77, 98304
    buffer_load_dwordx4 v[56:59], v18, s[44:47], s65 offen sc1
    s_add_u32 s65, s77, 114688
    buffer_load_dwordx4 v[60:63], v18, s[44:47], s65 offen sc1
    s_add_u32 s65, s77, 131072
    buffer_load_dwordx4 v[64:67], v18, s[44:47], s65 offen sc1
    s_waitcnt vmcnt(9)
    v_mfma_f32_16x16x32_bf16 v[116:119], v[32:35], a[0:3], 0
    s_add_u32 s65, s77, 147456
    s_waitcnt vmcnt(8)
    v_mfma_f32_16x16x32_bf16 v[116:119], v[36:39], a[20:23], v[116:119]
    buffer_load_dwordx4 v[68:71], v18, s[44:47], s65 offen sc1
    v_mfma_f32_16x16x32_bf16 v[120:123], v[32:35], a[4:7], 0
    ds_read_b64 v[112:113], v6 offset:256
    s_add_u32 s65, s77, 0
    v_mfma_f32_16x16x32_bf16 v[120:123], v[36:39], a[24:27], v[120:123]
    buffer_load_dwordx4 v[72:75], v19, s[44:47], s65 offen sc1
    v_mfma_f32_16x16x32_bf16 v[124:127], v[32:35], a[8:11], 0
    ds_read_u16 v114, v7 offset:384
    s_add_u32 s65, s77, 16384
    v_mfma_f32_16x16x32_bf16 v[124:127], v[36:39], a[28:31], v[124:127]
    ds_read2_b64 v[96:99], v4 offset0:0 offset1:20
    v_mfma_f32_16x16x32_bf16 v[128:131], v[32:35], a[12:15], 0
    buffer_load_dwordx4 v[76:79], v19, s[44:47], s65 offen sc1
    v_mfma_f32_16x16x32_bf16 v[128:131], v[36:39], a[32:35], v[128:131]
    ds_read2_b64 v[100:103], v4 offset0:40 offset1:60
    s_add_u32 s65, s77, 32768
    v_mfma_f32_16x16x32_bf16 v[132:135], v[32:35], a[16:19], 0
    buffer_load_dwordx4 v[80:83], v19, s[44:47], s65 offen sc1
    v_mfma_f32_16x16x32_bf16 v[132:135], v[36:39], a[36:39], v[132:135]
    s_waitcnt vmcnt(10)
    s_add_u32 s65, s77, 49152
    v_mfma_f32_16x16x32_bf16 v[116:119], v[40:43], a[40:43], v[116:119]
    ds_read_u16 v104, v5 offset:128
    v_mfma_f32_16x16x32_bf16 v[116:119], v[44:47], a[60:63], v[116:119]
    buffer_load_dwordx4 v[84:87], v19, s[44:47], s65 offen sc1
    v_mfma_f32_16x16x32_bf16 v[120:123], v[44:47], a[64:67], v[120:123]
    ds_read_u16 v105, v5 offset:288
    s_add_u32 s65, s77, 65536
    v_mfma_f32_16x16x32_bf16 v[120:123], v[40:43], a[44:47], v[120:123]
    buffer_load_dword v13, s[44:47], s70 offen sc1 lds
    v_mfma_f32_16x16x32_bf16 v[124:127], v[40:43], a[48:51], v[124:127]
    ds_read_u16 v106, v5 offset:448
    v_mfma_f32_16x16x32_bf16 v[124:127], v[44:47], a[68:71], v[124:127]
    buffer_load_dwordx4 v[88:91], v19, s[44:47], s65 offen sc1
    v_mfma_f32_16x16x32_bf16 v[128:131], v[44:47], a[72:75], v[128:131]
    ds_read_u16 v107, v5 offset:608
    s_add_u32 s65, s77, 81920
    v_mfma_f32_16x16x32_bf16 v[128:131], v[40:43], a[52:55], v[128:131]
    buffer_load_dwordx4 v[92:95], v19, s[44:47], s65 offen sc1
    v_mfma_f32_16x16x32_bf16 v[132:135], v[40:43], a[56:59], v[132:135]
    s_add_u32 s65, s77, 98304
    v_mfma_f32_16x16x32_bf16 v[132:135], v[44:47], a[76:79], v[132:135]
    s_waitcnt vmcnt(12)
    buffer_load_dwordx4 v[32:35], v19, s[44:47], s65 offen sc1
    v_mfma_f32_16x16x32_bf16 v[116:119], v[48:51], a[80:83], v[116:119]
    s_add_u32 s65, s77, 114688
    s_waitcnt lgkmcnt(0)
    v_lshlrev_b32 v184, 16, v112
    v_mfma_f32_16x16x32_bf16 v[116:119], v[52:55], a[100:103], v[116:119]
    buffer_load_dwordx4 v[36:39], v19, s[44:47], s65 offen sc1
    v_mfma_f32_16x16x32_bf16 v[120:123], v[52:55], a[104:107], v[120:123]
    s_add_u32 s65, s77, 131072
    v_and_b32 v185, 0xffff0000, v112
    v_lshlrev_b32 v186, 16, v113
    v_mfma_f32_16x16x32_bf16 v[120:123], v[48:51], a[84:87], v[120:123]
    buffer_load_dwordx4 v[40:43], v19, s[44:47], s65 offen sc1
    v_mfma_f32_16x16x32_bf16 v[124:127], v[48:51], a[88:91], v[124:127]
    s_add_u32 s65, s77, 147456
L_SB_pad0:
    s_cbranch_execz L_SB_pad4
    v_and_b32 v187, 0xffff0000, v113
    v_lshlrev_b32 v188, 16, v114
    v_mfma_f32_16x16x32_bf16 v[124:127], v[52:55], a[108:111], v[124:127]
    buffer_load_dwordx4 v[44:47], v19, s[44:47], s65 offen sc1
    v_mfma_f32_16x16x32_bf16 v[128:131], v[52:55], a[112:115], v[128:131]
    s_add_u32 s65, s77, 0
    v_lshlrev_b32 v196, 16, v96
    v_and_b32 v200, 0xffff0000, v96
    v_mfma_f32_16x16x32_bf16 v[128:131], v[48:51], a[92:95], v[128:131]
    v_lshlrev_b32 v204, 16, v97
    v_and_b32 v208, 0xffff0000, v97
    v_mfma_f32_16x16x32_bf16 v[132:135], v[48:51], a[96:99], v[132:135]
    v_lshlrev_b32 v212, 16, v104
    v_lshlrev_b32 v197, 16, v98
    v_mfma_f32_16x16x32_bf16 v[132:135], v[52:55], a[116:119], v[132:135]
    s_waitcnt vmcnt(13)
    v_and_b32 v201, 0xffff0000, v98
    v_lshlrev_b32 v205, 16, v99
    v_mfma_f32_16x16x32_bf16 v[116:119], v[56:59], a[120:123], v[116:119]
    buffer_load_dwordx4 v[48:51], v20, s[44:47], s65 offen sc1
    v_mfma_f32_16x16x32_bf16 v[116:119], v[60:63], a[140:143], v[116:119]
    s_add_u32 s65, s77, 16384
    v_and_b32 v209, 0xffff0000, v99
    v_lshlrev_b32 v213, 16, v105
    v_mfma_f32_16x16x32_bf16 v[120:123], v[60:63], a[144:147], v[120:123]
    v_lshlrev_b32 v198, 16, v100
    v_and_b32 v202, 0xffff0000, v100
    v_mfma_f32_16x16x32_bf16 v[120:123], v[56:59], a[124:127], v[120:123]
    v_lshlrev_b32 v206, 16, v101
    v_and_b32 v210, 0xffff0000, v101
    v_mfma_f32_16x16x32_bf16 v[124:127], v[56:59], a[128:131], v[124:127]
    v_lshlrev_b32 v214, 16, v106
    v_lshlrev_b32 v199, 16, v102
    v_mfma_f32_16x16x32_bf16 v[124:127], v[60:63], a[148:151], v[124:127]
    buffer_load_dwordx4 v[52:55], v20, s[44:47], s65 offen sc1
    v_mfma_f32_16x16x32_bf16 v[128:131], v[60:63], a[152:155], v[128:131]
    s_add_u32 s65, s77, 32768
    v_and_b32 v203, 0xffff0000, v102
    v_lshlrev_b32 v207, 16, v103
    v_mfma_f32_16x16x32_bf16 v[128:131], v[56:59], a[132:135], v[128:131]
    v_and_b32 v211, 0xffff0000, v103
    v_lshlrev_b32 v215, 16, v107
    v_mfma_f32_16x16x32_bf16 v[132:135], v[56:59], a[136:139], v[132:135]
    s_mov_b32 s56, s32
    s_mov_b32 s57, s33
    s_mov_b32 s58, 5242880
    v_mfma_f32_16x16x32_bf16 v[132:135], v[60:63], a[156:159], v[132:135]
    s_waitcnt vmcnt(13)
    s_mov_b32 s59, 0x20000
    v_mul_u32_u24 v13, 2560, v12
    v_mfma_f32_16x16x32_bf16 v[116:119], v[64:67], a[160:163], v[116:119]
    buffer_load_dwordx4 v[56:59], v20, s[44:47], s65 offen sc1
    v_mfma_f32_16x16x32_bf16 v[116:119], v[68:71], a[180:183], v[116:119]
    s_add_u32 s65, s77, 49152
    v_lshl_add_u32 v4, v2, 4, v13
    v_lshl_add_u32 v5, v2, 2, v13
    v_mfma_f32_16x16x32_bf16 v[120:123], v[68:71], a[184:187], v[120:123]
    v_add_u32 v6, 5120, v4
    v_add_u32 v7, 5120, v5
    v_mfma_f32_16x16x32_bf16 v[120:123], v[64:67], a[164:167], v[120:123]
    s_mul_i32 s69, s79, 320
    s_lshl2_add_u32 s62, s2, s60
    s_xor_b32 s63, s62, 512
    v_mfma_f32_16x16x32_bf16 v[124:127], v[64:67], a[168:171], v[124:127]
    s_mul_i32 s62, s62, 3072
    s_mul_i32 s63, s63, 3072
    s_add_u32 s62, s62, 19922944
    v_mfma_f32_16x16x32_bf16 v[124:127], v[68:71], a[188:191], v[124:127]
    buffer_load_dwordx4 v[60:63], v20, s[44:47], s65 offen sc1
    v_mfma_f32_16x16x32_bf16 v[128:131], v[68:71], a[192:195], v[128:131]
    s_add_u32 s65, s77, 65536
    s_add_u32 s63, s63, 19922944
    v_add_u32 v27, 65536, v27
    v_mfma_f32_16x16x32_bf16 v[128:131], v[64:67], a[172:175], v[128:131]
    v_mfma_f32_16x16x32_bf16 v[132:135], v[64:67], a[176:179], v[132:135]
    v_mfma_f32_16x16x32_bf16 v[132:135], v[68:71], a[196:199], v[132:135]
    s_waitcnt vmcnt(13)
    v_mfma_f32_16x16x32_bf16 v[136:139], v[72:75], a[0:3], 0
    buffer_load_dwordx4 v[64:67], v20, s[44:47], s65 offen sc1
    v_mfma_f32_16x16x32_bf16 v[136:139], v[76:79], a[20:23], v[136:139]
    s_add_u32 s65, s77, 81920
    v_mfma_f32_16x16x32_bf16 v[140:143], v[72:75], a[4:7], 0
    v_mfma_f32_16x16x32_bf16 v[140:143], v[76:79], a[24:27], v[140:143]
    ds_write_b128 v24, v[116:119] offset:0
    v_mfma_f32_16x16x32_bf16 v[144:147], v[72:75], a[8:11], 0
    v_mfma_f32_16x16x32_bf16 v[144:147], v[76:79], a[28:31], v[144:147]
    buffer_load_dwordx4 v[68:71], v20, s[44:47], s65 offen sc1
    v_mfma_f32_16x16x32_bf16 v[148:151], v[72:75], a[12:15], 0
    s_add_u32 s65, s77, 98304
    v_mfma_f32_16x16x32_bf16 v[148:151], v[76:79], a[32:35], v[148:151]
    ds_write_b128 v24, v[120:123] offset:1024
    v_mfma_f32_16x16x32_bf16 v[152:155], v[72:75], a[16:19], 0
    v_mfma_f32_16x16x32_bf16 v[152:155], v[76:79], a[36:39], v[152:155]
    s_waitcnt vmcnt(13)
    v_mfma_f32_16x16x32_bf16 v[136:139], v[80:83], a[40:43], v[136:139]
    ds_write_b128 v24, v[124:127] offset:2048
    v_mfma_f32_16x16x32_bf16 v[136:139], v[84:87], a[60:63], v[136:139]
    buffer_load_dwordx4 v[72:75], v20, s[44:47], s65 offen sc1
    v_mfma_f32_16x16x32_bf16 v[140:143], v[84:87], a[64:67], v[140:143]
    buffer_load_dword v8, v27, s[44:47], 0 offen sc1
    v_mfma_f32_16x16x32_bf16 v[140:143], v[80:83], a[44:47], v[140:143]
    s_waitcnt vmcnt(14)
    ds_read_b128 v[176:179], v14
    v_mfma_f32_16x16x32_bf16 v[144:147], v[80:83], a[48:51], v[144:147]
    ds_write_b128 v24, v[128:131] offset:3072
    v_mfma_f32_16x16x32_bf16 v[144:147], v[84:87], a[68:71], v[144:147]
    ds_read_b128 v[180:183], v14 offset:16
    s_add_u32 s65, s77, 114688
    v_mfma_f32_16x16x32_bf16 v[148:151], v[84:87], a[72:75], v[148:151]
    buffer_load_dwordx4 v[76:79], v20, s[44:47], s65 offen sc1
    v_mfma_f32_16x16x32_bf16 v[148:151], v[80:83], a[52:55], v[148:151]
    ds_write_b128 v24, v[132:135] offset:4096
    v_mfma_f32_16x16x32_bf16 v[152:155], v[80:83], a[56:59], v[152:155]
    s_add_u32 s65, s77, 131072
    v_mfma_f32_16x16x32_bf16 v[152:155], v[84:87], a[76:79], v[152:155]
    s_waitcnt vmcnt(13)
    v_mfma_f32_16x16x32_bf16 v[136:139], v[88:91], a[80:83], v[136:139]
    buffer_load_dwordx4 v[80:83], v20, s[44:47], s65 offen sc1
    v_mfma_f32_16x16x32_bf16 v[136:139], v[92:95], a[100:103], v[136:139]
    v_mfma_f32_16x16x32_bf16 v[140:143], v[92:95], a[104:107], v[140:143]
    v_mfma_f32_16x16x32_bf16 v[140:143], v[88:91], a[84:87], v[140:143]
    v_mfma_f32_16x16x32_bf16 v[144:147], v[88:91], a[88:91], v[144:147]
    s_waitcnt lgkmcnt(0)
    s_barrier
    v_mfma_f32_16x16x32_bf16 v[144:147], v[92:95], a[108:111], v[144:147]
    ds_read_b128 v[156:159], v21 offset:0
    s_add_u32 s65, s77, 147456
    v_mfma_f32_16x16x32_bf16 v[148:151], v[92:95], a[112:115], v[148:151]
    buffer_load_dwordx4 v[84:87], v20, s[44:47], s65 offen sc1
    v_mfma_f32_16x16x32_bf16 v[148:151], v[88:91], a[92:95], v[148:151]
    ds_read_b128 v[160:163], v21 offset:1024
    s_add_u32 s65, s77, 0
    v_mfma_f32_16x16x32_bf16 v[152:155], v[88:91], a[96:99], v[152:155]
    v_fma_f32 v216, v196, v176, -v177
    v_fma_f32 v220, v200, v176, -v177
    v_mfma_f32_16x16x32_bf16 v[152:155], v[92:95], a[116:119], v[152:155]
    s_waitcnt vmcnt(13)
    v_fma_f32 v224, v204, v176, -v177
    v_fma_f32 v228, v208, v176, -v177
    v_mfma_f32_16x16x32_bf16 v[136:139], v[32:35], a[120:123], v[136:139]
    ds_read_b128 v[164:167], v21 offset:2048
    v_fma_f32 v232, v212, v176, -v177
    v_mfma_f32_16x16x32_bf16 v[136:139], v[36:39], a[140:143], v[136:139]
    ds_read_b128 v[168:171], v21 offset:3072
    v_mul_f32 v216, v216, v184
    v_mfma_f32_16x16x32_bf16 v[140:143], v[36:39], a[144:147], v[140:143]
    buffer_load_dwordx4 v[88:91], v1, s[44:47], s65 offen sc1
    v_mfma_f32_16x16x32_bf16 v[140:143], v[32:35], a[124:127], v[140:143]
    ds_read_b128 v[172:175], v21 offset:4096
L_SB_pad1:
    s_cbranch_execz L_SB_pad5
    s_add_u32 s65, s77, 16384
    v_mfma_f32_16x16x32_bf16 v[144:147], v[32:35], a[128:131], v[144:147]
    v_mul_f32 v220, v220, v185
    v_mul_f32 v224, v224, v186
    v_mfma_f32_16x16x32_bf16 v[144:147], v[36:39], a[148:151], v[144:147]
    buffer_load_dwordx4 v[92:95], v1, s[44:47], s65 offen sc1
    v_mfma_f32_16x16x32_bf16 v[148:151], v[36:39], a[152:155], v[148:151]
    s_add_u32 s65, s77, 32768
    v_mul_f32 v228, v228, v187
    v_mul_f32 v232, v232, v188
    v_mfma_f32_16x16x32_bf16 v[148:151], v[32:35], a[132:135], v[148:151]
    v_fma_f32 v217, v197, v178, -v179
    v_fma_f32 v221, v201, v178, -v179
    v_mfma_f32_16x16x32_bf16 v[152:155], v[32:35], a[136:139], v[152:155]
    v_fma_f32 v225, v205, v178, -v179
    v_fma_f32 v229, v209, v178, -v179
    v_mfma_f32_16x16x32_bf16 v[152:155], v[36:39], a[156:159], v[152:155]
    s_waitcnt vmcnt(13)
    v_fma_f32 v233, v213, v178, -v179
    v_mul_f32 v217, v217, v184
    v_mfma_f32_16x16x32_bf16 v[136:139], v[40:43], a[160:163], v[136:139]
    buffer_load_dwordx4 v[32:35], v1, s[44:47], s65 offen sc1
    v_mfma_f32_16x16x32_bf16 v[136:139], v[44:47], a[180:183], v[136:139]
    s_add_u32 s65, s77, 49152
    v_mul_f32 v221, v221, v185
    v_mul_f32 v225, v225, v186
    v_mfma_f32_16x16x32_bf16 v[140:143], v[44:47], a[184:187], v[140:143]
    v_mul_f32 v229, v229, v187
    v_mul_f32 v233, v233, v188
    v_mfma_f32_16x16x32_bf16 v[140:143], v[40:43], a[164:167], v[140:143]
    v_fma_f32 v218, v198, v180, -v181
    v_fma_f32 v222, v202, v180, -v181
    v_mfma_f32_16x16x32_bf16 v[144:147], v[40:43], a[168:171], v[144:147]
    v_fma_f32 v226, v206, v180, -v181
    v_fma_f32 v230, v210, v180, -v181
    v_mfma_f32_16x16x32_bf16 v[144:147], v[44:47], a[188:191], v[144:147]
    buffer_load_dwordx4 v[36:39], v1, s[44:47], s65 offen sc1
    v_mfma_f32_16x16x32_bf16 v[148:151], v[44:47], a[192:195], v[148:151]
    s_add_u32 s65, s77, 65536
    v_fma_f32 v234, v214, v180, -v181
    v_mul_f32 v218, v218, v184
    v_mfma_f32_16x16x32_bf16 v[148:151], v[40:43], a[172:175], v[148:151]
    v_mul_f32 v222, v222, v185
    v_mul_f32 v226, v226, v186
    v_mfma_f32_16x16x32_bf16 v[152:155], v[40:43], a[176:179], v[152:155]
    v_mul_f32 v230, v230, v187
    v_mul_f32 v234, v234, v188
    v_mfma_f32_16x16x32_bf16 v[152:155], v[44:47], a[196:199], v[152:155]
    s_waitcnt vmcnt(13)
    v_fma_f32 v219, v199, v182, -v183
    v_fma_f32 v223, v203, v182, -v183
    s_waitcnt lgkmcnt(4)
    v_mfma_f32_16x16x32_bf16 v[156:159], v[48:51], a[0:3], v[156:159]
    buffer_load_dwordx4 v[40:43], v1, s[44:47], s65 offen sc1
    v_mfma_f32_16x16x32_bf16 v[156:159], v[52:55], a[20:23], v[156:159]
    s_add_u32 s65, s77, 81920
    v_fma_f32 v227, v207, v182, -v183
    v_fma_f32 v231, v211, v182, -v183
    s_waitcnt lgkmcnt(3)
    v_mfma_f32_16x16x32_bf16 v[160:163], v[48:51], a[4:7], v[160:163]
    v_fma_f32 v235, v215, v182, -v183
    v_mul_f32 v219, v219, v184
    v_mfma_f32_16x16x32_bf16 v[160:163], v[52:55], a[24:27], v[160:163]
    ds_write_b128 v24, v[136:139] offset:5120
    s_waitcnt lgkmcnt(3)
    v_mfma_f32_16x16x32_bf16 v[164:167], v[48:51], a[8:11], v[164:167]
    v_mul_f32 v223, v223, v185
    v_mul_f32 v227, v227, v186
    v_mfma_f32_16x16x32_bf16 v[164:167], v[52:55], a[28:31], v[164:167]
    buffer_load_dwordx4 v[44:47], v1, s[44:47], s65 offen sc1
    s_waitcnt lgkmcnt(2)
    v_mfma_f32_16x16x32_bf16 v[168:171], v[48:51], a[12:15], v[168:171]
    s_add_u32 s65, s77, 98304
    v_mul_f32 v231, v231, v187
    v_mul_f32 v235, v235, v188
    v_mfma_f32_16x16x32_bf16 v[168:171], v[52:55], a[32:35], v[168:171]
    ds_write_b128 v24, v[140:143] offset:6144
    s_waitcnt lgkmcnt(2)
    v_mfma_f32_16x16x32_bf16 v[172:175], v[48:51], a[16:19], v[172:175]
    v_mfma_f32_16x16x32_bf16 v[172:175], v[52:55], a[36:39], v[172:175]
    s_waitcnt vmcnt(13)
    v_mfma_f32_16x16x32_bf16 v[156:159], v[56:59], a[40:43], v[156:159]
    ds_write_b128 v24, v[144:147] offset:7168
    v_mfma_f32_16x16x32_bf16 v[156:159], v[60:63], a[60:63], v[156:159]
    buffer_load_dwordx4 v[48:51], v1, s[44:47], s65 offen sc1
    v_mfma_f32_16x16x32_bf16 v[160:163], v[60:63], a[64:67], v[160:163]
    s_add_u32 s65, s77, 114688
    v_mfma_f32_16x16x32_bf16 v[160:163], v[56:59], a[44:47], v[160:163]
    v_mfma_f32_16x16x32_bf16 v[164:167], v[56:59], a[48:51], v[164:167]
    ds_write_b128 v24, v[148:151] offset:8192
    v_mfma_f32_16x16x32_bf16 v[164:167], v[60:63], a[68:71], v[164:167]
    buffer_load_dwordx4 v[52:55], v1, s[44:47], s65 offen sc1
    v_mfma_f32_16x16x32_bf16 v[168:171], v[60:63], a[72:75], v[168:171]
    s_add_u32 s65, s77, 131072
    v_mfma_f32_16x16x32_bf16 v[168:171], v[56:59], a[52:55], v[168:171]
    ds_write_b128 v24, v[152:155] offset:9216
    v_mfma_f32_16x16x32_bf16 v[172:175], v[56:59], a[56:59], v[172:175]
    v_mfma_f32_16x16x32_bf16 v[172:175], v[60:63], a[76:79], v[172:175]
    s_waitcnt vmcnt(13)
    v_mfma_f32_16x16x32_bf16 v[156:159], v[64:67], a[80:83], v[156:159]
    buffer_load_dwordx4 v[56:59], v1, s[44:47], s65 offen sc1
    v_mfma_f32_16x16x32_bf16 v[156:159], v[68:71], a[100:103], v[156:159]
    v_mfma_f32_16x16x32_bf16 v[160:163], v[68:71], a[104:107], v[160:163]
    v_mfma_f32_16x16x32_bf16 v[160:163], v[64:67], a[84:87], v[160:163]
    v_mfma_f32_16x16x32_bf16 v[164:167], v[64:67], a[88:91], v[164:167]
    s_waitcnt lgkmcnt(0)
    s_barrier
    v_mfma_f32_16x16x32_bf16 v[164:167], v[68:71], a[108:111], v[164:167]
    ds_read_b128 v[96:99], v22 offset:0
    s_add_u32 s65, s77, 147456
    v_mfma_f32_16x16x32_bf16 v[168:171], v[68:71], a[112:115], v[168:171]
    buffer_load_dwordx4 v[60:63], v1, s[44:47], s65 offen sc1
    v_mfma_f32_16x16x32_bf16 v[168:171], v[64:67], a[92:95], v[168:171]
    ds_read_b128 v[100:103], v22 offset:1024
    v_mfma_f32_16x16x32_bf16 v[172:175], v[64:67], a[96:99], v[172:175]
    ds_read_b128 v[104:107], v22 offset:2048
    v_mfma_f32_16x16x32_bf16 v[172:175], v[68:71], a[116:119], v[172:175]
    s_waitcnt vmcnt(12)
    ds_read_b128 v[108:111], v22 offset:3072
    s_nop 0
L_SB_pad2:
    s_cbranch_execz L_SB_pad6
    ds_read_b128 v[112:115], v22 offset:4096
    v_cmp_ne_u32 vcc, s66, v8
    s_cbranch_vccz L_S_f1b_ok
    s_mov_b32 s25, 0
L_S_f1b_retry:

    buffer_load_dword v8, v27, s[44:47], 0 offen sc1
    s_add_u32 s25, s25, 1
    s_waitcnt vmcnt(0)
    v_cmp_ne_u32 vcc, s66, v8
    s_cmp_ge_u32 s25, 100000
    s_cbranch_scc1 L_S_f1b_ok
    s_cbranch_vccnz L_S_f1b_retry
L_S_f1b_ok:
    v_mfma_f32_16x16x32_bf16 v[156:159], v[72:75], a[120:123], v[156:159]
    s_add_u32 s65, s77, 393216
    v_mfma_f32_16x16x32_bf16 v[156:159], v[76:79], a[140:143], v[156:159]
    buffer_load_dwordx4 v[64:67], v18, s[44:47], s65 offen sc1
    v_mfma_f32_16x16x32_bf16 v[160:163], v[76:79], a[144:147], v[160:163]
    s_add_u32 s65, s77, 409600
    v_mfma_f32_16x16x32_bf16 v[160:163], v[72:75], a[124:127], v[160:163]
    v_mfma_f32_16x16x32_bf16 v[164:167], v[72:75], a[128:131], v[164:167]
    v_mfma_f32_16x16x32_bf16 v[164:167], v[76:79], a[148:151], v[164:167]
    buffer_load_dwordx4 v[68:71], v18, s[44:47], s65 offen sc1
    v_mfma_f32_16x16x32_bf16 v[168:171], v[76:79], a[152:155], v[168:171]
    s_add_u32 s65, s77, 425984
    v_mfma_f32_16x16x32_bf16 v[168:171], v[72:75], a[132:135], v[168:171]
    v_mfma_f32_16x16x32_bf16 v[172:175], v[72:75], a[136:139], v[172:175]
    v_mfma_f32_16x16x32_bf16 v[172:175], v[76:79], a[156:159], v[172:175]
    s_waitcnt vmcnt(12)
    v_mfma_f32_16x16x32_bf16 v[156:159], v[80:83], a[160:163], v[156:159]
    buffer_load_dwordx4 v[72:75], v18, s[44:47], s65 offen sc1
    v_mfma_f32_16x16x32_bf16 v[156:159], v[84:87], a[180:183], v[156:159]
    s_add_u32 s65, s77, 442368
    v_mfma_f32_16x16x32_bf16 v[160:163], v[84:87], a[184:187], v[160:163]
    v_mfma_f32_16x16x32_bf16 v[160:163], v[80:83], a[164:167], v[160:163]
    v_mfma_f32_16x16x32_bf16 v[164:167], v[80:83], a[168:171], v[164:167]
    v_mfma_f32_16x16x32_bf16 v[164:167], v[84:87], a[188:191], v[164:167]
    buffer_load_dwordx4 v[76:79], v18, s[44:47], s65 offen sc1
    v_mfma_f32_16x16x32_bf16 v[168:171], v[84:87], a[192:195], v[168:171]
    s_add_u32 s65, s77, 458752
    v_mfma_f32_16x16x32_bf16 v[168:171], v[80:83], a[172:175], v[168:171]
    v_mfma_f32_16x16x32_bf16 v[172:175], v[80:83], a[176:179], v[172:175]
    v_mfma_f32_16x16x32_bf16 v[172:175], v[84:87], a[196:199], v[172:175]
    s_waitcnt vmcnt(12)
    s_waitcnt lgkmcnt(4)
    v_mfma_f32_16x16x32_bf16 v[96:99], v[88:91], a[0:3], v[96:99]
    buffer_load_dwordx4 v[80:83], v18, s[44:47], s65 offen sc1
    v_mfma_f32_16x16x32_bf16 v[96:99], v[92:95], a[20:23], v[96:99]
    s_add_u32 s65, s77, 475136
    s_waitcnt lgkmcnt(3)
    v_mfma_f32_16x16x32_bf16 v[100:103], v[88:91], a[4:7], v[100:103]
    v_mfma_f32_16x16x32_bf16 v[100:103], v[92:95], a[24:27], v[100:103]
    ds_write_b128 v24, v[156:159] offset:10240
    s_waitcnt lgkmcnt(3)
    v_mfma_f32_16x16x32_bf16 v[104:107], v[88:91], a[8:11], v[104:107]
    v_mfma_f32_16x16x32_bf16 v[104:107], v[92:95], a[28:31], v[104:107]
    buffer_load_dwordx4 v[84:87], v18, s[44:47], s65 offen sc1
    s_waitcnt lgkmcnt(2)
    v_mfma_f32_16x16x32_bf16 v[108:111], v[88:91], a[12:15], v[108:111]
    s_add_u32 s65, s77, 491520
    v_mfma_f32_16x16x32_bf16 v[108:111], v[92:95], a[32:35], v[108:111]
    ds_write_b128 v24, v[160:163] offset:11264
    s_waitcnt lgkmcnt(2)
    v_mfma_f32_16x16x32_bf16 v[112:115], v[88:91], a[16:19], v[112:115]
    v_mfma_f32_16x16x32_bf16 v[112:115], v[92:95], a[36:39], v[112:115]
    s_waitcnt vmcnt(12)
    v_mfma_f32_16x16x32_bf16 v[96:99], v[32:35], a[40:43], v[96:99]
    ds_write_b128 v24, v[164:167] offset:12288
    v_mfma_f32_16x16x32_bf16 v[96:99], v[36:39], a[60:63], v[96:99]
    buffer_load_dwordx4 v[88:91], v18, s[44:47], s65 offen sc1
    v_mfma_f32_16x16x32_bf16 v[100:103], v[36:39], a[64:67], v[100:103]
    s_add_u32 s65, s77, 507904
    v_mfma_f32_16x16x32_bf16 v[100:103], v[32:35], a[44:47], v[100:103]
    v_mfma_f32_16x16x32_bf16 v[104:107], v[32:35], a[48:51], v[104:107]
    ds_write_b128 v24, v[168:171] offset:13312
    v_mfma_f32_16x16x32_bf16 v[104:107], v[36:39], a[68:71], v[104:107]
    buffer_load_dwordx4 v[92:95], v18, s[44:47], s65 offen sc1
    v_mfma_f32_16x16x32_bf16 v[108:111], v[36:39], a[72:75], v[108:111]
    s_add_u32 s65, s77, 524288
    v_mfma_f32_16x16x32_bf16 v[108:111], v[32:35], a[52:55], v[108:111]
    ds_write_b128 v24, v[172:175] offset:14336
    v_mfma_f32_16x16x32_bf16 v[112:115], v[32:35], a[56:59], v[112:115]
    v_mfma_f32_16x16x32_bf16 v[112:115], v[36:39], a[76:79], v[112:115]
    s_waitcnt vmcnt(12)
    v_mfma_f32_16x16x32_bf16 v[96:99], v[40:43], a[80:83], v[96:99]
    buffer_load_dwordx4 v[32:35], v18, s[44:47], s65 offen sc1
    v_mfma_f32_16x16x32_bf16 v[96:99], v[44:47], a[100:103], v[96:99]
    v_mfma_f32_16x16x32_bf16 v[100:103], v[44:47], a[104:107], v[100:103]
    v_mfma_f32_16x16x32_bf16 v[100:103], v[40:43], a[84:87], v[100:103]
    v_mfma_f32_16x16x32_bf16 v[104:107], v[40:43], a[88:91], v[104:107]
    s_waitcnt lgkmcnt(0)
    s_barrier
    v_mfma_f32_16x16x32_bf16 v[104:107], v[44:47], a[108:111], v[104:107]
    ds_read_b128 v[116:119], v23 offset:0
    s_add_u32 s65, s77, 540672
    v_mfma_f32_16x16x32_bf16 v[108:111], v[44:47], a[112:115], v[108:111]
    buffer_load_dwordx4 v[36:39], v18, s[44:47], s65 offen sc1
    v_mfma_f32_16x16x32_bf16 v[108:111], v[40:43], a[92:95], v[108:111]
    ds_read_b128 v[120:123], v23 offset:1024
    s_add_u32 s65, s77, 393216
    v_mfma_f32_16x16x32_bf16 v[112:115], v[40:43], a[96:99], v[112:115]
    v_lshlrev_b32 v14, 4, v0
    v_lshrrev_b32 v14, v14, v16
    v_mfma_f32_16x16x32_bf16 v[112:115], v[44:47], a[116:119], v[112:115]
    s_waitcnt vmcnt(12)
    v_lshlrev_b32 v14, 16, v14
    v_mov_b32 v147, v14
    v_mfma_f32_16x16x32_bf16 v[96:99], v[48:51], a[120:123], v[96:99]
    ds_read_b128 v[124:127], v23 offset:2048
    s_mov_b32 s68, 0xffff
    v_mfma_f32_16x16x32_bf16 v[96:99], v[52:55], a[140:143], v[96:99]
    ds_read_b128 v[128:131], v23 offset:3072
    v_mfma_f32_16x16x32_bf16 v[100:103], v[52:55], a[144:147], v[100:103]
    buffer_load_dwordx4 v[40:43], v19, s[44:47], s65 offen sc1
    v_mfma_f32_16x16x32_bf16 v[100:103], v[48:51], a[124:127], v[100:103]
    ds_read_b128 v[132:135], v23 offset:4096
    s_add_u32 s65, s77, 409600
    v_mfma_f32_16x16x32_bf16 v[104:107], v[48:51], a[128:131], v[104:107]
    v_mfma_f32_16x16x32_bf16 v[104:107], v[52:55], a[148:151], v[104:107]
    buffer_load_dwordx4 v[44:47], v19, s[44:47], s65 offen sc1
    v_mfma_f32_16x16x32_bf16 v[108:111], v[52:55], a[152:155], v[108:111]
    s_add_u32 s65, s77, 425984
    v_mfma_f32_16x16x32_bf16 v[108:111], v[48:51], a[132:135], v[108:111]
    v_mfma_f32_16x16x32_bf16 v[112:115], v[48:51], a[136:139], v[112:115]
    v_mfma_f32_16x16x32_bf16 v[112:115], v[52:55], a[156:159], v[112:115]
    s_waitcnt vmcnt(12)
    v_mfma_f32_16x16x32_bf16 v[96:99], v[56:59], a[160:163], v[96:99]
    buffer_load_dwordx4 v[48:51], v19, s[44:47], s65 offen sc1
    v_mfma_f32_16x16x32_bf16 v[96:99], v[60:63], a[180:183], v[96:99]
    s_add_u32 s65, s77, 442368
    v_mfma_f32_16x16x32_bf16 v[100:103], v[60:63], a[184:187], v[100:103]
    v_mfma_f32_16x16x32_bf16 v[100:103], v[56:59], a[164:167], v[100:103]
    v_mfma_f32_16x16x32_bf16 v[104:107], v[56:59], a[168:171], v[104:107]
    v_mfma_f32_16x16x32_bf16 v[104:107], v[60:63], a[188:191], v[104:107]
    buffer_load_dwordx4 v[52:55], v19, s[44:47], s65 offen sc1
    v_mfma_f32_16x16x32_bf16 v[108:111], v[60:63], a[192:195], v[108:111]
    s_add_u32 s65, s77, 458752
    v_mfma_f32_16x16x32_bf16 v[108:111], v[56:59], a[172:175], v[108:111]
    v_mfma_f32_16x16x32_bf16 v[112:115], v[56:59], a[176:179], v[112:115]
    v_mfma_f32_16x16x32_bf16 v[112:115], v[60:63], a[196:199], v[112:115]
    s_waitcnt vmcnt(12)
    v_mfma_f32_16x16x32_bf16 v[176:179], v[64:67], a[0:3], 0
    buffer_load_dwordx4 v[56:59], v19, s[44:47], s65 offen sc1
    v_mfma_f32_16x16x32_bf16 v[176:179], v[68:71], a[20:23], v[176:179]
    s_add_u32 s65, s77, 475136
    v_mfma_f32_16x16x32_bf16 v[180:183], v[64:67], a[4:7], 0
    v_mfma_f32_16x16x32_bf16 v[180:183], v[68:71], a[24:27], v[180:183]
    s_waitcnt lgkmcnt(4)
    v_add_f32 v96, v96, v116
    v_add_f32 v97, v97, v117
    v_mfma_f32_16x16x32_bf16 v[184:187], v[64:67], a[8:11], 0
    v_cvt_pk_bf16_f32 v136, v96, v97
L_SB_pad3:
    s_cbranch_execz L_SB_ret
    v_add_f32 v98, v98, v118
    v_mfma_f32_16x16x32_bf16 v[184:187], v[68:71], a[28:31], v[184:187]
    buffer_load_dwordx4 v[60:63], v19, s[44:47], s65 offen sc1
    v_mfma_f32_16x16x32_bf16 v[188:191], v[64:67], a[12:15], 0
    s_add_u32 s65, s77, 491520
    v_add_f32 v99, v99, v119
    v_cvt_pk_bf16_f32 v137, v98, v99
    v_mfma_f32_16x16x32_bf16 v[188:191], v[68:71], a[32:35], v[188:191]
    s_waitcnt lgkmcnt(3)
    v_add_f32 v100, v100, v120
    v_add_f32 v101, v101, v121
    v_mfma_f32_16x16x32_bf16 v[192:195], v[64:67], a[16:19], 0
    v_cvt_pk_bf16_f32 v138, v100, v101
    v_add_f32 v102, v102, v122
    v_mfma_f32_16x16x32_bf16 v[192:195], v[68:71], a[36:39], v[192:195]
    s_waitcnt vmcnt(12)
    v_cvt_pk_bf16_f32 v139, v102, v102
    v_bfi_b32 v139, s68, v139, v14
    v_mfma_f32_16x16x32_bf16 v[176:179], v[72:75], a[40:43], v[176:179]
    buffer_load_dwordx4 v[64:67], v19, s[44:47], s65 offen sc1
    v_mfma_f32_16x16x32_bf16 v[176:179], v[76:79], a[60:63], v[176:179]
    s_add_u32 s65, s77, 507904
    v_add_f32 v103, v103, v123
    s_waitcnt lgkmcnt(2)
    v_add_f32 v104, v104, v124
    v_mfma_f32_16x16x32_bf16 v[180:183], v[76:79], a[64:67], v[180:183]
    v_cvt_pk_bf16_f32 v140, v103, v104
    v_add_f32 v105, v105, v125
    v_mfma_f32_16x16x32_bf16 v[180:183], v[72:75], a[44:47], v[180:183]
    v_add_f32 v106, v106, v126
    v_cvt_pk_bf16_f32 v141, v105, v106
    v_mfma_f32_16x16x32_bf16 v[184:187], v[72:75], a[48:51], v[184:187]
    v_add_f32 v107, v107, v127
    s_waitcnt lgkmcnt(1)
    v_add_f32 v108, v108, v128
    v_mfma_f32_16x16x32_bf16 v[184:187], v[76:79], a[68:71], v[184:187]
    buffer_load_dwordx4 v[68:71], v19, s[44:47], s65 offen sc1
    v_mfma_f32_16x16x32_bf16 v[188:191], v[76:79], a[72:75], v[188:191]
    s_add_u32 s65, s77, 524288
    v_cvt_pk_bf16_f32 v142, v107, v108
    v_add_f32 v109, v109, v129
    v_mfma_f32_16x16x32_bf16 v[188:191], v[72:75], a[52:55], v[188:191]
    v_cvt_pk_bf16_f32 v143, v109, v109
    v_bfi_b32 v143, s68, v143, v14
    v_mfma_f32_16x16x32_bf16 v[192:195], v[72:75], a[56:59], v[192:195]
    v_add_f32 v110, v110, v130
    v_add_f32 v111, v111, v131
    v_mfma_f32_16x16x32_bf16 v[192:195], v[76:79], a[76:79], v[192:195]
    s_waitcnt vmcnt(12)
    v_cvt_pk_bf16_f32 v144, v110, v111
    s_waitcnt lgkmcnt(0)
    v_add_f32 v112, v112, v132
    v_mfma_f32_16x16x32_bf16 v[176:179], v[80:83], a[80:83], v[176:179]
    buffer_load_dwordx4 v[72:75], v19, s[44:47], s65 offen sc1
    v_mfma_f32_16x16x32_bf16 v[176:179], v[84:87], a[100:103], v[176:179]
    s_add_u32 s65, s77, 540672
    v_add_f32 v113, v113, v133
    v_cvt_pk_bf16_f32 v145, v112, v113
    v_mfma_f32_16x16x32_bf16 v[180:183], v[84:87], a[104:107], v[180:183]
    v_add_f32 v114, v114, v134
    v_add_f32 v115, v115, v135
    v_mfma_f32_16x16x32_bf16 v[180:183], v[80:83], a[84:87], v[180:183]
    v_cvt_pk_bf16_f32 v146, v114, v115
    v_mfma_f32_16x16x32_bf16 v[184:187], v[80:83], a[88:91], v[184:187]
    buffer_store_dwordx4 v[136:139], v15, s[44:47], s62 offen offset:0 sc1
    v_mfma_f32_16x16x32_bf16 v[184:187], v[84:87], a[108:111], v[184:187]
    buffer_store_dwordx4 v[140:143], v15, s[44:47], s62 offen offset:1024 sc1
    v_mfma_f32_16x16x32_bf16 v[188:191], v[84:87], a[112:115], v[188:191]
    buffer_store_dwordx4 v[144:147], v15, s[44:47], s62 offen offset:2048 sc1
    v_mfma_f32_16x16x32_bf16 v[188:191], v[80:83], a[92:95], v[188:191]
    buffer_load_dwordx4 v[76:79], v19, s[44:47], s65 offen sc1
    v_mfma_f32_16x16x32_bf16 v[192:195], v[80:83], a[96:99], v[192:195]
    s_add_u32 s65, s77, 393216
    v_mfma_f32_16x16x32_bf16 v[192:195], v[84:87], a[116:119], v[192:195]
    s_waitcnt vmcnt(15)
    v_mfma_f32_16x16x32_bf16 v[176:179], v[88:91], a[120:123], v[176:179]
    buffer_load_dwordx4 v[80:83], v20, s[44:47], s65 offen sc1
    v_mfma_f32_16x16x32_bf16 v[176:179], v[92:95], a[140:143], v[176:179]
    s_add_u32 s65, s77, 409600
    v_mfma_f32_16x16x32_bf16 v[180:183], v[92:95], a[144:147], v[180:183]
    v_mfma_f32_16x16x32_bf16 v[180:183], v[88:91], a[124:127], v[180:183]
    v_mfma_f32_16x16x32_bf16 v[184:187], v[88:91], a[128:131], v[184:187]
    v_mfma_f32_16x16x32_bf16 v[184:187], v[92:95], a[148:151], v[184:187]
    buffer_load_dwordx4 v[84:87], v20, s[44:47], s65 offen sc1
    v_mfma_f32_16x16x32_bf16 v[188:191], v[92:95], a[152:155], v[188:191]
    s_add_u32 s65, s77, 425984
    v_mfma_f32_16x16x32_bf16 v[188:191], v[88:91], a[132:135], v[188:191]
    v_mfma_f32_16x16x32_bf16 v[192:195], v[88:91], a[136:139], v[192:195]
    v_mfma_f32_16x16x32_bf16 v[192:195], v[92:95], a[156:159], v[192:195]
    s_waitcnt vmcnt(15)
    v_mfma_f32_16x16x32_bf16 v[176:179], v[32:35], a[160:163], v[176:179]
    buffer_load_dwordx4 v[88:91], v20, s[44:47], s65 offen sc1
    v_mfma_f32_16x16x32_bf16 v[176:179], v[36:39], a[180:183], v[176:179]
    s_add_u32 s65, s77, 442368
    v_mfma_f32_16x16x32_bf16 v[180:183], v[36:39], a[184:187], v[180:183]
    v_mfma_f32_16x16x32_bf16 v[180:183], v[32:35], a[164:167], v[180:183]
    v_mfma_f32_16x16x32_bf16 v[184:187], v[32:35], a[168:171], v[184:187]
    v_mfma_f32_16x16x32_bf16 v[184:187], v[36:39], a[188:191], v[184:187]
    buffer_load_dwordx4 v[92:95], v20, s[44:47], s65 offen sc1
    v_mfma_f32_16x16x32_bf16 v[188:191], v[36:39], a[192:195], v[188:191]
    s_add_u32 s65, s77, 458752
    v_mfma_f32_16x16x32_bf16 v[188:191], v[32:35], a[172:175], v[188:191]
    v_mfma_f32_16x16x32_bf16 v[192:195], v[32:35], a[176:179], v[192:195]
    v_mfma_f32_16x16x32_bf16 v[192:195], v[36:39], a[196:199], v[192:195]
    s_waitcnt vmcnt(15)
    v_mfma_f32_16x16x32_bf16 v[116:119], v[40:43], a[0:3], 0
    buffer_load_dwordx4 v[32:35], v20, s[44:47], s65 offen sc1
    v_mfma_f32_16x16x32_bf16 v[116:119], v[44:47], a[20:23], v[116:119]
    s_add_u32 s65, s77, 475136
    v_mfma_f32_16x16x32_bf16 v[120:123], v[40:43], a[4:7], 0
    v_mfma_f32_16x16x32_bf16 v[120:123], v[44:47], a[24:27], v[120:123]
    ds_write_b128 v24, v[176:179] offset:15360
    v_mfma_f32_16x16x32_bf16 v[124:127], v[40:43], a[8:11], 0
    v_mfma_f32_16x16x32_bf16 v[124:127], v[44:47], a[28:31], v[124:127]
    buffer_load_dwordx4 v[36:39], v20, s[44:47], s65 offen sc1
    v_mfma_f32_16x16x32_bf16 v[128:131], v[40:43], a[12:15], 0
    s_add_u32 s65, s77, 491520
    v_mfma_f32_16x16x32_bf16 v[128:131], v[44:47], a[32:35], v[128:131]
    ds_write_b128 v24, v[180:183] offset:16384
    v_mfma_f32_16x16x32_bf16 v[132:135], v[40:43], a[16:19], 0
    v_mfma_f32_16x16x32_bf16 v[132:135], v[44:47], a[36:39], v[132:135]
    s_waitcnt vmcnt(15)
    v_mfma_f32_16x16x32_bf16 v[116:119], v[48:51], a[40:43], v[116:119]
    ds_write_b128 v24, v[184:187] offset:17408
    v_mfma_f32_16x16x32_bf16 v[116:119], v[52:55], a[60:63], v[116:119]
    buffer_load_dwordx4 v[40:43], v20, s[44:47], s65 offen sc1
    v_mfma_f32_16x16x32_bf16 v[120:123], v[52:55], a[64:67], v[120:123]
    s_add_u32 s65, s77, 507904
    v_mfma_f32_16x16x32_bf16 v[120:123], v[48:51], a[44:47], v[120:123]
    v_mfma_f32_16x16x32_bf16 v[124:127], v[48:51], a[48:51], v[124:127]
    ds_write_b128 v24, v[188:191] offset:18432
    v_mfma_f32_16x16x32_bf16 v[124:127], v[52:55], a[68:71], v[124:127]
    buffer_load_dwordx4 v[44:47], v20, s[44:47], s65 offen sc1
    v_mfma_f32_16x16x32_bf16 v[128:131], v[52:55], a[72:75], v[128:131]
    s_add_u32 s65, s77, 524288
    v_mfma_f32_16x16x32_bf16 v[128:131], v[48:51], a[52:55], v[128:131]
    ds_write_b128 v24, v[192:195] offset:19456
    v_mfma_f32_16x16x32_bf16 v[132:135], v[48:51], a[56:59], v[132:135]
    v_mfma_f32_16x16x32_bf16 v[132:135], v[52:55], a[76:79], v[132:135]
    s_waitcnt vmcnt(15)
    v_mfma_f32_16x16x32_bf16 v[116:119], v[56:59], a[80:83], v[116:119]
    buffer_load_dwordx4 v[48:51], v20, s[44:47], s65 offen sc1
    v_mfma_f32_16x16x32_bf16 v[116:119], v[60:63], a[100:103], v[116:119]
    v_mfma_f32_16x16x32_bf16 v[120:123], v[60:63], a[104:107], v[120:123]
    v_mfma_f32_16x16x32_bf16 v[120:123], v[56:59], a[84:87], v[120:123]
    v_mfma_f32_16x16x32_bf16 v[124:127], v[56:59], a[88:91], v[124:127]
    s_waitcnt lgkmcnt(0)
    s_barrier
    v_mfma_f32_16x16x32_bf16 v[124:127], v[60:63], a[108:111], v[124:127]
    ds_read_b128 v[136:139], v21 offset:15360
    s_add_u32 s65, s77, 540672
L_SB_pad4:
    s_cbranch_execz L_SB_ret
    v_mfma_f32_16x16x32_bf16 v[128:131], v[60:63], a[112:115], v[128:131]
    buffer_load_dwordx4 v[52:55], v20, s[44:47], s65 offen sc1
    v_mfma_f32_16x16x32_bf16 v[128:131], v[56:59], a[92:95], v[128:131]
    buffer_load_dwordx4 v[236:239], v15, s[44:47], s63 offen offset:0 sc1
    v_mfma_f32_16x16x32_bf16 v[132:135], v[56:59], a[96:99], v[132:135]
    ds_read_b128 v[140:143], v21 offset:16384
    s_add_u32 s65, s77, 393216
    v_mfma_f32_16x16x32_bf16 v[132:135], v[60:63], a[116:119], v[132:135]
    s_waitcnt vmcnt(16)
    v_mfma_f32_16x16x32_bf16 v[116:119], v[64:67], a[120:123], v[116:119]
    buffer_load_dwordx4 v[240:243], v15, s[44:47], s63 offen offset:1024 sc1
    v_mfma_f32_16x16x32_bf16 v[116:119], v[68:71], a[140:143], v[116:119]
    buffer_load_dwordx4 v[244:247], v15, s[44:47], s63 offen offset:2048 sc1
    v_mfma_f32_16x16x32_bf16 v[120:123], v[68:71], a[144:147], v[120:123]
    ds_read_b128 v[144:147], v21 offset:17408
    v_mfma_f32_16x16x32_bf16 v[120:123], v[64:67], a[124:127], v[120:123]
    ds_read_b128 v[148:151], v21 offset:18432
    v_mfma_f32_16x16x32_bf16 v[124:127], v[64:67], a[128:131], v[124:127]
    buffer_load_dwordx4 v[56:59], v1, s[44:47], s65 offen sc1
    v_mfma_f32_16x16x32_bf16 v[124:127], v[68:71], a[148:151], v[124:127]
    ds_read_b128 v[152:155], v21 offset:19456
    s_add_u32 s65, s77, 409600
    v_mfma_f32_16x16x32_bf16 v[128:131], v[68:71], a[152:155], v[128:131]
    buffer_load_dwordx4 v[60:63], v1, s[44:47], s65 offen sc1
    v_mfma_f32_16x16x32_bf16 v[128:131], v[64:67], a[132:135], v[128:131]
    s_add_u32 s65, s77, 425984
    v_mfma_f32_16x16x32_bf16 v[132:135], v[64:67], a[136:139], v[132:135]
    v_mfma_f32_16x16x32_bf16 v[132:135], v[68:71], a[156:159], v[132:135]
    s_waitcnt vmcnt(15)
    v_mfma_f32_16x16x32_bf16 v[116:119], v[72:75], a[160:163], v[116:119]
    buffer_load_dwordx4 v[64:67], v1, s[44:47], s65 offen sc1
    v_mfma_f32_16x16x32_bf16 v[116:119], v[76:79], a[180:183], v[116:119]
    s_add_u32 s65, s77, 442368
    v_mfma_f32_16x16x32_bf16 v[120:123], v[76:79], a[184:187], v[120:123]
    v_mfma_f32_16x16x32_bf16 v[120:123], v[72:75], a[164:167], v[120:123]
    v_mfma_f32_16x16x32_bf16 v[124:127], v[72:75], a[168:171], v[124:127]
    v_mfma_f32_16x16x32_bf16 v[124:127], v[76:79], a[188:191], v[124:127]
    buffer_load_dwordx4 v[68:71], v1, s[44:47], s65 offen sc1
    v_mfma_f32_16x16x32_bf16 v[128:131], v[76:79], a[192:195], v[128:131]
    s_add_u32 s65, s77, 458752
    v_mfma_f32_16x16x32_bf16 v[128:131], v[72:75], a[172:175], v[128:131]
    v_mfma_f32_16x16x32_bf16 v[132:135], v[72:75], a[176:179], v[132:135]
    v_mfma_f32_16x16x32_bf16 v[132:135], v[76:79], a[196:199], v[132:135]
    s_waitcnt vmcnt(15)
    s_waitcnt lgkmcnt(4)
    v_mfma_f32_16x16x32_bf16 v[136:139], v[80:83], a[0:3], v[136:139]
    buffer_load_dwordx4 v[72:75], v1, s[44:47], s65 offen sc1
    v_mfma_f32_16x16x32_bf16 v[136:139], v[84:87], a[20:23], v[136:139]
    s_add_u32 s65, s77, 475136
    s_waitcnt lgkmcnt(3)
    v_mfma_f32_16x16x32_bf16 v[140:143], v[80:83], a[4:7], v[140:143]
    v_mfma_f32_16x16x32_bf16 v[140:143], v[84:87], a[24:27], v[140:143]
    ds_write_b128 v24, v[116:119] offset:20480
    s_waitcnt lgkmcnt(3)
    v_mfma_f32_16x16x32_bf16 v[144:147], v[80:83], a[8:11], v[144:147]
    v_mfma_f32_16x16x32_bf16 v[144:147], v[84:87], a[28:31], v[144:147]
    buffer_load_dwordx4 v[76:79], v1, s[44:47], s65 offen sc1
    s_waitcnt lgkmcnt(2)
    v_mfma_f32_16x16x32_bf16 v[148:151], v[80:83], a[12:15], v[148:151]
    s_add_u32 s65, s77, 491520
    v_mfma_f32_16x16x32_bf16 v[148:151], v[84:87], a[32:35], v[148:151]
    ds_write_b128 v24, v[120:123] offset:21504
    s_waitcnt lgkmcnt(2)
    v_mfma_f32_16x16x32_bf16 v[152:155], v[80:83], a[16:19], v[152:155]
    v_mfma_f32_16x16x32_bf16 v[152:155], v[84:87], a[36:39], v[152:155]
    s_waitcnt vmcnt(15)
    v_mfma_f32_16x16x32_bf16 v[136:139], v[88:91], a[40:43], v[136:139]
    ds_write_b128 v24, v[124:127] offset:22528
    v_mfma_f32_16x16x32_bf16 v[136:139], v[92:95], a[60:63], v[136:139]
    buffer_load_dwordx4 v[80:83], v1, s[44:47], s65 offen sc1
    v_mfma_f32_16x16x32_bf16 v[140:143], v[92:95], a[64:67], v[140:143]
    s_add_u32 s65, s77, 507904
    v_mfma_f32_16x16x32_bf16 v[140:143], v[88:91], a[44:47], v[140:143]
    v_mfma_f32_16x16x32_bf16 v[144:147], v[88:91], a[48:51], v[144:147]
    ds_write_b128 v24, v[128:131] offset:23552
    v_mfma_f32_16x16x32_bf16 v[144:147], v[92:95], a[68:71], v[144:147]
    buffer_load_dwordx4 v[84:87], v1, s[44:47], s65 offen sc1
    v_mfma_f32_16x16x32_bf16 v[148:151], v[92:95], a[72:75], v[148:151]
    v_mfma_f32_16x16x32_bf16 v[148:151], v[88:91], a[52:55], v[148:151]
    ds_write_b128 v24, v[132:135] offset:24576
    v_mfma_f32_16x16x32_bf16 v[152:155], v[88:91], a[56:59], v[152:155]
    v_mfma_f32_16x16x32_bf16 v[152:155], v[92:95], a[76:79], v[152:155]
    s_waitcnt vmcnt(15)
    s_waitcnt vmcnt(10)
    v_xor_b32 v13, v239, v14
    s_waitcnt vmcnt(9)
    v_bitop3_b32 v13, v243, v14, v13 bitop3:0xbe
    s_waitcnt vmcnt(8)
    v_bitop3_b32 v13, v247, v14, v13 bitop3:0xbe
    v_cmp_lt_u32 vcc, s68, v13
    s_cbranch_vccz L_S_xch_ok
    s_mov_b32 s25, 0
L_S_xch_retry:

    buffer_load_dwordx4 v[236:239], v15, s[44:47], s63 offen offset:0 sc1
    buffer_load_dwordx4 v[240:243], v15, s[44:47], s63 offen offset:1024 sc1
    buffer_load_dwordx4 v[244:247], v15, s[44:47], s63 offen offset:2048 sc1
    s_add_u32 s25, s25, 1
    s_waitcnt vmcnt(0)
    v_xor_b32 v13, v239, v14
    v_bitop3_b32 v13, v243, v14, v13 bitop3:0xbe
    v_bitop3_b32 v13, v247, v14, v13 bitop3:0xbe
    v_cmp_lt_u32 vcc, s68, v13
    s_cmp_ge_u32 s25, 100000
    s_cbranch_scc1 L_S_xch_ok
    s_cbranch_vccnz L_S_xch_retry
L_S_xch_ok:
    v_mfma_f32_16x16x32_bf16 v[136:139], v[32:35], a[80:83], v[136:139]
    s_add_u32 s65, s77, 524288
    v_lshlrev_b32 v96, 16, v236
    v_and_b32 v97, 0xffff0000, v236
    v_mfma_f32_16x16x32_bf16 v[136:139], v[36:39], a[100:103], v[136:139]
    buffer_load_dwordx4 v[88:91], v1, s[44:47], s65 offen sc1
    v_mfma_f32_16x16x32_bf16 v[140:143], v[36:39], a[104:107], v[140:143]
    v_lshlrev_b32 v98, 16, v237
    v_and_b32 v99, 0xffff0000, v237
    v_mfma_f32_16x16x32_bf16 v[140:143], v[32:35], a[84:87], v[140:143]
    v_mul_f32 v8, 0xbfb8aa3b, v96
    v_mul_f32 v9, 0xbfb8aa3b, v97
    v_mfma_f32_16x16x32_bf16 v[144:147], v[32:35], a[88:91], v[144:147]
    s_waitcnt lgkmcnt(0)
    s_barrier
    v_mfma_f32_16x16x32_bf16 v[144:147], v[36:39], a[108:111], v[144:147]
    ds_read_b128 v[156:159], v22 offset:15360
    s_add_u32 s65, s77, 540672
    v_mfma_f32_16x16x32_bf16 v[148:151], v[36:39], a[112:115], v[148:151]
    buffer_load_dwordx4 v[92:95], v1, s[44:47], s65 offen sc1
    v_mfma_f32_16x16x32_bf16 v[148:151], v[32:35], a[92:95], v[148:151]
    ds_read_b128 v[160:163], v22 offset:16384
    v_mul_f32 v10, 0xbfb8aa3b, v98
    v_mfma_f32_16x16x32_bf16 v[152:155], v[32:35], a[96:99], v[152:155]
    v_mul_f32 v11, 0xbfb8aa3b, v99
    v_mfma_f32_16x16x32_bf16 v[152:155], v[36:39], a[116:119], v[152:155]
    v_exp_f32 v8, v8
    v_mfma_f32_16x16x32_bf16 v[136:139], v[40:43], a[120:123], v[136:139]
    ds_read_b128 v[164:167], v22 offset:17408
    v_mfma_f32_16x16x32_bf16 v[136:139], v[44:47], a[140:143], v[136:139]
    ds_read_b128 v[168:171], v22 offset:18432
    v_mfma_f32_16x16x32_bf16 v[140:143], v[44:47], a[144:147], v[140:143]
    ds_read_b128 v[172:175], v22 offset:19456
    v_mfma_f32_16x16x32_bf16 v[140:143], v[40:43], a[124:127], v[140:143]
    v_exp_f32 v9, v9
    v_mfma_f32_16x16x32_bf16 v[144:147], v[40:43], a[128:131], v[144:147]
    v_exp_f32 v10, v10
    v_mfma_f32_16x16x32_bf16 v[144:147], v[44:47], a[148:151], v[144:147]
    v_exp_f32 v11, v11
    v_mfma_f32_16x16x32_bf16 v[148:151], v[44:47], a[152:155], v[148:151]
    v_add_f32 v8, 1.0, v8
    v_add_f32 v9, 1.0, v9
    v_mfma_f32_16x16x32_bf16 v[148:151], v[40:43], a[132:135], v[148:151]
    v_add_f32 v10, 1.0, v10
    v_add_f32 v11, 1.0, v11
    v_mfma_f32_16x16x32_bf16 v[152:155], v[40:43], a[136:139], v[152:155]
    v_rcp_f32 v8, v8
    v_mfma_f32_16x16x32_bf16 v[152:155], v[44:47], a[156:159], v[152:155]
    v_rcp_f32 v9, v9
    v_mfma_f32_16x16x32_bf16 v[136:139], v[48:51], a[160:163], v[136:139]
L_SB_pad5:
    s_cbranch_execz L_SB_ret
    v_rcp_f32 v10, v10
    v_mfma_f32_16x16x32_bf16 v[136:139], v[52:55], a[180:183], v[136:139]
    v_rcp_f32 v11, v11
    v_mfma_f32_16x16x32_bf16 v[140:143], v[52:55], a[184:187], v[140:143]
    v_mul_f32 v96, v96, v8
    v_mul_f32 v97, v97, v9
    v_mfma_f32_16x16x32_bf16 v[140:143], v[48:51], a[164:167], v[140:143]
    v_mul_f32 v98, v98, v10
    v_mul_f32 v99, v99, v11
    v_mfma_f32_16x16x32_bf16 v[144:147], v[48:51], a[168:171], v[144:147]
    v_fmac_f32 v196, v216, v96
    v_fmac_f32 v197, v217, v97
    v_mfma_f32_16x16x32_bf16 v[144:147], v[52:55], a[188:191], v[144:147]
    v_fmac_f32 v198, v218, v98
    v_fmac_f32 v199, v219, v99
    v_mfma_f32_16x16x32_bf16 v[148:151], v[52:55], a[192:195], v[148:151]
    v_lshlrev_b32 v100, 16, v238
    v_and_b32 v101, 0xffff0000, v238
    v_mfma_f32_16x16x32_bf16 v[148:151], v[48:51], a[172:175], v[148:151]
    v_lshlrev_b32 v102, 16, v239
    v_lshlrev_b32 v103, 16, v240
    v_mfma_f32_16x16x32_bf16 v[152:155], v[48:51], a[176:179], v[152:155]
    v_mul_f32 v8, 0xbfb8aa3b, v100
    v_mul_f32 v9, 0xbfb8aa3b, v101
    v_mfma_f32_16x16x32_bf16 v[152:155], v[52:55], a[196:199], v[152:155]
    s_waitcnt vmcnt(8)
    v_mul_f32 v10, 0xbfb8aa3b, v102
    v_mul_f32 v11, 0xbfb8aa3b, v103
    s_waitcnt lgkmcnt(4)
    v_mfma_f32_16x16x32_bf16 v[156:159], v[56:59], a[0:3], v[156:159]
    v_exp_f32 v8, v8
    v_mfma_f32_16x16x32_bf16 v[156:159], v[60:63], a[20:23], v[156:159]
    v_exp_f32 v9, v9
    s_waitcnt lgkmcnt(3)
    v_mfma_f32_16x16x32_bf16 v[160:163], v[56:59], a[4:7], v[160:163]
    v_exp_f32 v10, v10
    v_mfma_f32_16x16x32_bf16 v[160:163], v[60:63], a[24:27], v[160:163]
    ds_write_b128 v24, v[136:139] offset:25600
    s_waitcnt lgkmcnt(3)
    v_mfma_f32_16x16x32_bf16 v[164:167], v[56:59], a[8:11], v[164:167]
    v_exp_f32 v11, v11
    v_mfma_f32_16x16x32_bf16 v[164:167], v[60:63], a[28:31], v[164:167]
    v_add_f32 v8, 1.0, v8
    v_add_f32 v9, 1.0, v9
    s_waitcnt lgkmcnt(2)
    v_mfma_f32_16x16x32_bf16 v[168:171], v[56:59], a[12:15], v[168:171]
    v_add_f32 v10, 1.0, v10
    v_add_f32 v11, 1.0, v11
    v_mfma_f32_16x16x32_bf16 v[168:171], v[60:63], a[32:35], v[168:171]
    ds_write_b128 v24, v[140:143] offset:26624
    s_waitcnt lgkmcnt(2)
    v_mfma_f32_16x16x32_bf16 v[172:175], v[56:59], a[16:19], v[172:175]
    v_rcp_f32 v8, v8
    v_mfma_f32_16x16x32_bf16 v[172:175], v[60:63], a[36:39], v[172:175]
    s_waitcnt vmcnt(6)
    v_rcp_f32 v9, v9
    v_mfma_f32_16x16x32_bf16 v[156:159], v[64:67], a[40:43], v[156:159]
    ds_write_b128 v24, v[144:147] offset:27648
    v_mfma_f32_16x16x32_bf16 v[156:159], v[68:71], a[60:63], v[156:159]
    v_rcp_f32 v10, v10
    v_mfma_f32_16x16x32_bf16 v[160:163], v[68:71], a[64:67], v[160:163]
    v_rcp_f32 v11, v11
    v_mfma_f32_16x16x32_bf16 v[160:163], v[64:67], a[44:47], v[160:163]
    v_mul_f32 v100, v100, v8
    v_mul_f32 v101, v101, v9
    v_mfma_f32_16x16x32_bf16 v[164:167], v[64:67], a[48:51], v[164:167]
    ds_write_b128 v24, v[148:151] offset:28672
    v_mfma_f32_16x16x32_bf16 v[164:167], v[68:71], a[68:71], v[164:167]
    v_mul_f32 v102, v102, v10
    v_mul_f32 v103, v103, v11
    v_mfma_f32_16x16x32_bf16 v[168:171], v[68:71], a[72:75], v[168:171]
    v_fmac_f32 v200, v220, v100
    v_fmac_f32 v201, v221, v101
    v_mfma_f32_16x16x32_bf16 v[168:171], v[64:67], a[52:55], v[168:171]
    ds_write_b128 v24, v[152:155] offset:29696
    v_mfma_f32_16x16x32_bf16 v[172:175], v[64:67], a[56:59], v[172:175]
    v_fmac_f32 v202, v222, v102
    v_fmac_f32 v203, v223, v103
    v_mfma_f32_16x16x32_bf16 v[172:175], v[68:71], a[76:79], v[172:175]
    s_waitcnt vmcnt(4)
    v_and_b32 v104, 0xffff0000, v240
    v_lshlrev_b32 v105, 16, v241
    v_mfma_f32_16x16x32_bf16 v[156:159], v[72:75], a[80:83], v[156:159]
    v_and_b32 v106, 0xffff0000, v241
    v_lshlrev_b32 v107, 16, v242
    v_mfma_f32_16x16x32_bf16 v[156:159], v[76:79], a[100:103], v[156:159]
    v_mul_f32 v8, 0xbfb8aa3b, v104
    v_mul_f32 v9, 0xbfb8aa3b, v105
    v_mfma_f32_16x16x32_bf16 v[160:163], v[76:79], a[104:107], v[160:163]
    v_mul_f32 v10, 0xbfb8aa3b, v106
    v_mul_f32 v11, 0xbfb8aa3b, v107
    v_mfma_f32_16x16x32_bf16 v[160:163], v[72:75], a[84:87], v[160:163]
    v_exp_f32 v8, v8
    v_mfma_f32_16x16x32_bf16 v[164:167], v[72:75], a[88:91], v[164:167]
    s_waitcnt lgkmcnt(0)
    s_barrier
    v_mfma_f32_16x16x32_bf16 v[164:167], v[76:79], a[108:111], v[164:167]
    ds_read_b128 v[116:119], v23 offset:15360
    v_mfma_f32_16x16x32_bf16 v[168:171], v[76:79], a[112:115], v[168:171]
    v_exp_f32 v9, v9
    v_mfma_f32_16x16x32_bf16 v[168:171], v[72:75], a[92:95], v[168:171]
    ds_read_b128 v[120:123], v23 offset:16384
    v_mfma_f32_16x16x32_bf16 v[172:175], v[72:75], a[96:99], v[172:175]
    v_exp_f32 v10, v10
    v_mfma_f32_16x16x32_bf16 v[172:175], v[76:79], a[116:119], v[172:175]
    s_waitcnt vmcnt(2)
    v_exp_f32 v11, v11
    v_mfma_f32_16x16x32_bf16 v[156:159], v[80:83], a[120:123], v[156:159]
    ds_read_b128 v[124:127], v23 offset:17408
    v_add_f32 v8, 1.0, v8
    v_mfma_f32_16x16x32_bf16 v[156:159], v[84:87], a[140:143], v[156:159]
    ds_read_b128 v[128:131], v23 offset:18432
    v_add_f32 v9, 1.0, v9
    v_mfma_f32_16x16x32_bf16 v[160:163], v[84:87], a[144:147], v[160:163]
    ds_read_b128 v[132:135], v23 offset:19456
    v_add_f32 v10, 1.0, v10
    v_mfma_f32_16x16x32_bf16 v[160:163], v[80:83], a[124:127], v[160:163]
    v_add_f32 v11, 1.0, v11
    v_mfma_f32_16x16x32_bf16 v[164:167], v[80:83], a[128:131], v[164:167]
    v_rcp_f32 v8, v8
    v_mfma_f32_16x16x32_bf16 v[164:167], v[84:87], a[148:151], v[164:167]
    v_rcp_f32 v9, v9
    v_mfma_f32_16x16x32_bf16 v[168:171], v[84:87], a[152:155], v[168:171]
    v_rcp_f32 v10, v10
    v_mfma_f32_16x16x32_bf16 v[168:171], v[80:83], a[132:135], v[168:171]
    v_rcp_f32 v11, v11
    v_mfma_f32_16x16x32_bf16 v[172:175], v[80:83], a[136:139], v[172:175]
    v_mul_f32 v104, v104, v8
    v_mul_f32 v105, v105, v9
    v_mfma_f32_16x16x32_bf16 v[172:175], v[84:87], a[156:159], v[172:175]
    s_waitcnt vmcnt(0)
    v_mul_f32 v106, v106, v10
    v_mul_f32 v107, v107, v11
    v_mfma_f32_16x16x32_bf16 v[156:159], v[88:91], a[160:163], v[156:159]
    v_fmac_f32 v204, v224, v104
L_SB_pad6:
    s_cbranch_execz L_SB_ret
    v_fmac_f32 v205, v225, v105
    v_mfma_f32_16x16x32_bf16 v[156:159], v[92:95], a[180:183], v[156:159]
    v_fmac_f32 v206, v226, v106
    v_fmac_f32 v207, v227, v107
    v_mfma_f32_16x16x32_bf16 v[160:163], v[92:95], a[184:187], v[160:163]
    v_and_b32 v108, 0xffff0000, v242
    v_lshlrev_b32 v109, 16, v243
    v_mfma_f32_16x16x32_bf16 v[160:163], v[88:91], a[164:167], v[160:163]
    v_lshlrev_b32 v110, 16, v244
    v_and_b32 v111, 0xffff0000, v244
    v_mfma_f32_16x16x32_bf16 v[164:167], v[88:91], a[168:171], v[164:167]
    v_mul_f32 v8, 0xbfb8aa3b, v108
    v_mul_f32 v9, 0xbfb8aa3b, v109
    v_mfma_f32_16x16x32_bf16 v[164:167], v[92:95], a[188:191], v[164:167]
    v_mul_f32 v10, 0xbfb8aa3b, v110
    v_mul_f32 v11, 0xbfb8aa3b, v111
    v_mfma_f32_16x16x32_bf16 v[168:171], v[92:95], a[192:195], v[168:171]
    v_exp_f32 v8, v8
    v_mfma_f32_16x16x32_bf16 v[168:171], v[88:91], a[172:175], v[168:171]
    v_exp_f32 v9, v9
    v_mfma_f32_16x16x32_bf16 v[172:175], v[88:91], a[176:179], v[172:175]
    v_exp_f32 v10, v10
    v_mfma_f32_16x16x32_bf16 v[172:175], v[92:95], a[196:199], v[172:175]
    v_exp_f32 v11, v11
    v_add_f32 v8, 1.0, v8
    v_add_f32 v9, 1.0, v9
    v_add_f32 v10, 1.0, v10
    v_add_f32 v11, 1.0, v11
    v_rcp_f32 v8, v8
    v_rcp_f32 v9, v9
    v_rcp_f32 v10, v10
    v_rcp_f32 v11, v11
    v_mul_f32 v108, v108, v8
    v_mul_f32 v109, v109, v9
    v_mul_f32 v110, v110, v10
    v_mul_f32 v111, v111, v11
    v_fmac_f32 v208, v228, v108
    v_fmac_f32 v209, v229, v109
    v_fmac_f32 v210, v230, v110
    v_fmac_f32 v211, v231, v111
    v_lshlrev_b32 v112, 16, v245
    v_and_b32 v113, 0xffff0000, v245
    v_lshlrev_b32 v114, 16, v246
    v_and_b32 v115, 0xffff0000, v246
    v_mul_f32 v8, 0xbfb8aa3b, v112
    v_mul_f32 v9, 0xbfb8aa3b, v113
    v_mul_f32 v10, 0xbfb8aa3b, v114
    v_mul_f32 v11, 0xbfb8aa3b, v115
    v_exp_f32 v8, v8
    v_exp_f32 v9, v9
    v_exp_f32 v10, v10
    v_exp_f32 v11, v11
    v_add_f32 v8, 1.0, v8
    v_add_f32 v9, 1.0, v9
    v_add_f32 v10, 1.0, v10
    v_add_f32 v11, 1.0, v11
    v_rcp_f32 v8, v8
    v_rcp_f32 v9, v9
    v_rcp_f32 v10, v10
    v_rcp_f32 v11, v11
    v_mul_f32 v112, v112, v8
    v_mul_f32 v113, v113, v9
    v_mul_f32 v114, v114, v10
    v_mul_f32 v115, v115, v11
    v_fmac_f32 v212, v232, v112
    v_fmac_f32 v213, v233, v113
    v_fmac_f32 v214, v234, v114
    v_fmac_f32 v215, v235, v115
    s_waitcnt lgkmcnt(0)
    v_fmac_f32 v196, v116, v96
    v_fmac_f32 v197, v117, v97
    v_fmac_f32 v198, v118, v98
    v_fmac_f32 v199, v119, v99
    v_fmac_f32 v200, v120, v100
    v_fmac_f32 v201, v121, v101
    v_fmac_f32 v202, v122, v102
    v_fmac_f32 v203, v123, v103
    v_fmac_f32 v204, v124, v104
    v_fmac_f32 v205, v125, v105
    v_fmac_f32 v206, v126, v106
    v_fmac_f32 v207, v127, v107
    v_fmac_f32 v208, v128, v108
    v_fmac_f32 v209, v129, v109
    v_fmac_f32 v210, v130, v110
    v_fmac_f32 v211, v131, v111
    v_fmac_f32 v212, v132, v112
    v_fmac_f32 v213, v133, v113
    v_fmac_f32 v214, v134, v114
    v_fmac_f32_e64 v215, v135, v115
    v_fma_f32 v136, v156, v96, v196
    v_fma_f32 v137, v160, v100, v200
    v_fma_f32 v138, v164, v104, v204
    v_fma_f32 v139, v168, v108, v208
    buffer_store_dwordx4 v[136:139], v4, s[56:59], s69 offen offset:0 sc1
    v_fma_f32 v140, v157, v97, v197
    v_fma_f32 v141, v161, v101, v201
    v_fma_f32 v142, v165, v105, v205
    v_fma_f32 v143, v169, v109, v209
    buffer_store_dwordx4 v[140:143], v4, s[56:59], s69 offen offset:2560 sc1
    v_fma_f32 v144, v158, v98, v198
    v_fma_f32 v145, v162, v102, v202
    v_fma_f32 v146, v166, v106, v206
    v_fma_f32 v147, v170, v110, v210
    buffer_store_dwordx4 v[144:147], v6, s[56:59], s69 offen offset:0 sc1
    v_fma_f32 v148, v159, v99, v199
    v_fma_f32 v149, v163, v103, v203
    v_fma_f32 v150, v167, v107, v207
    v_fma_f32 v151, v171, v111, v211
    buffer_store_dwordx4 v[148:151], v6, s[56:59], s69 offen offset:2560 sc1
    v_fma_f32 v152, v172, v112, v212
    v_fma_f32 v153, v173, v113, v213
    v_fma_f32 v154, v174, v114, v214
    v_fma_f32 v155, v175, v115, v215
    buffer_store_dword v152, v5, s[56:59], s69 offen offset:256 sc1
    buffer_store_dword v153, v5, s[56:59], s69 offen offset:2816 sc1
    buffer_store_dword v154, v7, s[56:59], s69 offen offset:256 sc1
    buffer_store_dword v155, v7, s[56:59], s69 offen offset:2816 sc1
    s_endpgm
L_all_end:
    .fill (57344 - (L_all_end - L_F_start)) / 4, 4, 0xbf810000
    s_endpgm

.section .rodata,"a"
.p2align 6
.amdhsa_kernel recurrent_scan__ssm_conv_s5__dense_activation_gelu__prompt_kernel
  .amdhsa_next_free_vgpr 512
  .amdhsa_next_free_sgpr 102
  .amdhsa_accum_offset 256
  .amdhsa_group_segment_fixed_size 0
  .amdhsa_kernarg_size 136
  .amdhsa_user_sgpr_count 2
  .amdhsa_user_sgpr_kernarg_segment_ptr 1
  .amdhsa_system_sgpr_workgroup_id_x 1
  .amdhsa_float_denorm_mode_32 3
.end_amdhsa_kernel
```
